```python
import torch

def _softmax(x, axis=-1):
    return torch.softmax(x, dim=axis)
def _gelu(x):
    return torch.nn.functional.gelu(x, approximate="tanh")
def _silu(x):
    return torch.nn.functional.silu(x)
def _sigmoid(x):
    return torch.sigmoid(x)
def _layernorm(x, axis=-1, eps=1e-5):
    m = x.mean(dim=axis, keepdim=True)
    v = x.var(dim=axis, keepdim=True, unbiased=False)
    return (x - m) / torch.sqrt(v + eps)
def _scatter_add(tgt, idx, src, axis=0):
    return tgt.clone().index_add_(axis, idx, src)
def _segment_sum(src, seg, n):
    out = torch.zeros((n,) + src.shape[1:], dtype=src.dtype)
    return out.index_add_(0, seg, src)
def _pad(x, pw):
    flat = tuple(v for pair in reversed(pw) for v in pair)
    return torch.nn.functional.pad(x, flat)

kernel_name = 'recurrent_scan__linear_attn_block__mixer_s_mlp__prompt'

def setup_inputs():

    _w = (lambda a: (lambda t: t.to(torch.bfloat16) if t.is_floating_point() else t)(torch.as_tensor(a)))
    def _A_setup():
        B, S, D = 1, 2048, 640
        return {
            "x": _w((lambda *s: torch.randn(*s, dtype=torch.bfloat16) * 0.05)(B, S, D)),
            "wqkv": _w((lambda *s: torch.randn(*s, dtype=torch.bfloat16) * 0.05)(D, 3 * D)),
            "wo": _w((lambda *s: torch.randn(*s, dtype=torch.bfloat16) * 0.05)(D, D)),
        }
    _A_in = _A_setup()

    def _B_setup():
        B, S, D, F = 1, 2048, 640, 1536
        return {
            "x":  _w((lambda *s: torch.randn(*s, dtype=torch.bfloat16) * 0.05)(B, S, D)),
            "w1": _w((lambda *s: torch.randn(*s, dtype=torch.bfloat16) * 3.2)(D, D) * (D ** -0.5)),
            "w2": _w((lambda *s: torch.randn(*s, dtype=torch.bfloat16) * 3.2)(D, D) * (D ** -0.5)),
            "w3": _w((lambda *s: torch.randn(*s, dtype=torch.bfloat16) * 3.2)(D, F) * (D ** -0.5)),
            "w4": _w((lambda *s: torch.randn(*s, dtype=torch.bfloat16) * 1.6)(F, D) * (F ** -0.5)),
        }
    _B_in = _B_setup()

    return {
        "A_x": _A_in["x"],
        "A_wqkv": _A_in["wqkv"],
        "A_wo": _A_in["wo"],
        "B_x": _B_in["x"],
        "B_w1": _B_in["w1"],
        "B_w2": _B_in["w2"],
        "B_w3": _B_in["w3"],
        "B_w4": _B_in["w4"],
    }

def reference(A_x, A_wqkv, A_wo, B_x, B_w1, B_w2, B_w3, B_w4):
    def _A_ref(x, wqkv, wo):
        B, S, D = x.shape
        H = 32; Dh = D // H
        qkv = (lambda x, *d: x.permute(*d))((x @ wqkv).reshape(B, S, 3, H, Dh), 2, 0, 3, 1, 4)
        q, k, v = qkv[0], qkv[1], qkv[2]
        phi = lambda t: torch.where(t > 0, t + 1, torch.exp(t)) + 1e-6
        pq, pk = phi(q), phi(k)
        kv = torch.einsum("bhsd,bhse->bhde", pk, v)
        z = torch.einsum("bhsd->bhd", pk)
        num = torch.einsum("bhqd,bhde->bhqe", pq, kv)
        den = torch.einsum("bhqd,bhd->bhq", pq, z)[..., None] + 1e-6
        o = num / den
        return (lambda x, *d: x.permute(*d))(o, 0, 2, 1, 3).reshape(B, S, D) @ wo

    def _B_ref(x, w1, w2, w3, w4):
        B, S, D = x.shape
        h = _gelu(_layernorm(x, axis=-1) @ w1)
        c = D // 4
        g0 = _pad(h[:, :, 0*c:1*c], ((0, 0), (1, 0), (0, 0)))[:, :S, :]
        g1 = _pad(h[:, :, 1*c:2*c], ((0, 0), (0, 1), (0, 0)))[:, 1:, :]
        g2 = _pad(h[:, :, 2*c:3*c], ((0, 0), (2, 0), (0, 0)))[:, :S, :]
        g3 = _pad(h[:, :, 3*c:   ], ((0, 0), (0, 2), (0, 0)))[:, 2:, :]
        hs = torch.concatenate([g0, g1, g2, g3], axis=-1) @ w2
        x1 = x + hs
        h2 = _gelu(_layernorm(x1, axis=-1) @ w3) @ w4
        return x1 + h2

    x = A_x
    xn = _layernorm(x, axis=-1)
    s = _A_ref(xn, A_wqkv, A_wo)
    g = _silu(_B_ref(xn, B_w1, B_w2, B_w3, B_w4))
    return x + s * g
```

```asm
; @launch grid=(256,1,1) block=(256,1,1) lds=163840
.amdgcn_target "amdgcn-amd-amdhsa--gfx950"
.text
.globl recurrent_scan__linear_attn_block__mixer_s_mlp__prompt_kernel
.p2align 8
.type recurrent_scan__linear_attn_block__mixer_s_mlp__prompt_kernel,@function
recurrent_scan__linear_attn_block__mixer_s_mlp__prompt_kernel:
    s_cmp_ge_u32 s2, 256
    s_cbranch_scc1 L_end
    s_load_dwordx16 s[16:31], s[0:1], 0
    s_load_dwordx4 s[32:35], s[0:1], 64
    s_load_dwordx2 s[36:37], s[0:1], 80
    s_getpc_b64 s[4:5]
L_pc:
    s_lshr_b32 s3, s2, 3
    s_lshl_b32 s3, s3, 11
    v_and_b32 v1, 15, v0
    v_lshl_add_u32 v1, v1, 7, s3
    v_min_u32 v1, L_end-L_pc, v1
    global_load_dword v2, v1, s[4:5]
    v_lshrrev_b32 v1, 6, v0
    v_and_b32 v0, 63, v0
    v_readfirstlane_b32 s60, v1
    v_lshlrev_b32 v4, 4, v0
    v_mov_b32 v197, 1073741824
    s_and_b32 s82, s2, 7
    s_lshl_b32 s61, s82, 1
    s_lshr_b32 s82, s2, 7
    s_add_u32 s61, s61, s82
    s_lshr_b32 s62, s2, 3
    s_and_b32 s62, s62, 15
    s_lshl_b32 s65, s61, 4
    s_add_u32 s65, s65, s62
    s_mov_b32 s64, 1
    s_mul_i32 s66, s60, 5120
    s_lshr_b32 s77, s60, 1
    s_and_b32 s78, s60, 1
    s_lshl_b32 s79, s61, 2
    s_add_u32 s79, s79, s60
    s_lshr_b32 s82, s62, 3
    s_lshl_b32 s82, s82, 1
    s_lshl_b32 s80, s61, 2
    s_add_u32 s80, s80, s82
    s_add_u32 s80, s80, s78
    s_and_b32 s81, s62, 7
    s_mov_b32 s63, s62
    s_mov_b32 s98, s61
    s_and_b32 s82, s61, 1
    s_mul_i32 s82, s82, 12
    s_add_u32 s82, s82, s62
    s_mul_i32 s83, s82, 43
    s_lshr_b32 s83, s83, 8
    s_mul_i32 s84, s83, 6
    s_sub_u32 s82, s82, s84
    s_and_b32 s84, s61, 12
    s_add_u32 s83, s83, s84
    s_bfe_u32 s84, s61, 0x10001
    s_mul_i32 s84, s84, 6
    s_add_u32 s82, s82, s84
    s_cmp_lt_u32 s62, 12
    s_cselect_b32 s63, s82, s62
    s_cselect_b32 s98, s83, s61
    s_lshr_b32 s85, s61, 1
    s_and_b32 s88, s98, 3
    s_mul_i32 s12, s85, 10
    s_lshr_b32 s12, s12, 3
    s_mul_i32 s84, s12, 6554
    s_lshr_b32 s84, s84, 16
    s_mul_i32 s84, s84, 10
    s_sub_u32 s12, s12, s84
    s_lshl_b32 s98, s98, 2
    s_add_u32 s98, s98, s60
    s_cmp_ge_u32 s62, 12
    s_cselect_b32 s90, 1, 3
    s_cselect_b32 s91, 12, 0
    s_mul_i32 s89, s90, 1280
    s_sub_u32 s91, s63, s91
    s_mul_i32 s91, s91, 320
    s_sub_u32 s87, s63, 4
    s_mul_i32 s88, s87, 160
    s_add_u32 s88, s88, 1280
    s_cmp_lt_u32 s87, 8
    s_cselect_b32 s91, s88, s91
    s_cselect_b32 s87, 1120, 0
    v_mov_b32 v60, s87
    v_add_u32 v56, 0, v0
    v_mul_u32_u24 v57, 3277, v56
    v_lshrrev_b32 v57, 16, v57
    v_mul_u32_u24 v59, 20, v57
    v_sub_u32 v58, v56, v59
    v_mul_lo_u32 v57, v57, s89
    v_cmp_lt_u32 vcc, 9, v58
    v_lshl_add_u32 v57, v58, 4, v57
    s_nop 0
    v_cndmask_b32 v59, 0, v60, vcc
    v_add_u32 v5, v57, v59
    v_add_u32 v56, 64, v0
    v_mul_u32_u24 v57, 3277, v56
    v_lshrrev_b32 v57, 16, v57
    v_mul_u32_u24 v59, 20, v57
    v_sub_u32 v58, v56, v59
    v_mul_lo_u32 v57, v57, s89
    v_cmp_lt_u32 vcc, 9, v58
    v_lshl_add_u32 v57, v58, 4, v57
    s_nop 0
    v_cndmask_b32 v59, 0, v60, vcc
    v_add_u32 v6, v57, v59
    v_add_u32 v56, 128, v0
    v_mul_u32_u24 v57, 3277, v56
    v_lshrrev_b32 v57, 16, v57
    v_mul_u32_u24 v59, 20, v57
    v_sub_u32 v58, v56, v59
    v_mul_lo_u32 v57, v57, s89
    v_cmp_lt_u32 vcc, 9, v58
    v_lshl_add_u32 v57, v58, 4, v57
    s_nop 0
    v_cndmask_b32 v59, 0, v60, vcc
    v_add_u32 v7, v57, v59
    v_add_u32 v56, 192, v0
    v_mul_u32_u24 v57, 3277, v56
    v_lshrrev_b32 v57, 16, v57
    v_mul_u32_u24 v59, 20, v57
    v_sub_u32 v58, v56, v59
    v_mul_lo_u32 v57, v57, s89
    v_cmp_lt_u32 vcc, 9, v58
    v_lshl_add_u32 v57, v58, 4, v57
    s_nop 0
    v_cndmask_b32 v59, 0, v60, vcc
    v_add_u32 v8, v57, v59
    v_add_u32 v56, 256, v0
    v_mul_u32_u24 v57, 3277, v56
    v_lshrrev_b32 v57, 16, v57
    v_mul_u32_u24 v59, 20, v57
    v_sub_u32 v58, v56, v59
    v_mul_lo_u32 v57, v57, s89
    v_cmp_lt_u32 vcc, 9, v58
    v_lshl_add_u32 v57, v58, 4, v57
    s_nop 0
    v_cndmask_b32 v59, 0, v60, vcc
    v_add_u32 v9, v57, v59
    v_subrev_u32 v6, 1024, v6
    v_subrev_u32 v7, 2048, v7
    v_subrev_u32 v8, 3072, v8
    v_subrev_u32 v9, 3072, v9
    s_lshl_b32 s88, s60, 4
    s_mul_i32 s88, s88, s89
    s_add_u32 s88, s88, s91
    s_lshl_b32 s68, s89, 6
    s_mov_b32 s70, s88
    s_mul_i32 s69, s68, 10
    s_add_u32 s69, s69, s88
    s_mul_i32 s67, s12, s68
    s_add_u32 s67, s67, s88
    s_sub_u32 s82, s62, 12
    s_lshr_b32 s83, s82, 1
    s_add_u32 s83, s83, 1
    s_sub_u32 s84, 0, s83
    s_bitcmp1_b32 s62, 0
    s_cselect_b32 s83, s83, s84
    s_cmp_ge_u32 s62, 12
    s_cselect_b32 s83, s83, 0
    s_lshl_b32 s3, s98, 5
    s_add_u32 s3, s3, s83
    v_lshrrev_b32 v56, 3, v0
    v_lshrrev_b32 v57, 4, v0
    v_and_b32 v58, 7, v0
    v_xor_b32 v58, v58, v57
    v_lshlrev_b32 v58, 4, v58
    v_add_u32 v56, s3, v56
    v_mul_u32_u24 v57, 1280, v56
    v_cmp_gt_u32 vcc, 2048, v56
    v_add_u32 v57, v57, v58
    s_nop 0
    v_cndmask_b32 v10, v197, v57, vcc
    v_add_u32 v56, 8, v56
    v_xor_b32 v58, 64, v58
    v_mul_u32_u24 v57, 1280, v56
    v_cmp_gt_u32 vcc, 2048, v56
    v_add_u32 v57, v57, v58
    v_subrev_u32 v57, 1024, v57
    v_cndmask_b32 v11, v197, v57, vcc
    v_add_u32 v56, 8, v56
    v_xor_b32 v58, 64, v58
    v_mul_u32_u24 v57, 1280, v56
    v_cmp_gt_u32 vcc, 2048, v56
    v_add_u32 v57, v57, v58
    v_subrev_u32 v57, 2048, v57
    v_cndmask_b32 v12, v197, v57, vcc
    v_add_u32 v56, 8, v56
    v_xor_b32 v58, 64, v58
    v_mul_u32_u24 v57, 1280, v56
    v_cmp_gt_u32 vcc, 2048, v56
    v_add_u32 v57, v57, v58
    v_subrev_u32 v57, 3072, v57
    v_cndmask_b32 v13, v197, v57, vcc
    s_mov_b32 s82, 0
    s_mov_b32 s76, s82
    s_add_u32 s75, s82, 1280
    s_mul_i32 s74, s12, 128
    s_add_u32 s74, s74, s82
    s_lshl_b32 s39, s60, 12
    s_add_u32 s39, s39, 102400
    v_lshrrev_b32 v40, 5, v0
    s_lshl_b32 s82, s60, 1
    v_add_u32 v41, s82, v40
    v_and_b32 v42, 31, v0
    v_mul_u32_u24 v43, 1280, v41
    v_lshl_add_u32 v43, v42, 4, v43
    v_cmp_gt_u32 vcc, 16, v42
    s_nop 1
    v_cndmask_b32 v44, v197, v43, vcc
    s_waitcnt lgkmcnt(0)
    s_mov_b32 s48, s16
    s_mov_b32 s49, s17
    s_mov_b32 s50, 2621440
    s_mov_b32 s51, 0x20000
    s_mul_i32 s82, s65, 10240
    buffer_load_dwordx4 v[16:19], v43, s[48:51], s82 offen
    buffer_load_dwordx4 v[20:23], v43, s[48:51], s82 offen offset:512
    buffer_load_dwordx4 v[24:27], v44, s[48:51], s82 offen offset:1024
    s_cmp_ge_u32 s62, 12
    s_cselect_b32 s44, s24, s18
    s_cselect_b32 s45, s25, s19
    s_mul_i32 s46, s90, 819200
    s_mov_b32 s47, 0x20000
    s_add_u32 m0, s66, 0
    s_nop 0
    buffer_load_dwordx4 v5, s[44:47], s67 offen offset:0  lds
    buffer_load_dwordx4 v6, s[44:47], s67 offen offset:1024  lds
    buffer_load_dwordx4 v7, s[44:47], s67 offen offset:2048  lds
    buffer_load_dwordx4 v8, s[44:47], s67 offen offset:3072  lds
    s_add_u32 m0, s66, 1024
    s_nop 0
    buffer_load_dwordx4 v9, s[44:47], s67 offen offset:3072  lds
    s_add_u32 s67, s67, s68
    s_cmp_ge_u32 s67, s69
    s_cselect_b32 s67, s70, s67
    s_mov_b32 s40, s36
    s_mov_b32 s41, s37
    s_mov_b32 s42, 33554432
    s_mov_b32 s43, 0x20000
    s_lshr_b32 s85, s61, 1
    s_and_b32 s86, s61, 1
    s_lshl_b32 s87, s86, 1
    s_lshr_b32 s84, s62, 3
    s_add_u32 s87, s87, s84
    s_mul_i32 s99, s85, 10
    s_lshr_b32 s99, s99, 3
    s_mul_i32 s84, s99, 6554
    s_lshr_b32 s84, s84, 16
    s_mul_i32 s84, s84, 10
    s_sub_u32 s99, s99, s84
    s_mul_i32 s13, s85, 5
    s_lshr_b32 s13, s13, 3
    s_mul_i32 s84, s13, 13108
    s_lshr_b32 s84, s84, 16
    s_mul_i32 s84, s84, 5
    s_sub_u32 s13, s13, s84
    s_mov_b32 s14, 0
    v_bfe_u32 v56, v0, 2, 2
    v_lshl_add_u32 v58, v40, 3, v56
    v_mul_u32_u24 v58, 320, v58
    v_bfe_u32 v57, v0, 4, 1
    v_lshl_add_u32 v58, v57, 5, v58
    v_and_b32 v57, 3, v0
    v_lshl_add_u32 v58, v57, 3, v58
    v_bfe_u32 v59, v0, 1, 3
    v_xor_b32 v59, v59, v40
    v_lshlrev_b32 v60, 7, v42
    v_add_u32 v60, s39, v60
    s_add_u32 s82, s60, 0
    s_and_b32 s82, s82, 3
    s_mul_i32 s83, s82, 5120
    s_lshl_b32 s82, s82, 1
    v_add_u32 v148, s83, v58
    v_add_u32 v149, 61440, v148
    v_xor_b32 v61, s82, v59
    v_lshl_add_u32 v156, v61, 4, v60
    s_add_u32 s82, s60, 1
    s_and_b32 s82, s82, 3
    s_mul_i32 s83, s82, 5120
    s_lshl_b32 s82, s82, 1
    v_add_u32 v150, s83, v58
    v_add_u32 v151, 61440, v150
    v_xor_b32 v61, s82, v59
    v_lshl_add_u32 v157, v61, 4, v60
    s_add_u32 s82, s60, 2
    s_and_b32 s82, s82, 3
    s_mul_i32 s83, s82, 5120
    s_lshl_b32 s82, s82, 1
    v_add_u32 v152, s83, v58
    v_add_u32 v153, 61440, v152
    v_xor_b32 v61, s82, v59
    v_lshl_add_u32 v158, v61, 4, v60
    s_add_u32 s82, s60, 3
    s_and_b32 s82, s82, 3
    s_mul_i32 s83, s82, 5120
    s_lshl_b32 s82, s82, 1
    v_add_u32 v154, s83, v58
    v_add_u32 v155, 61440, v154
    v_xor_b32 v61, s82, v59
    v_lshl_add_u32 v159, v61, 4, v60
    v_bfe_u32 v56, v0, 2, 1
    v_bfe_u32 v57, v0, 4, 1
    v_cmp_eq_u32 s[6:7], v56, v57
    v_mov_b32 v56, 0x3f803f80
    s_nop 0
    v_cndmask_b32 v160, 0, v56, s[6:7]
    v_cndmask_b32 v161, 0, v56, s[6:7]
    v_cndmask_b32 v162, 0, v56, s[6:7]
    v_cndmask_b32 v163, 0, v56, s[6:7]
    s_mul_i32 s85, s60, 2816
    s_add_u32 s85, s85, 151552
    v_add_u32 v56, 0, v0
    v_mul_u32_u24 v57, 6554, v56
    v_lshrrev_b32 v57, 16, v57
    v_mul_u32_u24 v59, 10, v57
    v_sub_u32 v58, v56, v59
    v_mul_u32_u24 v59, 1280, v57
    v_lshl_add_u32 v192, v58, 4, v59
    v_mul_u32_u24 v59, 176, v57
    v_lshl_add_u32 v59, v58, 4, v59
    v_add_u32 v45, s85, v59
    v_add_u32 v56, 64, v0
    v_mul_u32_u24 v57, 6554, v56
    v_lshrrev_b32 v57, 16, v57
    v_mul_u32_u24 v59, 10, v57
    v_sub_u32 v58, v56, v59
    v_mul_u32_u24 v59, 1280, v57
    v_lshl_add_u32 v193, v58, 4, v59
    v_mul_u32_u24 v59, 176, v57
    v_lshl_add_u32 v59, v58, 4, v59
    v_add_u32 v46, s85, v59
    v_add_u32 v56, 128, v0
    v_mul_u32_u24 v57, 6554, v56
    v_lshrrev_b32 v57, 16, v57
    v_mul_u32_u24 v59, 10, v57
    v_sub_u32 v58, v56, v59
    v_mul_u32_u24 v59, 1280, v57
    v_lshl_add_u32 v194, v58, 4, v59
    v_mul_u32_u24 v59, 176, v57
    v_lshl_add_u32 v59, v58, 4, v59
    v_add_u32 v47, s85, v59
    v_add_u32 v56, 192, v0
    v_mul_u32_u24 v57, 6554, v56
    v_lshrrev_b32 v57, 16, v57
    v_mul_u32_u24 v59, 10, v57
    v_sub_u32 v58, v56, v59
    v_mul_u32_u24 v59, 1280, v57
    v_lshl_add_u32 v195, v58, 4, v59
    v_add_u32 v56, 256, v0
    v_mul_u32_u24 v57, 6554, v56
    v_lshrrev_b32 v57, 16, v57
    v_mul_u32_u24 v59, 10, v57
    v_sub_u32 v58, v56, v59
    v_mul_u32_u24 v59, 1280, v57
    v_lshl_add_u32 v196, v58, 4, v59
    v_cmp_gt_u32 s[6:7], 32, v0
    s_nop 1
    v_cndmask_b32 v198, v197, v194, s[6:7]
    v_lshlrev_b32 v56, 4, v42
    v_add_u32 v56, 162816, v56
    v_cndmask_b32 v47, v56, v47, s[6:7]
    v_and_b32 v48, 15, v0
    v_mul_u32_u24 v48, 176, v48
    v_lshrrev_b32 v56, 4, v0
    v_lshl_add_u32 v48, v56, 3, v48
    v_add_u32 v48, s85, v48
    v_lshl_add_u32 v49, v40, 4, v48
    s_mul_i32 s38, s80, 40960
    s_mul_i32 s82, s81, 5120
    s_add_u32 s38, s38, s82
    s_lshl_b32 s15, s80, 1
    s_add_u32 s15, s15, s77
    s_mul_i32 s15, s15, 20480
    s_mul_i32 s82, s81, 160
    s_add_u32 s15, s15, s82
    s_add_u32 m0, s39, 0
    s_nop 0
    buffer_load_dwordx4 v10, s[48:51], s74 offen offset:0  lds
    buffer_load_dwordx4 v11, s[48:51], s74 offen offset:1024  lds
    buffer_load_dwordx4 v12, s[48:51], s74 offen offset:2048  lds
    buffer_load_dwordx4 v13, s[48:51], s74 offen offset:3072  lds
    s_add_u32 s74, s74, 128
    s_cmp_ge_u32 s74, s75
    s_cselect_b32 s74, s76, s74
    v_mov_b32 v248, v192
    v_mov_b32 v249, v193
    v_mov_b32 v250, v194
    v_mov_b32 v251, v195
    v_mov_b32 v252, v196
    v_subrev_u32 v249, 1024, v249
    v_subrev_u32 v250, 2048, v250
    v_subrev_u32 v251, 3072, v251
    v_subrev_u32 v252, 3072, v252
    s_mul_i32 s82, s77, 10240
    v_bfe_u32 v56, v0, 2, 3
    v_lshrrev_b32 v57, 5, v0
    v_lshl_add_u32 v56, v57, 4, v56
    v_mul_u32_u24 v56, 160, v56
    v_add_u32 v56, s82, v56
    v_and_b32 v57, 3, v0
    v_lshl_add_u32 v224, v57, 3, v56
    v_and_b32 v57, 2, v0
    v_lshl_add_u32 v225, v57, 3, v224
    v_add_u32 v226, 61440, v224
    v_add_u32 v227, 61440, v225
    s_mul_i32 s82, s81, 48
    s_mul_i32 s83, s77, 24
    s_add_u32 s82, s82, s83
    s_add_u32 s82, s82, s78
    s_mul_i32 s82, s82, 5120
    s_add_u32 s82, s82, 19398656
    s_mov_b32 s73, s82
    s_add_u32 s72, s82, 122880
    s_mul_i32 s71, s14, 10240
    s_add_u32 s71, s71, s82
    s_mul_i32 s82, s60, 5
    v_add_u32 v58, s82, v40
    v_min_u32 v56, 20, v42
    v_subrev_u32 v57, s60, v40
    v_add_u32 v59, 0, v57
    v_cmp_gt_u32 s[6:7], 5, v59
    v_mad_u32_u24 v59, v59, 21, v56
    v_lshlrev_b32 v59, 4, v59
    v_cndmask_b32 v236, v197, v59, s[6:7]
    v_add_u32 v59, 2, v57
    v_cmp_gt_u32 s[6:7], 5, v59
    v_mad_u32_u24 v59, v59, 21, v56
    v_lshlrev_b32 v59, 4, v59
    v_cndmask_b32 v237, v197, v59, s[6:7]
    v_add_u32 v59, 4, v57
    v_cmp_gt_u32 s[6:7], 5, v59
    v_mad_u32_u24 v59, v59, 21, v56
    v_lshlrev_b32 v59, 4, v59
    v_cndmask_b32 v238, v197, v59, s[6:7]
    v_add_u32 v59, 6, v57
    v_cmp_gt_u32 s[6:7], 5, v59
    v_mad_u32_u24 v59, v59, 21, v56
    v_lshlrev_b32 v59, 4, v59
    v_cndmask_b32 v239, v197, v59, s[6:7]
    v_lshlrev_b32 v59, 4, v42
    v_add_u32 v56, 0, v58
    v_lshrrev_b32 v228, 2, v56
    v_lshl_add_u32 v228, v228, 10, v59
    v_and_b32 v57, 1, v56
    v_lshl_add_u32 v228, v57, 9, v228
    v_bfe_u32 v57, v56, 1, 1
    v_lshl_add_u32 v228, v57, 3, v228
    v_add_u32 v56, 2, v58
    v_lshrrev_b32 v229, 2, v56
    v_lshl_add_u32 v229, v229, 10, v59
    v_and_b32 v57, 1, v56
    v_lshl_add_u32 v229, v57, 9, v229
    v_bfe_u32 v57, v56, 1, 1
    v_lshl_add_u32 v229, v57, 3, v229
    v_add_u32 v56, 4, v58
    v_lshrrev_b32 v230, 2, v56
    v_lshl_add_u32 v230, v230, 10, v59
    v_and_b32 v57, 1, v56
    v_lshl_add_u32 v230, v57, 9, v230
    v_bfe_u32 v57, v56, 1, 1
    v_lshl_add_u32 v230, v57, 3, v230
    v_cmp_gt_u32 s[6:7], 32, v0
    v_add_u32 v59, 12288, v59
    s_nop 0
    v_cndmask_b32 v230, v59, v230, s[6:7]
    s_mul_i32 s82, s78, 5120
    s_mul_i32 s83, s77, 3072
    s_add_u32 s82, s82, s83
    v_add_u32 v232, s82, v4
    v_lshlrev_b32 v233, 3, v0
    v_cmp_gt_u32 s[6:7], 16, v0
    s_nop 1
    v_cndmask_b32 v233, v197, v233, s[6:7]
    s_add_u32 s82, s81, 4
    s_lshl_b32 s82, s82, 7
    v_lshl_add_u32 v56, v0, 2, s82
    s_lshr_b32 s82, s81, 1
    s_lshl_b32 s82, s82, 7
    s_lshl_b32 s83, s61, 2
    s_add_u32 s82, s82, s83
    v_mov_b32 v57, s82
    v_cndmask_b32 v231, v57, v56, s[6:7]
    s_xor_b32 s83, s60, 2
    s_mul_i32 s83, s83, 5120
    v_add_u32 v234, s66, v4
    v_add_u32 v235, s83, v4
    s_mov_b32 s83, 22151168
    v_mov_b32 v1, 0
    buffer_load_dword v15, v1, s[40:43], s83 offen sc1
    s_mov_b32 s82, 0xffff0000
    s_waitcnt vmcnt(12)
    v_lshlrev_b32 v64, 16, v16
    v_and_b32 v65, s82, v16
    v_lshlrev_b32 v66, 16, v17
    v_and_b32 v67, s82, v17
    v_lshlrev_b32 v68, 16, v18
    v_and_b32 v69, s82, v18
    v_lshlrev_b32 v70, 16, v19
    v_and_b32 v71, s82, v19
    s_waitcnt vmcnt(11)
    v_lshlrev_b32 v72, 16, v20
    v_and_b32 v73, s82, v20
    v_lshlrev_b32 v74, 16, v21
    v_and_b32 v75, s82, v21
    v_lshlrev_b32 v76, 16, v22
    v_and_b32 v77, s82, v22
    v_lshlrev_b32 v78, 16, v23
    v_and_b32 v79, s82, v23
    s_waitcnt vmcnt(10)
    v_lshlrev_b32 v80, 16, v24
    v_and_b32 v81, s82, v24
    v_lshlrev_b32 v82, 16, v25
    v_and_b32 v83, s82, v25
    v_lshlrev_b32 v84, 16, v26
    v_and_b32 v85, s82, v26
    v_lshlrev_b32 v86, 16, v27
    v_and_b32 v87, s82, v27
    v_pk_add_f32 v[56:57], v[64:65], v[66:67]
    v_pk_add_f32 v[56:57], v[56:57], v[68:69]
    v_pk_add_f32 v[56:57], v[56:57], v[70:71]
    v_pk_add_f32 v[56:57], v[56:57], v[72:73]
    v_pk_add_f32 v[56:57], v[56:57], v[74:75]
    v_pk_add_f32 v[56:57], v[56:57], v[76:77]
    v_pk_add_f32 v[56:57], v[56:57], v[78:79]
    v_pk_add_f32 v[56:57], v[56:57], v[80:81]
    v_pk_add_f32 v[56:57], v[56:57], v[82:83]
    v_pk_add_f32 v[56:57], v[56:57], v[84:85]
    v_pk_add_f32 v[56:57], v[56:57], v[86:87]
    v_add_f32 v56, v56, v57
    s_add_u32 m0, s66, 20480
    s_nop 0
    buffer_load_dwordx4 v5, s[44:47], s67 offen offset:0  lds
    buffer_load_dwordx4 v6, s[44:47], s67 offen offset:1024  lds
    buffer_load_dwordx4 v7, s[44:47], s67 offen offset:2048  lds
    buffer_load_dwordx4 v8, s[44:47], s67 offen offset:3072  lds
    s_add_u32 m0, s66, 21504
    s_nop 0
    buffer_load_dwordx4 v9, s[44:47], s67 offen offset:3072  lds
    s_add_u32 s67, s67, s68
    s_cmp_ge_u32 s67, s69
    s_cselect_b32 s67, s70, s67
    v_add_f32_dpp v56, v56, v56 quad_perm:[1,0,3,2] row_mask:0xf bank_mask:0xf
    s_nop 1
    v_add_f32_dpp v56, v56, v56 quad_perm:[2,3,0,1] row_mask:0xf bank_mask:0xf
    s_nop 1
    v_add_f32_dpp v56, v56, v56 row_half_mirror row_mask:0xf bank_mask:0xf
    s_nop 1
    v_add_f32_dpp v56, v56, v56 row_mirror row_mask:0xf bank_mask:0xf
    v_mov_b32 v57, v56
    s_nop 1
    v_permlane16_swap_b32 v56, v57
    v_add_f32 v56, v56, v57
    v_mul_f32 v60, 0x3acccccd, v56
    v_cndmask_b32 v58, 0, v60, vcc
    v_pk_add_f32 v[64:65], v[64:65], v[60:61] op_sel_hi:[1,0] neg_lo:[0,1] neg_hi:[0,1]
    v_pk_add_f32 v[66:67], v[66:67], v[60:61] op_sel_hi:[1,0] neg_lo:[0,1] neg_hi:[0,1]
    v_pk_add_f32 v[68:69], v[68:69], v[60:61] op_sel_hi:[1,0] neg_lo:[0,1] neg_hi:[0,1]
    v_pk_add_f32 v[70:71], v[70:71], v[60:61] op_sel_hi:[1,0] neg_lo:[0,1] neg_hi:[0,1]
    v_pk_add_f32 v[72:73], v[72:73], v[60:61] op_sel_hi:[1,0] neg_lo:[0,1] neg_hi:[0,1]
    v_pk_add_f32 v[74:75], v[74:75], v[60:61] op_sel_hi:[1,0] neg_lo:[0,1] neg_hi:[0,1]
    v_pk_add_f32 v[76:77], v[76:77], v[60:61] op_sel_hi:[1,0] neg_lo:[0,1] neg_hi:[0,1]
    v_pk_add_f32 v[78:79], v[78:79], v[60:61] op_sel_hi:[1,0] neg_lo:[0,1] neg_hi:[0,1]
    v_pk_add_f32 v[80:81], v[80:81], v[58:59] op_sel_hi:[1,0] neg_lo:[0,1] neg_hi:[0,1]
    v_pk_add_f32 v[82:83], v[82:83], v[58:59] op_sel_hi:[1,0] neg_lo:[0,1] neg_hi:[0,1]
    v_pk_add_f32 v[84:85], v[84:85], v[58:59] op_sel_hi:[1,0] neg_lo:[0,1] neg_hi:[0,1]
    v_pk_add_f32 v[86:87], v[86:87], v[58:59] op_sel_hi:[1,0] neg_lo:[0,1] neg_hi:[0,1]
    v_pk_mul_f32 v[56:57], v[64:65], v[64:65]
    v_pk_fma_f32 v[56:57], v[66:67], v[66:67], v[56:57]
    v_pk_fma_f32 v[56:57], v[68:69], v[68:69], v[56:57]
    v_pk_fma_f32 v[56:57], v[70:71], v[70:71], v[56:57]
    v_pk_fma_f32 v[56:57], v[72:73], v[72:73], v[56:57]
    v_pk_fma_f32 v[56:57], v[74:75], v[74:75], v[56:57]
    v_pk_fma_f32 v[56:57], v[76:77], v[76:77], v[56:57]
    v_pk_fma_f32 v[56:57], v[78:79], v[78:79], v[56:57]
    v_pk_fma_f32 v[56:57], v[80:81], v[80:81], v[56:57]
    v_pk_fma_f32 v[56:57], v[82:83], v[82:83], v[56:57]
    v_pk_fma_f32 v[56:57], v[84:85], v[84:85], v[56:57]
    v_pk_fma_f32 v[56:57], v[86:87], v[86:87], v[56:57]
    v_add_f32 v56, v56, v57
    s_nop 1
    v_add_f32_dpp v56, v56, v56 quad_perm:[1,0,3,2] row_mask:0xf bank_mask:0xf
    s_nop 1
    v_add_f32_dpp v56, v56, v56 quad_perm:[2,3,0,1] row_mask:0xf bank_mask:0xf
    s_nop 1
    v_add_f32_dpp v56, v56, v56 row_half_mirror row_mask:0xf bank_mask:0xf
    s_nop 1
    v_add_f32_dpp v56, v56, v56 row_mirror row_mask:0xf bank_mask:0xf
    v_mov_b32 v57, v56
    s_nop 1
    v_permlane16_swap_b32 v56, v57
    v_add_f32 v56, v56, v57
    v_mul_f32 v56, 0x3acccccd, v56
    v_add_f32 v56, 0x3727c5ac, v56
    v_rsq_f32 v61, v56
    v_cmp_eq_u32 vcc, 0, v42
    v_lshlrev_b32 v57, 3, v41
    s_nop 0
    v_cndmask_b32 v57, v197, v57, vcc
    s_lshl_b32 s82, s65, 6
    s_add_u32 s82, s82, 21757952
    buffer_store_dwordx2 v[60:61], v57, s[40:43], s82 offen sc1
    v_mov_b32 v28, 0
    v_mov_b32 v29, 0
    v_mov_b32 v30, 0
    v_mov_b32 v31, 0
    s_lshl_b32 s82, s65, 10
    s_add_u32 s82, s82, 21495808
    s_cmp_eq_u32 s60, 3
    s_cselect_b32 s82, s82, 1073741824
    buffer_store_dwordx4 v[28:31], v4, s[40:43], s82 offen sc1
    s_add_u32 m0, s39, 16384
    s_nop 0
    buffer_load_dwordx4 v10, s[48:51], s74 offen offset:0  lds
    buffer_load_dwordx4 v11, s[48:51], s74 offen offset:1024  lds
    buffer_load_dwordx4 v12, s[48:51], s74 offen offset:2048  lds
    buffer_load_dwordx4 v13, s[48:51], s74 offen offset:3072  lds
    s_add_u32 s74, s74, 128
    s_cmp_ge_u32 s74, s75
    s_cselect_b32 s74, s76, s74
    v_mov_b32 v212, v45
    v_mov_b32 v213, v46
    v_mov_b32 v214, v47
    v_mov_b32 v215, v48
    v_mov_b32 v216, v49
    s_mov_b32 s101, 1073741824
    s_mov_b32 s23, 1073741824
    s_mov_b32 s56, s30
    s_mov_b32 s57, s31
    s_mov_b32 s58, 1966080
    s_mov_b32 s59, 0x20000
    s_lshr_b32 s86, s98, 2
    v_mov_b32 v240, v192
    v_mov_b32 v241, v193
    v_mov_b32 v242, v194
    v_mov_b32 v243, v195
    v_mov_b32 v244, v196
    s_cmp_ge_u32 s63, 12
    s_cbranch_scc1 L_sd_2
    s_cmp_ge_u32 s63, 4
    s_cbranch_scc1 L_sd_1
    s_lshl_b32 s87, s63, 4
    s_add_u32 s87, s87, s86
    s_mul_i32 s101, s87, 40960
    s_mul_i32 s90, s60, 160
    s_add_u32 s101, s101, s90
    s_add_u32 s23, s101, 640
    s_mul_i32 s100, s60, 48
    s_add_u32 s100, s100, s87
    s_mul_i32 s100, s100, 5120
    s_add_u32 s100, s100, 19398656
    s_cmp_lt_u32 s87, 48
    s_cselect_b32 s100, s100, 1073741824
    s_branch L_sd_2
L_sd_1:
    s_mov_b32 s56, s28
    s_mov_b32 s57, s29
    s_mov_b32 s58, 1966080
    s_mov_b32 s59, 0x20000
    s_lshl_b32 s84, s86, 3
    s_add_u32 s84, s84, s63
    s_sub_u32 s84, s84, 4
    s_mul_i32 s87, s84, 2731
    s_lshr_b32 s87, s87, 16
    s_mul_i32 s88, s87, 24
    s_sub_u32 s88, s84, s88
    s_lshl_b32 s87, s87, 2
    s_add_u32 s87, s87, s60
    s_mul_i32 s101, s87, 98304
    s_lshl_b32 s87, s88, 7
    s_add_u32 s101, s101, s87
    s_lshl_b32 s100, s88, 8
    s_add_u32 s100, s100, 21626880
    s_cmp_lt_u32 s84, 120
    s_cselect_b32 s100, s100, 1073741824
    v_lshrrev_b32 v58, 3, v0
    v_mul_u32_u24 v58, 3072, v58
    v_and_b32 v59, 7, v0
    v_lshl_add_u32 v240, v59, 4, v58
    v_add_u32 v241, 24576, v240
    v_add_u32 v242, 49152, v240
    v_add_u32 v243, 73728, v240
    v_mov_b32 v244, v197
L_sd_2:
    s_waitcnt vmcnt(12)
    s_barrier
    ds_read_b128 v[184:187], v156 offset:0
    ds_read_b64_tr_b16 v[16:17], v148 offset:0
    ds_read_b64_tr_b16 v[18:19], v148 offset:1280
    ds_read_b64_tr_b16 v[20:21], v148 offset:64
    ds_read_b64_tr_b16 v[22:23], v148 offset:1344
    ds_read_b64_tr_b16 v[24:25], v148 offset:128
    ds_read_b64_tr_b16 v[26:27], v148 offset:1408
    ds_read_b64_tr_b16 v[28:29], v148 offset:192
    ds_read_b64_tr_b16 v[30:31], v148 offset:1472
    ds_read_b64_tr_b16 v[32:33], v148 offset:256
    ds_read_b64_tr_b16 v[34:35], v148 offset:1536
    s_waitcnt lgkmcnt(8)
    v_mfma_f32_32x32x16_bf16 v[64:79], v[16:19], v[184:187], 0
    ds_read_b128 v[188:191], v157 offset:0
    ds_read_b64_tr_b16 v[36:37], v150 offset:0
    s_add_u32 m0, s66, 40960
    v_mfma_f32_16x16x32_bf16 v[164:167], v[160:163], v[16:19], 0
    ds_read_b64_tr_b16 v[38:39], v150 offset:1280
    s_waitcnt lgkmcnt(9)
    v_mfma_f32_32x32x16_bf16 v[80:95], v[20:23], v[184:187], 0
    ds_read_b64_tr_b16 v[40:41], v150 offset:64
    ds_read_b64_tr_b16 v[42:43], v150 offset:1344
    ds_read_b64_tr_b16 v[44:45], v150 offset:128
    buffer_load_dwordx4 v5, s[44:47], s67 offen offset:0  lds
    s_waitcnt lgkmcnt(10)
    v_mfma_f32_32x32x16_bf16 v[96:111], v[24:27], v[184:187], 0
    ds_read_b64_tr_b16 v[46:47], v150 offset:1408
    ds_read_b64_tr_b16 v[48:49], v150 offset:192
    buffer_load_dwordx4 v6, s[44:47], s67 offen offset:1024  lds
    s_waitcnt lgkmcnt(10)
    v_mfma_f32_32x32x16_bf16 v[112:127], v[28:31], v[184:187], 0
    ds_read_b64_tr_b16 v[50:51], v150 offset:1472
    ds_read_b64_tr_b16 v[52:53], v150 offset:256
    s_waitcnt lgkmcnt(10)
    v_mfma_f32_32x32x16_bf16 v[128:143], v[32:35], v[184:187], 0
    ds_read_b64_tr_b16 v[54:55], v150 offset:1536
    buffer_load_dwordx4 v7, s[44:47], s67 offen offset:2048  lds
    v_mfma_f32_16x16x32_bf16 v[180:183], v[160:163], v[32:35], 0
    s_waitcnt lgkmcnt(8)
    v_mfma_f32_32x32x16_bf16 v[64:79], v[36:39], v[188:191], v[64:79]
    ds_read_b128 v[184:187], v158 offset:0
    ds_read_b64_tr_b16 v[16:17], v152 offset:0
    ds_read_b64_tr_b16 v[18:19], v152 offset:1280
    buffer_load_dwordx4 v8, s[44:47], s67 offen offset:3072  lds
    s_waitcnt lgkmcnt(9)
    v_mfma_f32_32x32x16_bf16 v[80:95], v[40:43], v[188:191], v[80:95]
    ds_read_b64_tr_b16 v[20:21], v152 offset:64
    ds_read_b64_tr_b16 v[22:23], v152 offset:1344
    v_mfma_f32_16x16x32_bf16 v[168:171], v[160:163], v[40:43], 0
    ds_read_b64_tr_b16 v[24:25], v152 offset:128
    s_add_u32 m0, s66, 41984
    s_waitcnt lgkmcnt(10)
    v_mfma_f32_32x32x16_bf16 v[96:111], v[44:47], v[188:191], v[96:111]
    ds_read_b64_tr_b16 v[26:27], v152 offset:1408
    ds_read_b64_tr_b16 v[28:29], v152 offset:192
    ds_read_b64_tr_b16 v[30:31], v152 offset:1472
    buffer_load_dwordx4 v9, s[44:47], s67 offen offset:3072  lds
    s_waitcnt lgkmcnt(11)
    v_mfma_f32_32x32x16_bf16 v[112:127], v[48:51], v[188:191], v[112:127]
    ds_read_b64_tr_b16 v[32:33], v152 offset:256
    ds_read_b64_tr_b16 v[34:35], v152 offset:1536
    s_add_u32 s67, s67, s68
    s_waitcnt lgkmcnt(11)
    v_mfma_f32_32x32x16_bf16 v[128:143], v[52:55], v[188:191], v[128:143]
    s_cmp_ge_u32 s67, s69
    s_cselect_b32 s67, s70, s67
    s_waitcnt lgkmcnt(8)
    v_mfma_f32_32x32x16_bf16 v[64:79], v[16:19], v[184:187], v[64:79]
    ds_read_b128 v[188:191], v159 offset:0
    ds_read_b64_tr_b16 v[36:37], v154 offset:0
    ds_read_b64_tr_b16 v[38:39], v154 offset:1280
    s_waitcnt lgkmcnt(9)
    v_mfma_f32_32x32x16_bf16 v[80:95], v[20:23], v[184:187], v[80:95]
    ds_read_b64_tr_b16 v[40:41], v154 offset:64
    ds_read_b64_tr_b16 v[42:43], v154 offset:1344
    s_add_u32 m0, s39, 32768
    s_waitcnt lgkmcnt(9)
    v_mfma_f32_32x32x16_bf16 v[96:111], v[24:27], v[184:187], v[96:111]
    ds_read_b64_tr_b16 v[44:45], v154 offset:128
    ds_read_b64_tr_b16 v[46:47], v154 offset:1408
    buffer_load_dwordx4 v10, s[48:51], s74 offen offset:0  lds
    v_mfma_f32_16x16x32_bf16 v[172:175], v[160:163], v[24:27], 0
    ds_read_b64_tr_b16 v[48:49], v154 offset:192
    s_waitcnt lgkmcnt(10)
    v_mfma_f32_32x32x16_bf16 v[112:127], v[28:31], v[184:187], v[112:127]
    ds_read_b64_tr_b16 v[50:51], v154 offset:1472
    ds_read_b64_tr_b16 v[52:53], v154 offset:256
    ds_read_b64_tr_b16 v[54:55], v154 offset:1536
    buffer_load_dwordx4 v11, s[48:51], s74 offen offset:1024  lds
    s_waitcnt lgkmcnt(11)
    v_mfma_f32_32x32x16_bf16 v[128:143], v[32:35], v[184:187], v[128:143]
    buffer_load_dwordx4 v12, s[48:51], s74 offen offset:2048  lds
    s_waitcnt lgkmcnt(8)
    v_mfma_f32_32x32x16_bf16 v[64:79], v[36:39], v[188:191], v[64:79]
    s_waitcnt vmcnt(8)
    s_barrier
    ds_read_b128 v[184:187], v156 offset:16384
    ds_read_b64_tr_b16 v[16:17], v148 offset:20480
    s_waitcnt lgkmcnt(8)
    v_mfma_f32_32x32x16_bf16 v[80:95], v[40:43], v[188:191], v[80:95]
    ds_read_b64_tr_b16 v[18:19], v148 offset:21760
    ds_read_b64_tr_b16 v[20:21], v148 offset:20544
    ds_read_b64_tr_b16 v[22:23], v148 offset:21824
    buffer_load_dwordx4 v13, s[48:51], s74 offen offset:3072  lds
    s_waitcnt lgkmcnt(9)
    v_mfma_f32_32x32x16_bf16 v[96:111], v[44:47], v[188:191], v[96:111]
    ds_read_b64_tr_b16 v[24:25], v148 offset:20608
    ds_read_b64_tr_b16 v[26:27], v148 offset:21888
    s_waitcnt lgkmcnt(9)
    v_mfma_f32_32x32x16_bf16 v[112:127], v[48:51], v[188:191], v[112:127]
    ds_read_b64_tr_b16 v[28:29], v148 offset:20672
    ds_read_b64_tr_b16 v[30:31], v148 offset:21952
    s_add_u32 s74, s74, 128
    v_mfma_f32_16x16x32_bf16 v[176:179], v[160:163], v[48:51], 0
    ds_read_b64_tr_b16 v[32:33], v148 offset:20736
    ds_read_b64_tr_b16 v[34:35], v148 offset:22016
    s_waitcnt lgkmcnt(11)
    v_mfma_f32_32x32x16_bf16 v[128:143], v[52:55], v[188:191], v[128:143]
    s_cmp_ge_u32 s74, s75
    s_cselect_b32 s74, s76, s74
    s_waitcnt lgkmcnt(8)
    v_mfma_f32_32x32x16_bf16 v[64:79], v[16:19], v[184:187], v[64:79]
    ds_read_b128 v[188:191], v157 offset:16384
    ds_read_b64_tr_b16 v[36:37], v150 offset:20480
    s_add_u32 m0, s66, 61440
    v_mfma_f32_16x16x32_bf16 v[164:167], v[160:163], v[16:19], v[164:167]
    ds_read_b64_tr_b16 v[38:39], v150 offset:21760
    s_waitcnt lgkmcnt(9)
    v_mfma_f32_32x32x16_bf16 v[80:95], v[20:23], v[184:187], v[80:95]
    ds_read_b64_tr_b16 v[40:41], v150 offset:20544
    ds_read_b64_tr_b16 v[42:43], v150 offset:21824
    ds_read_b64_tr_b16 v[44:45], v150 offset:20608
    buffer_load_dwordx4 v5, s[44:47], s67 offen offset:0  lds
    s_waitcnt lgkmcnt(10)
    v_mfma_f32_32x32x16_bf16 v[96:111], v[24:27], v[184:187], v[96:111]
    ds_read_b64_tr_b16 v[46:47], v150 offset:21888
    ds_read_b64_tr_b16 v[48:49], v150 offset:20672
    buffer_load_dwordx4 v6, s[44:47], s67 offen offset:1024  lds
    s_waitcnt lgkmcnt(10)
    v_mfma_f32_32x32x16_bf16 v[112:127], v[28:31], v[184:187], v[112:127]
    ds_read_b64_tr_b16 v[50:51], v150 offset:21952
    ds_read_b64_tr_b16 v[52:53], v150 offset:20736
    s_waitcnt lgkmcnt(10)
    v_mfma_f32_32x32x16_bf16 v[128:143], v[32:35], v[184:187], v[128:143]
    ds_read_b64_tr_b16 v[54:55], v150 offset:22016
    buffer_load_dwordx4 v7, s[44:47], s67 offen offset:2048  lds
    v_mfma_f32_16x16x32_bf16 v[180:183], v[160:163], v[32:35], v[180:183]
    s_waitcnt lgkmcnt(8)
    v_mfma_f32_32x32x16_bf16 v[64:79], v[36:39], v[188:191], v[64:79]
    ds_read_b128 v[184:187], v158 offset:16384
    ds_read_b64_tr_b16 v[16:17], v152 offset:20480
    ds_read_b64_tr_b16 v[18:19], v152 offset:21760
    buffer_load_dwordx4 v8, s[44:47], s67 offen offset:3072  lds
    s_waitcnt lgkmcnt(9)
    v_mfma_f32_32x32x16_bf16 v[80:95], v[40:43], v[188:191], v[80:95]
    ds_read_b64_tr_b16 v[20:21], v152 offset:20544
    ds_read_b64_tr_b16 v[22:23], v152 offset:21824
    v_mfma_f32_16x16x32_bf16 v[168:171], v[160:163], v[40:43], v[168:171]
    ds_read_b64_tr_b16 v[24:25], v152 offset:20608
    s_add_u32 m0, s66, 62464
    s_waitcnt lgkmcnt(10)
    v_mfma_f32_32x32x16_bf16 v[96:111], v[44:47], v[188:191], v[96:111]
    ds_read_b64_tr_b16 v[26:27], v152 offset:21888
    ds_read_b64_tr_b16 v[28:29], v152 offset:20672
    ds_read_b64_tr_b16 v[30:31], v152 offset:21952
    buffer_load_dwordx4 v9, s[44:47], s67 offen offset:3072  lds
    s_waitcnt lgkmcnt(11)
    v_mfma_f32_32x32x16_bf16 v[112:127], v[48:51], v[188:191], v[112:127]
    ds_read_b64_tr_b16 v[32:33], v152 offset:20736
    ds_read_b64_tr_b16 v[34:35], v152 offset:22016
    s_add_u32 s67, s67, s68
    s_waitcnt lgkmcnt(11)
    v_mfma_f32_32x32x16_bf16 v[128:143], v[52:55], v[188:191], v[128:143]
    s_cmp_ge_u32 s67, s69
    s_cselect_b32 s67, s70, s67
    s_waitcnt lgkmcnt(8)
    v_mfma_f32_32x32x16_bf16 v[64:79], v[16:19], v[184:187], v[64:79]
    ds_read_b128 v[188:191], v159 offset:16384
    ds_read_b64_tr_b16 v[36:37], v154 offset:20480
    ds_read_b64_tr_b16 v[38:39], v154 offset:21760
    s_waitcnt lgkmcnt(9)
    v_mfma_f32_32x32x16_bf16 v[80:95], v[20:23], v[184:187], v[80:95]
    ds_read_b64_tr_b16 v[40:41], v154 offset:20544
    ds_read_b64_tr_b16 v[42:43], v154 offset:21824
    s_add_u32 m0, s39, 0
    s_waitcnt lgkmcnt(9)
    v_mfma_f32_32x32x16_bf16 v[96:111], v[24:27], v[184:187], v[96:111]
    ds_read_b64_tr_b16 v[44:45], v154 offset:20608
    ds_read_b64_tr_b16 v[46:47], v154 offset:21888
    buffer_load_dwordx4 v10, s[48:51], s74 offen offset:0  lds
    v_mfma_f32_16x16x32_bf16 v[172:175], v[160:163], v[24:27], v[172:175]
    ds_read_b64_tr_b16 v[48:49], v154 offset:20672
    s_waitcnt lgkmcnt(10)
    v_mfma_f32_32x32x16_bf16 v[112:127], v[28:31], v[184:187], v[112:127]
    ds_read_b64_tr_b16 v[50:51], v154 offset:21952
    ds_read_b64_tr_b16 v[52:53], v154 offset:20736
    ds_read_b64_tr_b16 v[54:55], v154 offset:22016
    buffer_load_dwordx4 v11, s[48:51], s74 offen offset:1024  lds
    s_waitcnt lgkmcnt(11)
    v_mfma_f32_32x32x16_bf16 v[128:143], v[32:35], v[184:187], v[128:143]
    buffer_load_dwordx4 v12, s[48:51], s74 offen offset:2048  lds
    s_waitcnt lgkmcnt(8)
    v_mfma_f32_32x32x16_bf16 v[64:79], v[36:39], v[188:191], v[64:79]
    s_waitcnt vmcnt(8)
    s_barrier
    v_add_u32 v15, 1, v15
    s_cmp_gt_u32 s60, 1
    s_cbranch_scc1 L_fs_3
    s_mov_b64 exec, 1
    s_cmp_eq_u32 s60, 0
    s_cbranch_scc1 L_fs_4
    s_lshl_b32 s93, s65, 2
    s_add_u32 s93, s93, 22085632
    buffer_store_dword v15, v4, s[40:43], s93 offen sc1
    s_branch L_fs_3
L_fs_4:
L_fs_3:
    s_mov_b64 exec, -1
    ds_read_b128 v[184:187], v156 offset:32768
    ds_read_b64_tr_b16 v[16:17], v148 offset:40960
    s_waitcnt lgkmcnt(8)
    v_mfma_f32_32x32x16_bf16 v[80:95], v[40:43], v[188:191], v[80:95]
    ds_read_b64_tr_b16 v[18:19], v148 offset:42240
    ds_read_b64_tr_b16 v[20:21], v148 offset:41024
    ds_read_b64_tr_b16 v[22:23], v148 offset:42304
    buffer_load_dwordx4 v13, s[48:51], s74 offen offset:3072  lds
    s_waitcnt lgkmcnt(9)
    v_mfma_f32_32x32x16_bf16 v[96:111], v[44:47], v[188:191], v[96:111]
    ds_read_b64_tr_b16 v[24:25], v148 offset:41088
    ds_read_b64_tr_b16 v[26:27], v148 offset:42368
    s_waitcnt lgkmcnt(9)
    v_mfma_f32_32x32x16_bf16 v[112:127], v[48:51], v[188:191], v[112:127]
    ds_read_b64_tr_b16 v[28:29], v148 offset:41152
    ds_read_b64_tr_b16 v[30:31], v148 offset:42432
    s_add_u32 s74, s74, 128
    v_mfma_f32_16x16x32_bf16 v[176:179], v[160:163], v[48:51], v[176:179]
    ds_read_b64_tr_b16 v[32:33], v148 offset:41216
    ds_read_b64_tr_b16 v[34:35], v148 offset:42496
    s_waitcnt lgkmcnt(11)
    v_mfma_f32_32x32x16_bf16 v[128:143], v[52:55], v[188:191], v[128:143]
    s_cmp_ge_u32 s74, s75
    s_cselect_b32 s74, s76, s74
    s_waitcnt lgkmcnt(8)
    v_mfma_f32_32x32x16_bf16 v[64:79], v[16:19], v[184:187], v[64:79]
    ds_read_b128 v[188:191], v157 offset:32768
    ds_read_b64_tr_b16 v[36:37], v150 offset:40960
    s_add_u32 m0, s66, 81920
    s_nop 0
    buffer_load_dwordx4 v5, s[44:47], s67 offen offset:0  lds
    v_mfma_f32_16x16x32_bf16 v[164:167], v[160:163], v[16:19], v[164:167]
    ds_read_b64_tr_b16 v[38:39], v150 offset:42240
    s_waitcnt lgkmcnt(9)
    v_mfma_f32_32x32x16_bf16 v[80:95], v[20:23], v[184:187], v[80:95]
    ds_read_b64_tr_b16 v[40:41], v150 offset:41024
    ds_read_b64_tr_b16 v[42:43], v150 offset:42304
    ds_read_b64_tr_b16 v[44:45], v150 offset:41088
    buffer_load_dwordx4 v6, s[44:47], s67 offen offset:1024  lds
    s_waitcnt lgkmcnt(10)
    v_mfma_f32_32x32x16_bf16 v[96:111], v[24:27], v[184:187], v[96:111]
    ds_read_b64_tr_b16 v[46:47], v150 offset:42368
    ds_read_b64_tr_b16 v[48:49], v150 offset:41152
    s_waitcnt lgkmcnt(10)
    v_mfma_f32_32x32x16_bf16 v[112:127], v[28:31], v[184:187], v[112:127]
    ds_read_b64_tr_b16 v[50:51], v150 offset:42432
    ds_read_b64_tr_b16 v[52:53], v150 offset:41216
    buffer_load_dwordx4 v7, s[44:47], s67 offen offset:2048  lds
    s_waitcnt lgkmcnt(10)
    v_mfma_f32_32x32x16_bf16 v[128:143], v[32:35], v[184:187], v[128:143]
    ds_read_b64_tr_b16 v[54:55], v150 offset:42496
    buffer_load_dwordx4 v8, s[44:47], s67 offen offset:3072  lds
    v_mfma_f32_16x16x32_bf16 v[180:183], v[160:163], v[32:35], v[180:183]
    s_waitcnt lgkmcnt(8)
    v_mfma_f32_32x32x16_bf16 v[64:79], v[36:39], v[188:191], v[64:79]
    ds_read_b128 v[184:187], v158 offset:32768
    ds_read_b64_tr_b16 v[16:17], v152 offset:40960
    ds_read_b64_tr_b16 v[18:19], v152 offset:42240
    s_add_u32 m0, s66, 82944
    s_waitcnt lgkmcnt(9)
    v_mfma_f32_32x32x16_bf16 v[80:95], v[40:43], v[188:191], v[80:95]
    ds_read_b64_tr_b16 v[20:21], v152 offset:41024
    ds_read_b64_tr_b16 v[22:23], v152 offset:42304
    buffer_load_dwordx4 v9, s[44:47], s67 offen offset:3072  lds
    v_mfma_f32_16x16x32_bf16 v[168:171], v[160:163], v[40:43], v[168:171]
    ds_read_b64_tr_b16 v[24:25], v152 offset:41088
    s_add_u32 s67, s67, s68
    s_waitcnt lgkmcnt(10)
    v_mfma_f32_32x32x16_bf16 v[96:111], v[44:47], v[188:191], v[96:111]
    ds_read_b64_tr_b16 v[26:27], v152 offset:42368
    ds_read_b64_tr_b16 v[28:29], v152 offset:41152
    ds_read_b64_tr_b16 v[30:31], v152 offset:42432
    s_cmp_ge_u32 s67, s69
    s_cselect_b32 s67, s70, s67
    s_waitcnt lgkmcnt(11)
    v_mfma_f32_32x32x16_bf16 v[112:127], v[48:51], v[188:191], v[112:127]
    ds_read_b64_tr_b16 v[32:33], v152 offset:41216
    ds_read_b64_tr_b16 v[34:35], v152 offset:42496
    s_add_u32 m0, s39, 16384
    s_waitcnt lgkmcnt(11)
    v_mfma_f32_32x32x16_bf16 v[128:143], v[52:55], v[188:191], v[128:143]
    buffer_load_dwordx4 v10, s[48:51], s74 offen offset:0  lds
    s_waitcnt lgkmcnt(8)
    v_mfma_f32_32x32x16_bf16 v[64:79], v[16:19], v[184:187], v[64:79]
    ds_read_b128 v[188:191], v159 offset:32768
    ds_read_b64_tr_b16 v[36:37], v154 offset:40960
    ds_read_b64_tr_b16 v[38:39], v154 offset:42240
    buffer_load_dwordx4 v11, s[48:51], s74 offen offset:1024  lds
    s_waitcnt lgkmcnt(9)
    v_mfma_f32_32x32x16_bf16 v[80:95], v[20:23], v[184:187], v[80:95]
    ds_read_b64_tr_b16 v[40:41], v154 offset:41024
    ds_read_b64_tr_b16 v[42:43], v154 offset:42304
    s_waitcnt lgkmcnt(9)
    v_mfma_f32_32x32x16_bf16 v[96:111], v[24:27], v[184:187], v[96:111]
    ds_read_b64_tr_b16 v[44:45], v154 offset:41088
    ds_read_b64_tr_b16 v[46:47], v154 offset:42368
    buffer_load_dwordx4 v12, s[48:51], s74 offen offset:2048  lds
    v_mfma_f32_16x16x32_bf16 v[172:175], v[160:163], v[24:27], v[172:175]
    ds_read_b64_tr_b16 v[48:49], v154 offset:41152
    s_waitcnt lgkmcnt(10)
    v_mfma_f32_32x32x16_bf16 v[112:127], v[28:31], v[184:187], v[112:127]
    ds_read_b64_tr_b16 v[50:51], v154 offset:42432
    ds_read_b64_tr_b16 v[52:53], v154 offset:41216
    ds_read_b64_tr_b16 v[54:55], v154 offset:42496
    buffer_load_dwordx4 v13, s[48:51], s74 offen offset:3072  lds
    s_add_u32 s74, s74, 128
    s_waitcnt lgkmcnt(11)
    v_mfma_f32_32x32x16_bf16 v[128:143], v[32:35], v[184:187], v[128:143]
    s_cmp_ge_u32 s74, s75
    s_cselect_b32 s74, s76, s74
    s_waitcnt lgkmcnt(8)
    v_mfma_f32_32x32x16_bf16 v[64:79], v[36:39], v[188:191], v[64:79]
    s_waitcnt vmcnt(9)
    s_barrier
    ds_read_b128 v[184:187], v156 offset:0
    ds_read_b64_tr_b16 v[16:17], v149 offset:0
    s_waitcnt lgkmcnt(8)
    v_mfma_f32_32x32x16_bf16 v[80:95], v[40:43], v[188:191], v[80:95]
    ds_read_b64_tr_b16 v[18:19], v149 offset:1280
    ds_read_b64_tr_b16 v[20:21], v149 offset:64
    ds_read_b64_tr_b16 v[22:23], v149 offset:1344
    buffer_load_dwordx4 v[200:203], v192, s[48:51], s15 offen
    buffer_load_dwordx4 v[204:207], v193, s[48:51], s15 offen
    s_waitcnt lgkmcnt(9)
    v_mfma_f32_32x32x16_bf16 v[96:111], v[44:47], v[188:191], v[96:111]
    ds_read_b64_tr_b16 v[24:25], v149 offset:128
    ds_read_b64_tr_b16 v[26:27], v149 offset:1408
    buffer_load_dwordx4 v[208:211], v198, s[48:51], s15 offen
    s_waitcnt lgkmcnt(9)
    v_mfma_f32_32x32x16_bf16 v[112:127], v[48:51], v[188:191], v[112:127]
    ds_read_b64_tr_b16 v[28:29], v149 offset:192
    ds_read_b64_tr_b16 v[30:31], v149 offset:1472
    s_lshl_b32 s83, s61, 9
    s_add_u32 s83, s83, 22020096
    v_mfma_f32_16x16x32_bf16 v[176:179], v[160:163], v[48:51], v[176:179]
    ds_read_b64_tr_b16 v[32:33], v149 offset:256
    ds_read_b64_tr_b16 v[34:35], v149 offset:1536
    s_waitcnt lgkmcnt(11)
    v_mfma_f32_32x32x16_bf16 v[128:143], v[52:55], v[188:191], v[128:143]
    v_lshlrev_b32 v1, 3, v0
    buffer_load_dword v2, v1, s[40:43], s83 offen sc1
    s_waitcnt lgkmcnt(8)
    v_mfma_f32_32x32x16_bf16 v[64:79], v[16:19], v[184:187], v[64:79]
    ds_read_b128 v[188:191], v157 offset:0
    ds_read_b64_tr_b16 v[36:37], v151 offset:0
    s_add_u32 m0, s66, 0
    v_mfma_f32_16x16x32_bf16 v[164:167], v[160:163], v[16:19], v[164:167]
    ds_read_b64_tr_b16 v[38:39], v151 offset:1280
    s_waitcnt lgkmcnt(9)
    v_mfma_f32_32x32x16_bf16 v[80:95], v[20:23], v[184:187], v[80:95]
    ds_read_b64_tr_b16 v[40:41], v151 offset:64
    ds_read_b64_tr_b16 v[42:43], v151 offset:1344
    ds_read_b64_tr_b16 v[44:45], v151 offset:128
    buffer_load_dwordx4 v5, s[44:47], s67 offen offset:0  lds
    s_waitcnt lgkmcnt(10)
    v_mfma_f32_32x32x16_bf16 v[96:111], v[24:27], v[184:187], v[96:111]
    ds_read_b64_tr_b16 v[46:47], v151 offset:1408
    ds_read_b64_tr_b16 v[48:49], v151 offset:192
    buffer_load_dwordx4 v6, s[44:47], s67 offen offset:1024  lds
    s_waitcnt lgkmcnt(10)
    v_mfma_f32_32x32x16_bf16 v[112:127], v[28:31], v[184:187], v[112:127]
    ds_read_b64_tr_b16 v[50:51], v151 offset:1472
    ds_read_b64_tr_b16 v[52:53], v151 offset:256
    s_waitcnt lgkmcnt(10)
    v_mfma_f32_32x32x16_bf16 v[128:143], v[32:35], v[184:187], v[128:143]
    ds_read_b64_tr_b16 v[54:55], v151 offset:1536
    buffer_load_dwordx4 v7, s[44:47], s67 offen offset:2048  lds
    v_mfma_f32_16x16x32_bf16 v[180:183], v[160:163], v[32:35], v[180:183]
    s_waitcnt lgkmcnt(8)
    v_mfma_f32_32x32x16_bf16 v[64:79], v[36:39], v[188:191], v[64:79]
    ds_read_b128 v[184:187], v158 offset:0
    ds_read_b64_tr_b16 v[16:17], v153 offset:0
    ds_read_b64_tr_b16 v[18:19], v153 offset:1280
    buffer_load_dwordx4 v8, s[44:47], s67 offen offset:3072  lds
    s_waitcnt lgkmcnt(9)
    v_mfma_f32_32x32x16_bf16 v[80:95], v[40:43], v[188:191], v[80:95]
    ds_read_b64_tr_b16 v[20:21], v153 offset:64
    ds_read_b64_tr_b16 v[22:23], v153 offset:1344
    v_mfma_f32_16x16x32_bf16 v[168:171], v[160:163], v[40:43], v[168:171]
    ds_read_b64_tr_b16 v[24:25], v153 offset:128
    s_add_u32 m0, s66, 1024
    s_waitcnt lgkmcnt(10)
    v_mfma_f32_32x32x16_bf16 v[96:111], v[44:47], v[188:191], v[96:111]
    ds_read_b64_tr_b16 v[26:27], v153 offset:1408
    ds_read_b64_tr_b16 v[28:29], v153 offset:192
    ds_read_b64_tr_b16 v[30:31], v153 offset:1472
    buffer_load_dwordx4 v9, s[44:47], s67 offen offset:3072  lds
    s_waitcnt lgkmcnt(11)
    v_mfma_f32_32x32x16_bf16 v[112:127], v[48:51], v[188:191], v[112:127]
    ds_read_b64_tr_b16 v[32:33], v153 offset:256
    ds_read_b64_tr_b16 v[34:35], v153 offset:1536
    s_add_u32 s67, s67, s68
    s_waitcnt lgkmcnt(11)
    v_mfma_f32_32x32x16_bf16 v[128:143], v[52:55], v[188:191], v[128:143]
    s_cmp_ge_u32 s67, s69
    s_cselect_b32 s67, s70, s67
    s_waitcnt lgkmcnt(8)
    v_mfma_f32_32x32x16_bf16 v[64:79], v[16:19], v[184:187], v[64:79]
    ds_read_b128 v[188:191], v159 offset:0
    ds_read_b64_tr_b16 v[36:37], v155 offset:0
    ds_read_b64_tr_b16 v[38:39], v155 offset:1280
    s_waitcnt lgkmcnt(9)
    v_mfma_f32_32x32x16_bf16 v[80:95], v[20:23], v[184:187], v[80:95]
    ds_read_b64_tr_b16 v[40:41], v155 offset:64
    ds_read_b64_tr_b16 v[42:43], v155 offset:1344
    s_add_u32 m0, s39, 32768
    s_waitcnt lgkmcnt(9)
    v_mfma_f32_32x32x16_bf16 v[96:111], v[24:27], v[184:187], v[96:111]
    ds_read_b64_tr_b16 v[44:45], v155 offset:128
    ds_read_b64_tr_b16 v[46:47], v155 offset:1408
    buffer_load_dwordx4 v10, s[48:51], s74 offen offset:0  lds
    v_mfma_f32_16x16x32_bf16 v[172:175], v[160:163], v[24:27], v[172:175]
    ds_read_b64_tr_b16 v[48:49], v155 offset:192
    s_waitcnt lgkmcnt(10)
    v_mfma_f32_32x32x16_bf16 v[112:127], v[28:31], v[184:187], v[112:127]
    ds_read_b64_tr_b16 v[50:51], v155 offset:1472
    ds_read_b64_tr_b16 v[52:53], v155 offset:256
    ds_read_b64_tr_b16 v[54:55], v155 offset:1536
    buffer_load_dwordx4 v11, s[48:51], s74 offen offset:1024  lds
    s_waitcnt lgkmcnt(11)
    v_mfma_f32_32x32x16_bf16 v[128:143], v[32:35], v[184:187], v[128:143]
    buffer_load_dwordx4 v12, s[48:51], s74 offen offset:2048  lds
    s_waitcnt lgkmcnt(8)
    v_mfma_f32_32x32x16_bf16 v[64:79], v[36:39], v[188:191], v[64:79]
    s_waitcnt vmcnt(12)
    s_barrier
    ds_read_b128 v[184:187], v156 offset:16384
    ds_read_b64_tr_b16 v[16:17], v149 offset:20480
    s_waitcnt lgkmcnt(8)
    v_mfma_f32_32x32x16_bf16 v[80:95], v[40:43], v[188:191], v[80:95]
    ds_read_b64_tr_b16 v[18:19], v149 offset:21760
    ds_read_b64_tr_b16 v[20:21], v149 offset:20544
    ds_read_b64_tr_b16 v[22:23], v149 offset:21824
    buffer_load_dwordx4 v13, s[48:51], s74 offen offset:3072  lds
    s_waitcnt lgkmcnt(9)
    v_mfma_f32_32x32x16_bf16 v[96:111], v[44:47], v[188:191], v[96:111]
    ds_read_b64_tr_b16 v[24:25], v149 offset:20608
    ds_read_b64_tr_b16 v[26:27], v149 offset:21888
    s_waitcnt lgkmcnt(9)
    v_mfma_f32_32x32x16_bf16 v[112:127], v[48:51], v[188:191], v[112:127]
    ds_read_b64_tr_b16 v[28:29], v149 offset:20672
    ds_read_b64_tr_b16 v[30:31], v149 offset:21952
    s_add_u32 s74, s74, 128
    v_mfma_f32_16x16x32_bf16 v[176:179], v[160:163], v[48:51], v[176:179]
    ds_read_b64_tr_b16 v[32:33], v149 offset:20736
    ds_read_b64_tr_b16 v[34:35], v149 offset:22016
    s_waitcnt lgkmcnt(11)
    v_mfma_f32_32x32x16_bf16 v[128:143], v[52:55], v[188:191], v[128:143]
    s_cmp_ge_u32 s74, s75
    s_cselect_b32 s74, s76, s74
    s_waitcnt lgkmcnt(8)
    v_mfma_f32_32x32x16_bf16 v[64:79], v[16:19], v[184:187], v[64:79]
    ds_read_b128 v[188:191], v157 offset:16384
    ds_read_b64_tr_b16 v[36:37], v151 offset:20480
    s_add_u32 m0, s66, 20480
    v_mfma_f32_16x16x32_bf16 v[164:167], v[160:163], v[16:19], v[164:167]
    ds_read_b64_tr_b16 v[38:39], v151 offset:21760
    s_waitcnt lgkmcnt(9)
    v_mfma_f32_32x32x16_bf16 v[80:95], v[20:23], v[184:187], v[80:95]
    ds_read_b64_tr_b16 v[40:41], v151 offset:20544
    ds_read_b64_tr_b16 v[42:43], v151 offset:21824
    ds_read_b64_tr_b16 v[44:45], v151 offset:20608
    buffer_load_dwordx4 v5, s[44:47], s67 offen offset:0  lds
    s_waitcnt lgkmcnt(10)
    v_mfma_f32_32x32x16_bf16 v[96:111], v[24:27], v[184:187], v[96:111]
    ds_read_b64_tr_b16 v[46:47], v151 offset:21888
    ds_read_b64_tr_b16 v[48:49], v151 offset:20672
    buffer_load_dwordx4 v6, s[44:47], s67 offen offset:1024  lds
    s_waitcnt lgkmcnt(10)
    v_mfma_f32_32x32x16_bf16 v[112:127], v[28:31], v[184:187], v[112:127]
    ds_read_b64_tr_b16 v[50:51], v151 offset:21952
    ds_read_b64_tr_b16 v[52:53], v151 offset:20736
    s_waitcnt lgkmcnt(10)
    v_mfma_f32_32x32x16_bf16 v[128:143], v[32:35], v[184:187], v[128:143]
    ds_read_b64_tr_b16 v[54:55], v151 offset:22016
    buffer_load_dwordx4 v7, s[44:47], s67 offen offset:2048  lds
    v_mfma_f32_16x16x32_bf16 v[180:183], v[160:163], v[32:35], v[180:183]
    s_waitcnt lgkmcnt(8)
    v_mfma_f32_32x32x16_bf16 v[64:79], v[36:39], v[188:191], v[64:79]
    ds_read_b128 v[184:187], v158 offset:16384
    ds_read_b64_tr_b16 v[16:17], v153 offset:20480
    ds_read_b64_tr_b16 v[18:19], v153 offset:21760
    buffer_load_dwordx4 v8, s[44:47], s67 offen offset:3072  lds
    s_waitcnt lgkmcnt(9)
    v_mfma_f32_32x32x16_bf16 v[80:95], v[40:43], v[188:191], v[80:95]
    ds_read_b64_tr_b16 v[20:21], v153 offset:20544
    ds_read_b64_tr_b16 v[22:23], v153 offset:21824
    v_mfma_f32_16x16x32_bf16 v[168:171], v[160:163], v[40:43], v[168:171]
    ds_read_b64_tr_b16 v[24:25], v153 offset:20608
    s_add_u32 m0, s66, 21504
    s_waitcnt lgkmcnt(10)
    v_mfma_f32_32x32x16_bf16 v[96:111], v[44:47], v[188:191], v[96:111]
    ds_read_b64_tr_b16 v[26:27], v153 offset:21888
    ds_read_b64_tr_b16 v[28:29], v153 offset:20672
    ds_read_b64_tr_b16 v[30:31], v153 offset:21952
    buffer_load_dwordx4 v9, s[44:47], s67 offen offset:3072  lds
    s_waitcnt lgkmcnt(11)
    v_mfma_f32_32x32x16_bf16 v[112:127], v[48:51], v[188:191], v[112:127]
    ds_read_b64_tr_b16 v[32:33], v153 offset:20736
    ds_read_b64_tr_b16 v[34:35], v153 offset:22016
    s_add_u32 s67, s67, s68
    s_waitcnt lgkmcnt(11)
    v_mfma_f32_32x32x16_bf16 v[128:143], v[52:55], v[188:191], v[128:143]
    s_cmp_ge_u32 s67, s69
    s_cselect_b32 s67, s70, s67
    s_waitcnt lgkmcnt(8)
    v_mfma_f32_32x32x16_bf16 v[64:79], v[16:19], v[184:187], v[64:79]
    ds_read_b128 v[188:191], v159 offset:16384
    ds_read_b64_tr_b16 v[36:37], v155 offset:20480
    ds_read_b64_tr_b16 v[38:39], v155 offset:21760
    s_waitcnt lgkmcnt(9)
    v_mfma_f32_32x32x16_bf16 v[80:95], v[20:23], v[184:187], v[80:95]
    ds_read_b64_tr_b16 v[40:41], v155 offset:20544
    ds_read_b64_tr_b16 v[42:43], v155 offset:21824
    s_add_u32 m0, s39, 0
    s_waitcnt lgkmcnt(9)
    v_mfma_f32_32x32x16_bf16 v[96:111], v[24:27], v[184:187], v[96:111]
    ds_read_b64_tr_b16 v[44:45], v155 offset:20608
    ds_read_b64_tr_b16 v[46:47], v155 offset:21888
    buffer_load_dwordx4 v10, s[48:51], s74 offen offset:0  lds
    v_mfma_f32_16x16x32_bf16 v[172:175], v[160:163], v[24:27], v[172:175]
    ds_read_b64_tr_b16 v[48:49], v155 offset:20672
    s_waitcnt lgkmcnt(10)
    v_mfma_f32_32x32x16_bf16 v[112:127], v[28:31], v[184:187], v[112:127]
    ds_read_b64_tr_b16 v[50:51], v155 offset:21952
    ds_read_b64_tr_b16 v[52:53], v155 offset:20736
    ds_read_b64_tr_b16 v[54:55], v155 offset:22016
    buffer_load_dwordx4 v11, s[48:51], s74 offen offset:1024  lds
    s_waitcnt lgkmcnt(11)
    v_mfma_f32_32x32x16_bf16 v[128:143], v[32:35], v[184:187], v[128:143]
    buffer_load_dwordx4 v12, s[48:51], s74 offen offset:2048  lds
    s_waitcnt lgkmcnt(8)
    v_mfma_f32_32x32x16_bf16 v[64:79], v[36:39], v[188:191], v[64:79]
    s_waitcnt vmcnt(8)
    s_barrier
    ds_read_b128 v[184:187], v156 offset:32768
    ds_read_b64_tr_b16 v[16:17], v148 offset:0
    s_waitcnt lgkmcnt(8)
    v_mfma_f32_32x32x16_bf16 v[80:95], v[40:43], v[188:191], v[80:95]
    ds_read_b64_tr_b16 v[18:19], v148 offset:1280
    ds_read_b64_tr_b16 v[20:21], v148 offset:64
    ds_read_b64_tr_b16 v[22:23], v148 offset:1344
    buffer_load_dwordx4 v13, s[48:51], s74 offen offset:3072  lds
    s_waitcnt lgkmcnt(9)
    v_mfma_f32_32x32x16_bf16 v[96:111], v[44:47], v[188:191], v[96:111]
    ds_read_b64_tr_b16 v[24:25], v148 offset:128
    ds_read_b64_tr_b16 v[26:27], v148 offset:1408
    s_waitcnt lgkmcnt(9)
    v_mfma_f32_32x32x16_bf16 v[112:127], v[48:51], v[188:191], v[112:127]
    ds_read_b64_tr_b16 v[28:29], v148 offset:192
    ds_read_b64_tr_b16 v[30:31], v148 offset:1472
    s_add_u32 s74, s74, 128
    v_mfma_f32_16x16x32_bf16 v[176:179], v[160:163], v[48:51], v[176:179]
    ds_read_b64_tr_b16 v[32:33], v148 offset:256
    ds_read_b64_tr_b16 v[34:35], v148 offset:1536
    s_waitcnt lgkmcnt(11)
    v_mfma_f32_32x32x16_bf16 v[128:143], v[52:55], v[188:191], v[128:143]
    s_cmp_ge_u32 s74, s75
    s_cselect_b32 s74, s76, s74
    s_waitcnt lgkmcnt(8)
    v_mfma_f32_32x32x16_bf16 v[64:79], v[16:19], v[184:187], v[64:79]
    ds_read_b128 v[188:191], v157 offset:32768
    ds_read_b64_tr_b16 v[36:37], v150 offset:0
    s_add_u32 m0, s66, 40960
    s_nop 0
    buffer_load_dwordx4 v5, s[44:47], s67 offen offset:0  lds
    v_mfma_f32_16x16x32_bf16 v[164:167], v[160:163], v[16:19], v[164:167]
    ds_read_b64_tr_b16 v[38:39], v150 offset:1280
    s_waitcnt lgkmcnt(9)
    v_mfma_f32_32x32x16_bf16 v[80:95], v[20:23], v[184:187], v[80:95]
    ds_read_b64_tr_b16 v[40:41], v150 offset:64
    ds_read_b64_tr_b16 v[42:43], v150 offset:1344
    ds_read_b64_tr_b16 v[44:45], v150 offset:128
    buffer_load_dwordx4 v6, s[44:47], s67 offen offset:1024  lds
    s_waitcnt lgkmcnt(10)
    v_mfma_f32_32x32x16_bf16 v[96:111], v[24:27], v[184:187], v[96:111]
    ds_read_b64_tr_b16 v[46:47], v150 offset:1408
    ds_read_b64_tr_b16 v[48:49], v150 offset:192
    s_waitcnt lgkmcnt(10)
    v_mfma_f32_32x32x16_bf16 v[112:127], v[28:31], v[184:187], v[112:127]
    ds_read_b64_tr_b16 v[50:51], v150 offset:1472
    ds_read_b64_tr_b16 v[52:53], v150 offset:256
    buffer_load_dwordx4 v7, s[44:47], s67 offen offset:2048  lds
    s_waitcnt lgkmcnt(10)
    v_mfma_f32_32x32x16_bf16 v[128:143], v[32:35], v[184:187], v[128:143]
    ds_read_b64_tr_b16 v[54:55], v150 offset:1536
    v_mfma_f32_16x16x32_bf16 v[180:183], v[160:163], v[32:35], v[180:183]
    buffer_load_dwordx4 v8, s[44:47], s67 offen offset:3072  lds
    s_waitcnt lgkmcnt(8)
    v_mfma_f32_32x32x16_bf16 v[64:79], v[36:39], v[188:191], v[64:79]
    ds_read_b128 v[184:187], v158 offset:32768
    ds_read_b64_tr_b16 v[16:17], v152 offset:0
    ds_read_b64_tr_b16 v[18:19], v152 offset:1280
    s_add_u32 m0, s66, 41984
    s_waitcnt lgkmcnt(9)
    v_mfma_f32_32x32x16_bf16 v[80:95], v[40:43], v[188:191], v[80:95]
    ds_read_b64_tr_b16 v[20:21], v152 offset:64
    ds_read_b64_tr_b16 v[22:23], v152 offset:1344
    buffer_load_dwordx4 v9, s[44:47], s67 offen offset:3072  lds
    v_mfma_f32_16x16x32_bf16 v[168:171], v[160:163], v[40:43], v[168:171]
    ds_read_b64_tr_b16 v[24:25], v152 offset:128
    s_waitcnt lgkmcnt(10)
    v_mfma_f32_32x32x16_bf16 v[96:111], v[44:47], v[188:191], v[96:111]
    ds_read_b64_tr_b16 v[26:27], v152 offset:1408
    ds_read_b64_tr_b16 v[28:29], v152 offset:192
    ds_read_b64_tr_b16 v[30:31], v152 offset:1472
    s_add_u32 s67, s67, s68
    s_cmp_ge_u32 s67, s69
    s_cselect_b32 s67, s70, s67
    s_waitcnt lgkmcnt(11)
    v_mfma_f32_32x32x16_bf16 v[112:127], v[48:51], v[188:191], v[112:127]
    ds_read_b64_tr_b16 v[32:33], v152 offset:256
    ds_read_b64_tr_b16 v[34:35], v152 offset:1536
    s_waitcnt lgkmcnt(11)
    v_mfma_f32_32x32x16_bf16 v[128:143], v[52:55], v[188:191], v[128:143]
    s_add_u32 m0, s39, 16384
    s_waitcnt lgkmcnt(8)
    v_mfma_f32_32x32x16_bf16 v[64:79], v[16:19], v[184:187], v[64:79]
    ds_read_b128 v[188:191], v159 offset:32768
    ds_read_b64_tr_b16 v[36:37], v154 offset:0
    ds_read_b64_tr_b16 v[38:39], v154 offset:1280
    buffer_load_dwordx4 v10, s[48:51], s74 offen offset:0  lds
    s_waitcnt lgkmcnt(9)
    v_mfma_f32_32x32x16_bf16 v[80:95], v[20:23], v[184:187], v[80:95]
    ds_read_b64_tr_b16 v[40:41], v154 offset:64
    ds_read_b64_tr_b16 v[42:43], v154 offset:1344
    buffer_load_dwordx4 v11, s[48:51], s74 offen offset:1024  lds
    s_waitcnt lgkmcnt(9)
    v_mfma_f32_32x32x16_bf16 v[96:111], v[24:27], v[184:187], v[96:111]
    ds_read_b64_tr_b16 v[44:45], v154 offset:128
    ds_read_b64_tr_b16 v[46:47], v154 offset:1408
    v_mfma_f32_16x16x32_bf16 v[172:175], v[160:163], v[24:27], v[172:175]
    ds_read_b64_tr_b16 v[48:49], v154 offset:192
    s_waitcnt lgkmcnt(10)
    v_mfma_f32_32x32x16_bf16 v[112:127], v[28:31], v[184:187], v[112:127]
    ds_read_b64_tr_b16 v[50:51], v154 offset:1472
    ds_read_b64_tr_b16 v[52:53], v154 offset:256
    ds_read_b64_tr_b16 v[54:55], v154 offset:1536
    buffer_load_dwordx4 v12, s[48:51], s74 offen offset:2048  lds
    s_waitcnt lgkmcnt(11)
    v_mfma_f32_32x32x16_bf16 v[128:143], v[32:35], v[184:187], v[128:143]
    buffer_load_dwordx4 v13, s[48:51], s74 offen offset:3072  lds
    s_waitcnt lgkmcnt(8)
    v_mfma_f32_32x32x16_bf16 v[64:79], v[36:39], v[188:191], v[64:79]
    s_waitcnt vmcnt(9)
    s_barrier
    ds_read_b128 v[184:187], v156 offset:0
    ds_read_b64_tr_b16 v[16:17], v148 offset:20480
    s_add_u32 s74, s74, 128
    s_waitcnt lgkmcnt(8)
    v_mfma_f32_32x32x16_bf16 v[80:95], v[40:43], v[188:191], v[80:95]
    ds_read_b64_tr_b16 v[18:19], v148 offset:21760
    ds_read_b64_tr_b16 v[20:21], v148 offset:20544
    ds_read_b64_tr_b16 v[22:23], v148 offset:21824
    s_cmp_ge_u32 s74, s75
    s_cselect_b32 s74, s76, s74
    s_waitcnt lgkmcnt(9)
    v_mfma_f32_32x32x16_bf16 v[96:111], v[44:47], v[188:191], v[96:111]
    ds_read_b64_tr_b16 v[24:25], v148 offset:20608
    ds_read_b64_tr_b16 v[26:27], v148 offset:21888
    ds_write_b128 v212, v[200:203]
    s_waitcnt lgkmcnt(10)
    v_mfma_f32_32x32x16_bf16 v[112:127], v[48:51], v[188:191], v[112:127]
    ds_read_b64_tr_b16 v[28:29], v148 offset:20672
    ds_read_b64_tr_b16 v[30:31], v148 offset:21952
    ds_write_b128 v213, v[204:207]
    ds_write_b128 v214, v[208:211]
    v_mfma_f32_16x16x32_bf16 v[176:179], v[160:163], v[48:51], v[176:179]
    ds_read_b64_tr_b16 v[32:33], v148 offset:20736
    ds_read_b64_tr_b16 v[34:35], v148 offset:22016
    s_waitcnt lgkmcnt(14)
    v_mfma_f32_32x32x16_bf16 v[128:143], v[52:55], v[188:191], v[128:143]
    v_mov_b32 v56, v215
    v_mov_b32 v57, v216
    s_waitcnt lgkmcnt(11)
    v_mfma_f32_32x32x16_bf16 v[64:79], v[16:19], v[184:187], v[64:79]
    ds_read_b128 v[188:191], v157 offset:0
    ds_read_b64_tr_b16 v[36:37], v150 offset:20480
    ds_read_b64 v[212:213], v57 offset:0
    ds_read_b64 v[214:215], v57 offset:16
    v_mfma_f32_16x16x32_bf16 v[164:167], v[160:163], v[16:19], v[164:167]
    ds_read_b64_tr_b16 v[38:39], v150 offset:21760
    ds_read_b64 v[216:217], v57 offset:64
    s_waitcnt lgkmcnt(15)
    v_mfma_f32_32x32x16_bf16 v[80:95], v[20:23], v[184:187], v[80:95]
    ds_read_b64_tr_b16 v[40:41], v150 offset:20544
    ds_read_b64_tr_b16 v[42:43], v150 offset:21824
    ds_read_b64_tr_b16 v[44:45], v150 offset:20608
    ds_read_b64 v[218:219], v57 offset:80
    s_waitcnt lgkmcnt(15)
    v_mfma_f32_32x32x16_bf16 v[96:111], v[24:27], v[184:187], v[96:111]
    ds_read_b64_tr_b16 v[46:47], v150 offset:21888
    ds_read_b64_tr_b16 v[48:49], v150 offset:20672
    ds_read_b64 v[220:221], v56 offset:128
    s_waitcnt lgkmcnt(15)
    v_mfma_f32_32x32x16_bf16 v[112:127], v[28:31], v[184:187], v[112:127]
    ds_read_b64_tr_b16 v[50:51], v150 offset:21952
    ds_read_b64_tr_b16 v[52:53], v150 offset:20736
    s_add_u32 m0, s66, 61440
    s_nop 0
    buffer_load_dwordx4 v5, s[44:47], s67 offen offset:0  lds
    s_waitcnt lgkmcnt(15)
    v_mfma_f32_32x32x16_bf16 v[128:143], v[32:35], v[184:187], v[128:143]
    ds_read_b64_tr_b16 v[54:55], v150 offset:22016
    v_mfma_f32_16x16x32_bf16 v[180:183], v[160:163], v[32:35], v[180:183]
    buffer_load_dwordx4 v6, s[44:47], s67 offen offset:1024  lds
    s_waitcnt lgkmcnt(11)
    v_mfma_f32_32x32x16_bf16 v[64:79], v[36:39], v[188:191], v[64:79]
    ds_read_b128 v[184:187], v158 offset:0
    ds_read_b64_tr_b16 v[16:17], v152 offset:20480
    ds_read_b64_tr_b16 v[18:19], v152 offset:21760
    s_waitcnt lgkmcnt(11)
    v_mfma_f32_32x32x16_bf16 v[80:95], v[40:43], v[188:191], v[80:95]
    ds_read_b64_tr_b16 v[20:21], v152 offset:20544
    ds_read_b64_tr_b16 v[22:23], v152 offset:21824
    buffer_load_dwordx4 v7, s[44:47], s67 offen offset:2048  lds
    v_mfma_f32_16x16x32_bf16 v[168:171], v[160:163], v[40:43], v[168:171]
    ds_read_b64_tr_b16 v[24:25], v152 offset:20608
    s_waitcnt lgkmcnt(11)
    v_mfma_f32_32x32x16_bf16 v[96:111], v[44:47], v[188:191], v[96:111]
    ds_read_b64_tr_b16 v[26:27], v152 offset:21888
    ds_read_b64_tr_b16 v[28:29], v152 offset:20672
    ds_read_b64_tr_b16 v[30:31], v152 offset:21952
    buffer_load_dwordx4 v8, s[44:47], s67 offen offset:3072  lds
    s_add_u32 m0, s66, 62464
    s_waitcnt lgkmcnt(11)
    v_mfma_f32_32x32x16_bf16 v[112:127], v[48:51], v[188:191], v[112:127]
    ds_read_b64_tr_b16 v[32:33], v152 offset:20736
    ds_read_b64_tr_b16 v[34:35], v152 offset:22016
    buffer_load_dwordx4 v9, s[44:47], s67 offen offset:3072  lds
    s_waitcnt lgkmcnt(11)
    v_mfma_f32_32x32x16_bf16 v[128:143], v[52:55], v[188:191], v[128:143]
    s_waitcnt lgkmcnt(8)
    v_mfma_f32_32x32x16_bf16 v[64:79], v[16:19], v[184:187], v[64:79]
    ds_read_b128 v[188:191], v159 offset:0
    ds_read_b64_tr_b16 v[36:37], v154 offset:20480
    ds_read_b64_tr_b16 v[38:39], v154 offset:21760
    s_add_u32 s67, s67, s68
    s_cmp_ge_u32 s67, s69
    s_cselect_b32 s67, s70, s67
    s_waitcnt lgkmcnt(9)
    v_mfma_f32_32x32x16_bf16 v[80:95], v[20:23], v[184:187], v[80:95]
    ds_read_b64_tr_b16 v[40:41], v154 offset:20544
    ds_read_b64_tr_b16 v[42:43], v154 offset:21824
    s_waitcnt lgkmcnt(9)
    v_mfma_f32_32x32x16_bf16 v[96:111], v[24:27], v[184:187], v[96:111]
    ds_read_b64_tr_b16 v[44:45], v154 offset:20608
    ds_read_b64_tr_b16 v[46:47], v154 offset:21888
    s_add_u32 m0, s39, 32768
    s_nop 0
    buffer_load_dwordx4 v10, s[48:51], s74 offen offset:0  lds
    v_mfma_f32_16x16x32_bf16 v[172:175], v[160:163], v[24:27], v[172:175]
    ds_read_b64_tr_b16 v[48:49], v154 offset:20672
    s_waitcnt lgkmcnt(10)
    v_mfma_f32_32x32x16_bf16 v[112:127], v[28:31], v[184:187], v[112:127]
    ds_read_b64_tr_b16 v[50:51], v154 offset:21952
    ds_read_b64_tr_b16 v[52:53], v154 offset:20736
    ds_read_b64_tr_b16 v[54:55], v154 offset:22016
    buffer_load_dwordx4 v11, s[48:51], s74 offen offset:1024  lds
    s_waitcnt lgkmcnt(11)
    v_mfma_f32_32x32x16_bf16 v[128:143], v[32:35], v[184:187], v[128:143]
    buffer_load_dwordx4 v12, s[48:51], s74 offen offset:2048  lds
    s_waitcnt lgkmcnt(8)
    v_mfma_f32_32x32x16_bf16 v[64:79], v[36:39], v[188:191], v[64:79]
    s_waitcnt vmcnt(8)
    s_barrier
    ds_read_b128 v[184:187], v156 offset:16384
    ds_read_b64_tr_b16 v[16:17], v148 offset:40960
    s_waitcnt lgkmcnt(8)
    v_mfma_f32_32x32x16_bf16 v[80:95], v[40:43], v[188:191], v[80:95]
    ds_read_b64_tr_b16 v[18:19], v148 offset:42240
    ds_read_b64_tr_b16 v[20:21], v148 offset:41024
    ds_read_b64_tr_b16 v[22:23], v148 offset:42304
    buffer_load_dwordx4 v13, s[48:51], s74 offen offset:3072  lds
    s_waitcnt lgkmcnt(9)
    v_mfma_f32_32x32x16_bf16 v[96:111], v[44:47], v[188:191], v[96:111]
    ds_read_b64_tr_b16 v[24:25], v148 offset:41088
    ds_read_b64_tr_b16 v[26:27], v148 offset:42368
    s_add_u32 s74, s74, 128
    s_waitcnt lgkmcnt(9)
    v_mfma_f32_32x32x16_bf16 v[112:127], v[48:51], v[188:191], v[112:127]
    ds_read_b64_tr_b16 v[28:29], v148 offset:41152
    ds_read_b64_tr_b16 v[30:31], v148 offset:42432
    s_cmp_ge_u32 s74, s75
    s_cselect_b32 s74, s76, s74
    v_mfma_f32_16x16x32_bf16 v[176:179], v[160:163], v[48:51], v[176:179]
    ds_read_b64_tr_b16 v[32:33], v148 offset:41216
    ds_read_b64_tr_b16 v[34:35], v148 offset:42496
    s_waitcnt lgkmcnt(11)
    v_mfma_f32_32x32x16_bf16 v[128:143], v[52:55], v[188:191], v[128:143]
    s_mov_b32 s95, 22085632
    buffer_load_dwordx4 v[144:147], v4, s[40:43], s95 offen sc1
    s_waitcnt lgkmcnt(8)
    v_mfma_f32_32x32x16_bf16 v[64:79], v[16:19], v[184:187], v[64:79]
    ds_read_b128 v[188:191], v157 offset:16384
    ds_read_b64_tr_b16 v[36:37], v150 offset:40960
    s_add_u32 m0, s66, 81920
    v_mfma_f32_16x16x32_bf16 v[164:167], v[160:163], v[16:19], v[164:167]
    ds_read_b64_tr_b16 v[38:39], v150 offset:42240
    s_waitcnt lgkmcnt(9)
    v_mfma_f32_32x32x16_bf16 v[80:95], v[20:23], v[184:187], v[80:95]
    ds_read_b64_tr_b16 v[40:41], v150 offset:41024
    ds_read_b64_tr_b16 v[42:43], v150 offset:42304
    ds_read_b64_tr_b16 v[44:45], v150 offset:41088
    buffer_load_dwordx4 v5, s[44:47], s67 offen offset:0  lds
    s_waitcnt lgkmcnt(10)
    v_mfma_f32_32x32x16_bf16 v[96:111], v[24:27], v[184:187], v[96:111]
    ds_read_b64_tr_b16 v[46:47], v150 offset:42368
    ds_read_b64_tr_b16 v[48:49], v150 offset:41152
    buffer_load_dwordx4 v6, s[44:47], s67 offen offset:1024  lds
    s_waitcnt lgkmcnt(10)
    v_mfma_f32_32x32x16_bf16 v[112:127], v[28:31], v[184:187], v[112:127]
    ds_read_b64_tr_b16 v[50:51], v150 offset:42432
    ds_read_b64_tr_b16 v[52:53], v150 offset:41216
    s_waitcnt lgkmcnt(10)
    v_mfma_f32_32x32x16_bf16 v[128:143], v[32:35], v[184:187], v[128:143]
    ds_read_b64_tr_b16 v[54:55], v150 offset:42496
    buffer_load_dwordx4 v7, s[44:47], s67 offen offset:2048  lds
    v_mfma_f32_16x16x32_bf16 v[180:183], v[160:163], v[32:35], v[180:183]
    s_waitcnt lgkmcnt(8)
    v_mfma_f32_32x32x16_bf16 v[64:79], v[36:39], v[188:191], v[64:79]
    ds_read_b128 v[184:187], v158 offset:16384
    ds_read_b64_tr_b16 v[16:17], v152 offset:40960
    ds_read_b64_tr_b16 v[18:19], v152 offset:42240
    buffer_load_dwordx4 v8, s[44:47], s67 offen offset:3072  lds
    s_waitcnt lgkmcnt(9)
    v_mfma_f32_32x32x16_bf16 v[80:95], v[40:43], v[188:191], v[80:95]
    ds_read_b64_tr_b16 v[20:21], v152 offset:41024
    ds_read_b64_tr_b16 v[22:23], v152 offset:42304
    v_mfma_f32_16x16x32_bf16 v[168:171], v[160:163], v[40:43], v[168:171]
    ds_read_b64_tr_b16 v[24:25], v152 offset:41088
    s_add_u32 m0, s66, 82944
    s_waitcnt lgkmcnt(10)
    v_mfma_f32_32x32x16_bf16 v[96:111], v[44:47], v[188:191], v[96:111]
    ds_read_b64_tr_b16 v[26:27], v152 offset:42368
    ds_read_b64_tr_b16 v[28:29], v152 offset:41152
    ds_read_b64_tr_b16 v[30:31], v152 offset:42432
    buffer_load_dwordx4 v9, s[44:47], s67 offen offset:3072  lds
    s_waitcnt lgkmcnt(11)
    v_mfma_f32_32x32x16_bf16 v[112:127], v[48:51], v[188:191], v[112:127]
    ds_read_b64_tr_b16 v[32:33], v152 offset:41216
    ds_read_b64_tr_b16 v[34:35], v152 offset:42496
    s_add_u32 s67, s67, s68
    s_waitcnt lgkmcnt(11)
    v_mfma_f32_32x32x16_bf16 v[128:143], v[52:55], v[188:191], v[128:143]
    s_cmp_ge_u32 s67, s69
    s_cselect_b32 s67, s70, s67
    s_waitcnt lgkmcnt(8)
    v_mfma_f32_32x32x16_bf16 v[64:79], v[16:19], v[184:187], v[64:79]
    ds_read_b128 v[188:191], v159 offset:16384
    ds_read_b64_tr_b16 v[36:37], v154 offset:40960
    ds_read_b64_tr_b16 v[38:39], v154 offset:42240
    s_waitcnt lgkmcnt(9)
    v_mfma_f32_32x32x16_bf16 v[80:95], v[20:23], v[184:187], v[80:95]
    ds_read_b64_tr_b16 v[40:41], v154 offset:41024
    ds_read_b64_tr_b16 v[42:43], v154 offset:42304
    s_add_u32 m0, s39, 0
    s_waitcnt lgkmcnt(9)
    v_mfma_f32_32x32x16_bf16 v[96:111], v[24:27], v[184:187], v[96:111]
    ds_read_b64_tr_b16 v[44:45], v154 offset:41088
    ds_read_b64_tr_b16 v[46:47], v154 offset:42368
    buffer_load_dwordx4 v10, s[48:51], s74 offen offset:0  lds
    v_mfma_f32_16x16x32_bf16 v[172:175], v[160:163], v[24:27], v[172:175]
    ds_read_b64_tr_b16 v[48:49], v154 offset:41152
    s_waitcnt lgkmcnt(10)
    v_mfma_f32_32x32x16_bf16 v[112:127], v[28:31], v[184:187], v[112:127]
    ds_read_b64_tr_b16 v[50:51], v154 offset:42432
    ds_read_b64_tr_b16 v[52:53], v154 offset:41216
    ds_read_b64_tr_b16 v[54:55], v154 offset:42496
    buffer_load_dwordx4 v11, s[48:51], s74 offen offset:1024  lds
    s_waitcnt lgkmcnt(11)
    v_mfma_f32_32x32x16_bf16 v[128:143], v[32:35], v[184:187], v[128:143]
    buffer_load_dwordx4 v12, s[48:51], s74 offen offset:2048  lds
    s_waitcnt lgkmcnt(8)
    v_mfma_f32_32x32x16_bf16 v[64:79], v[36:39], v[188:191], v[64:79]
    s_waitcnt vmcnt(9)
    s_barrier
    ds_read_b128 v[184:187], v156 offset:32768
    ds_read_b64_tr_b16 v[16:17], v149 offset:0
    s_waitcnt lgkmcnt(8)
    v_mfma_f32_32x32x16_bf16 v[80:95], v[40:43], v[188:191], v[80:95]
    ds_read_b64_tr_b16 v[18:19], v149 offset:1280
    ds_read_b64_tr_b16 v[20:21], v149 offset:64
    ds_read_b64_tr_b16 v[22:23], v149 offset:1344
    buffer_load_dwordx4 v13, s[48:51], s74 offen offset:3072  lds
    s_waitcnt lgkmcnt(9)
    v_mfma_f32_32x32x16_bf16 v[96:111], v[44:47], v[188:191], v[96:111]
    ds_read_b64_tr_b16 v[24:25], v149 offset:128
    ds_read_b64_tr_b16 v[26:27], v149 offset:1408
    s_waitcnt lgkmcnt(9)
    v_mfma_f32_32x32x16_bf16 v[112:127], v[48:51], v[188:191], v[112:127]
    ds_read_b64_tr_b16 v[28:29], v149 offset:192
    ds_read_b64_tr_b16 v[30:31], v149 offset:1472
    s_add_u32 s74, s74, 128
    v_mfma_f32_16x16x32_bf16 v[176:179], v[160:163], v[48:51], v[176:179]
    ds_read_b64_tr_b16 v[32:33], v149 offset:256
    ds_read_b64_tr_b16 v[34:35], v149 offset:1536
    s_waitcnt lgkmcnt(11)
    v_mfma_f32_32x32x16_bf16 v[128:143], v[52:55], v[188:191], v[128:143]
    s_cmp_ge_u32 s74, s75
    s_cselect_b32 s74, s76, s74
    s_waitcnt lgkmcnt(8)
    v_mfma_f32_32x32x16_bf16 v[64:79], v[16:19], v[184:187], v[64:79]
    ds_read_b128 v[188:191], v157 offset:32768
    ds_read_b64_tr_b16 v[36:37], v151 offset:0
    v_mfma_f32_16x16x32_bf16 v[164:167], v[160:163], v[16:19], v[164:167]
    ds_read_b64_tr_b16 v[38:39], v151 offset:1280
    s_waitcnt lgkmcnt(9)
    v_mfma_f32_32x32x16_bf16 v[80:95], v[20:23], v[184:187], v[80:95]
    ds_read_b64_tr_b16 v[40:41], v151 offset:64
    ds_read_b64_tr_b16 v[42:43], v151 offset:1344
    ds_read_b64_tr_b16 v[44:45], v151 offset:128
    s_waitcnt lgkmcnt(10)
    v_mfma_f32_32x32x16_bf16 v[96:111], v[24:27], v[184:187], v[96:111]
    ds_read_b64_tr_b16 v[46:47], v151 offset:1408
    ds_read_b64_tr_b16 v[48:49], v151 offset:192
    s_waitcnt lgkmcnt(10)
    v_mfma_f32_32x32x16_bf16 v[112:127], v[28:31], v[184:187], v[112:127]
    ds_read_b64_tr_b16 v[50:51], v151 offset:1472
    ds_read_b64_tr_b16 v[52:53], v151 offset:256
    s_waitcnt lgkmcnt(10)
    v_mfma_f32_32x32x16_bf16 v[128:143], v[32:35], v[184:187], v[128:143]
    ds_read_b64_tr_b16 v[54:55], v151 offset:1536
    v_mfma_f32_16x16x32_bf16 v[180:183], v[160:163], v[32:35], v[180:183]
    s_waitcnt vmcnt(9)
    v_xor_b32 v144, v144, v15
    v_xor_b32 v145, v145, v15
    v_xor_b32 v146, v146, v15
    v_xor_b32 v147, v147, v15
    v_or3_b32 v144, v144, v145, v146
    v_or_b32 v144, v144, v147
    v_cmp_ne_u32 vcc, 0, v144
    s_cbranch_vccz L_gd_5
    s_mov_b32 s94, 0
    s_mov_b32 s95, 22085632
L_gl_6:
    s_sleep 16
    buffer_load_dwordx4 v[144:147], v4, s[40:43], s95 offen sc1
    s_add_u32 s94, s94, 1
    s_waitcnt vmcnt(0)
    v_xor_b32 v144, v144, v15
    v_xor_b32 v145, v145, v15
    v_xor_b32 v146, v146, v15
    v_xor_b32 v147, v147, v15
    v_or3_b32 v144, v144, v145, v146
    v_or_b32 v144, v144, v147
    v_cmp_ne_u32 vcc, 0, v144
    s_cbranch_vccz L_gd_5
    s_cmp_lt_u32 s94, 200000
    s_cbranch_scc1 L_gl_6
L_gd_5:
    v_and_b32 v144, 31, v0
    v_add_u32 v144, s3, v144
    s_waitcnt lgkmcnt(8)
    v_mfma_f32_32x32x16_bf16 v[64:79], v[36:39], v[188:191], v[64:79]
    ds_read_b128 v[184:187], v158 offset:32768
    ds_read_b64_tr_b16 v[16:17], v153 offset:0
    ds_read_b64_tr_b16 v[18:19], v153 offset:1280
    v_cmp_gt_u32 vcc, 2048, v144
    v_lshlrev_b32 v144, 3, v144
    s_nop 0
    v_cndmask_b32 v144, v197, v144, vcc
    s_waitcnt lgkmcnt(9)
    v_mfma_f32_32x32x16_bf16 v[80:95], v[40:43], v[188:191], v[80:95]
    ds_read_b64_tr_b16 v[20:21], v153 offset:64
    ds_read_b64_tr_b16 v[22:23], v153 offset:1344
    s_mov_b32 s82, 21757952
    buffer_load_dwordx2 v[60:61], v144, s[40:43], s82 offen sc1
    s_lshl_b32 s82, s80, 1
    s_add_u32 s82, s82, s77
    v_mfma_f32_16x16x32_bf16 v[168:171], v[160:163], v[40:43], v[168:171]
    ds_read_b64_tr_b16 v[24:25], v153 offset:128
    s_lshl_b32 s82, s82, 7
    s_waitcnt lgkmcnt(10)
    v_mfma_f32_32x32x16_bf16 v[96:111], v[44:47], v[188:191], v[96:111]
    ds_read_b64_tr_b16 v[26:27], v153 offset:1408
    ds_read_b64_tr_b16 v[28:29], v153 offset:192
    ds_read_b64_tr_b16 v[30:31], v153 offset:1472
    s_add_u32 s82, s82, 21757952
    v_and_b32 v144, 15, v0
    v_lshlrev_b32 v144, 3, v144
    s_waitcnt lgkmcnt(11)
    v_mfma_f32_32x32x16_bf16 v[112:127], v[48:51], v[188:191], v[112:127]
    ds_read_b64_tr_b16 v[32:33], v153 offset:256
    ds_read_b64_tr_b16 v[34:35], v153 offset:1536
    buffer_load_dwordx2 v[222:223], v144, s[40:43], s82 offen sc1
    s_waitcnt lgkmcnt(11)
    v_mfma_f32_32x32x16_bf16 v[128:143], v[52:55], v[188:191], v[128:143]
    s_add_u32 s82, s65, s60
    s_cmp_lg_u32 s82, 0
    s_cbranch_scc1 L_gen_7
    s_mov_b32 s82, 22151168
    s_mov_b64 exec, 1
    buffer_store_dword v15, v4, s[40:43], s82 offen sc1
    s_mov_b64 exec, -1
L_gen_7:
    s_mov_b32 s44, s26
    s_mov_b32 s45, s27
    s_waitcnt lgkmcnt(8)
    v_mfma_f32_32x32x16_bf16 v[64:79], v[16:19], v[184:187], v[64:79]
    ds_read_b128 v[188:191], v159 offset:32768
    ds_read_b64_tr_b16 v[36:37], v155 offset:0
    ds_read_b64_tr_b16 v[38:39], v155 offset:1280
    s_mov_b32 s46, 819200
    s_mov_b32 s47, 0x20000
    s_mul_i32 s82, s77, 320
    s_waitcnt lgkmcnt(9)
    v_mfma_f32_32x32x16_bf16 v[80:95], v[20:23], v[184:187], v[80:95]
    ds_read_b64_tr_b16 v[40:41], v155 offset:64
    ds_read_b64_tr_b16 v[42:43], v155 offset:1344
    s_lshl_b32 s83, s78, 5
    s_add_u32 s82, s82, s83
    s_mul_i32 s82, s82, 1280
    s_mul_i32 s83, s81, 160
    s_waitcnt lgkmcnt(9)
    v_mfma_f32_32x32x16_bf16 v[96:111], v[24:27], v[184:187], v[96:111]
    ds_read_b64_tr_b16 v[44:45], v155 offset:128
    ds_read_b64_tr_b16 v[46:47], v155 offset:1408
    s_add_u32 s82, s82, s83
    s_mov_b32 s68, 81920
    s_mov_b32 s70, s82
    s_add_u32 s69, s82, 409600
    v_mfma_f32_16x16x32_bf16 v[172:175], v[160:163], v[24:27], v[172:175]
    ds_read_b64_tr_b16 v[48:49], v155 offset:192
    s_mul_i32 s67, s13, 81920
    s_waitcnt lgkmcnt(10)
    v_mfma_f32_32x32x16_bf16 v[112:127], v[28:31], v[184:187], v[112:127]
    ds_read_b64_tr_b16 v[50:51], v155 offset:1472
    ds_read_b64_tr_b16 v[52:53], v155 offset:256
    ds_read_b64_tr_b16 v[54:55], v155 offset:1536
    s_add_u32 s67, s67, s82
    buffer_load_dwordx4 a[120:123], v240, s[56:59], s101 offen
    s_waitcnt lgkmcnt(11)
    v_mfma_f32_32x32x16_bf16 v[128:143], v[32:35], v[184:187], v[128:143]
    buffer_load_dwordx4 a[124:127], v241, s[56:59], s101 offen
    buffer_load_dwordx4 a[128:131], v242, s[56:59], s101 offen
    s_waitcnt lgkmcnt(8)
    v_mfma_f32_32x32x16_bf16 v[64:79], v[36:39], v[188:191], v[64:79]
    s_waitcnt vmcnt(5)
    s_barrier
    ds_read_b128 v[184:187], v156 offset:0
    ds_read_b64_tr_b16 v[16:17], v149 offset:20480
    s_waitcnt lgkmcnt(8)
    v_mfma_f32_32x32x16_bf16 v[80:95], v[40:43], v[188:191], v[80:95]
    ds_read_b64_tr_b16 v[18:19], v149 offset:21760
    ds_read_b64_tr_b16 v[20:21], v149 offset:20544
    ds_read_b64_tr_b16 v[22:23], v149 offset:21824
    buffer_load_dwordx4 a[132:135], v243, s[56:59], s101 offen
    s_waitcnt lgkmcnt(9)
    v_mfma_f32_32x32x16_bf16 v[96:111], v[44:47], v[188:191], v[96:111]
    ds_read_b64_tr_b16 v[24:25], v149 offset:20608
    ds_read_b64_tr_b16 v[26:27], v149 offset:21888
    buffer_load_dwordx4 a[136:139], v244, s[56:59], s101 offen
    buffer_load_dwordx4 a[140:143], v240, s[56:59], s23 offen
    s_waitcnt lgkmcnt(9)
    v_mfma_f32_32x32x16_bf16 v[112:127], v[48:51], v[188:191], v[112:127]
    ds_read_b64_tr_b16 v[28:29], v149 offset:20672
    ds_read_b64_tr_b16 v[30:31], v149 offset:21952
    buffer_load_dwordx4 a[144:147], v241, s[56:59], s23 offen
    buffer_load_dwordx4 a[148:151], v242, s[56:59], s23 offen
    v_mfma_f32_16x16x32_bf16 v[176:179], v[160:163], v[48:51], v[176:179]
    ds_read_b64_tr_b16 v[32:33], v149 offset:20736
    ds_read_b64_tr_b16 v[34:35], v149 offset:22016
    s_waitcnt lgkmcnt(11)
    v_mfma_f32_32x32x16_bf16 v[128:143], v[52:55], v[188:191], v[128:143]
    buffer_load_dwordx4 a[152:155], v243, s[56:59], s23 offen
    buffer_load_dwordx4 a[156:159], v244, s[56:59], s23 offen
    s_waitcnt lgkmcnt(8)
    v_mfma_f32_32x32x16_bf16 v[64:79], v[16:19], v[184:187], v[64:79]
    ds_read_b128 v[188:191], v157 offset:0
    ds_read_b64_tr_b16 v[36:37], v151 offset:20480
    s_add_u32 m0, s66, 0
    s_nop 0
    buffer_load_dwordx4 v248, s[44:47], s67 offen offset:0  lds
    v_mfma_f32_16x16x32_bf16 v[164:167], v[160:163], v[16:19], v[164:167]
    ds_read_b64_tr_b16 v[38:39], v151 offset:21760
    s_waitcnt lgkmcnt(9)
    v_mfma_f32_32x32x16_bf16 v[80:95], v[20:23], v[184:187], v[80:95]
    ds_read_b64_tr_b16 v[40:41], v151 offset:20544
    ds_read_b64_tr_b16 v[42:43], v151 offset:21824
    ds_read_b64_tr_b16 v[44:45], v151 offset:20608
    buffer_load_dwordx4 v249, s[44:47], s67 offen offset:1024  lds
    s_waitcnt lgkmcnt(10)
    v_mfma_f32_32x32x16_bf16 v[96:111], v[24:27], v[184:187], v[96:111]
    ds_read_b64_tr_b16 v[46:47], v151 offset:21888
    ds_read_b64_tr_b16 v[48:49], v151 offset:20672
    buffer_load_dwordx4 v250, s[44:47], s67 offen offset:2048  lds
    buffer_load_dwordx4 v251, s[44:47], s67 offen offset:3072  lds
    s_waitcnt lgkmcnt(10)
    v_mfma_f32_32x32x16_bf16 v[112:127], v[28:31], v[184:187], v[112:127]
    ds_read_b64_tr_b16 v[50:51], v151 offset:21952
    ds_read_b64_tr_b16 v[52:53], v151 offset:20736
    s_add_u32 m0, s66, 1024
    s_waitcnt lgkmcnt(10)
    v_mfma_f32_32x32x16_bf16 v[128:143], v[32:35], v[184:187], v[128:143]
    ds_read_b64_tr_b16 v[54:55], v151 offset:22016
    buffer_load_dwordx4 v252, s[44:47], s67 offen offset:3072  lds
    v_mfma_f32_16x16x32_bf16 v[180:183], v[160:163], v[32:35], v[180:183]
    s_add_u32 s67, s67, s68
    s_waitcnt lgkmcnt(8)
    v_mfma_f32_32x32x16_bf16 v[64:79], v[36:39], v[188:191], v[64:79]
    ds_read_b128 v[184:187], v158 offset:0
    ds_read_b64_tr_b16 v[16:17], v153 offset:20480
    ds_read_b64_tr_b16 v[18:19], v153 offset:21760
    s_cmp_ge_u32 s67, s69
    s_cselect_b32 s67, s70, s67
    s_waitcnt lgkmcnt(9)
    v_mfma_f32_32x32x16_bf16 v[80:95], v[40:43], v[188:191], v[80:95]
    ds_read_b64_tr_b16 v[20:21], v153 offset:20544
    ds_read_b64_tr_b16 v[22:23], v153 offset:21824
    v_lshrrev_b32 v56, 4, v0
    v_lshlrev_b32 v56, 9, v56
    v_mfma_f32_16x16x32_bf16 v[168:171], v[160:163], v[40:43], v[168:171]
    ds_read_b64_tr_b16 v[24:25], v153 offset:20608
    v_and_b32 v57, 15, v0
    s_waitcnt lgkmcnt(10)
    v_mfma_f32_32x32x16_bf16 v[96:111], v[44:47], v[188:191], v[96:111]
    ds_read_b64_tr_b16 v[26:27], v153 offset:21888
    ds_read_b64_tr_b16 v[28:29], v153 offset:20672
    ds_read_b64_tr_b16 v[30:31], v153 offset:21952
    v_lshlrev_b32 v57, 4, v57
    s_lshl_b32 s82, s77, 8
    v_add_u32 v57, s82, v57
    s_waitcnt lgkmcnt(11)
    v_mfma_f32_32x32x16_bf16 v[112:127], v[48:51], v[188:191], v[112:127]
    ds_read_b64_tr_b16 v[32:33], v153 offset:20736
    ds_read_b64_tr_b16 v[34:35], v153 offset:22016
    v_add_u32 v10, v56, v57
    v_xor_b32 v11, 256, v10
    v_and_b32 v56, 512, v56
    s_waitcnt lgkmcnt(11)
    v_mfma_f32_32x32x16_bf16 v[128:143], v[52:55], v[188:191], v[128:143]
    v_add_u32 v57, v56, v57
    v_lshrrev_b32 v56, 5, v0
    s_waitcnt lgkmcnt(8)
    v_mfma_f32_32x32x16_bf16 v[64:79], v[16:19], v[184:187], v[64:79]
    ds_read_b128 v[188:191], v159 offset:0
    ds_read_b64_tr_b16 v[36:37], v155 offset:20480
    ds_read_b64_tr_b16 v[38:39], v155 offset:21760
    v_lshl_add_u32 v12, v56, 3, v57
    s_mul_i32 s82, s77, 20480
    s_waitcnt lgkmcnt(9)
    v_mfma_f32_32x32x16_bf16 v[80:95], v[20:23], v[184:187], v[80:95]
    ds_read_b64_tr_b16 v[40:41], v155 offset:20544
    ds_read_b64_tr_b16 v[42:43], v155 offset:21824
    s_mul_i32 s83, s80, 40960
    s_add_u32 s82, s82, s83
    s_waitcnt lgkmcnt(9)
    v_mfma_f32_32x32x16_bf16 v[96:111], v[24:27], v[184:187], v[96:111]
    ds_read_b64_tr_b16 v[44:45], v155 offset:20608
    ds_read_b64_tr_b16 v[46:47], v155 offset:21888
    s_add_u32 s82, s82, 2621440
    s_mov_b32 s76, s82
    v_mfma_f32_16x16x32_bf16 v[172:175], v[160:163], v[24:27], v[172:175]
    ds_read_b64_tr_b16 v[48:49], v155 offset:20672
    s_add_u32 s75, s82, 20480
    s_waitcnt lgkmcnt(10)
    v_mfma_f32_32x32x16_bf16 v[112:127], v[28:31], v[184:187], v[112:127]
    ds_read_b64_tr_b16 v[50:51], v155 offset:21952
    ds_read_b64_tr_b16 v[52:53], v155 offset:20736
    ds_read_b64_tr_b16 v[54:55], v155 offset:22016
    s_mul_i32 s74, s13, 4096
    s_add_u32 s74, s74, s82
    v_and_b32 v59, 31, v0
    s_waitcnt lgkmcnt(11)
    v_mfma_f32_32x32x16_bf16 v[128:143], v[32:35], v[184:187], v[128:143]
    v_lshlrev_b32 v59, 4, v59
    v_add_u32 v59, 161280, v59
    s_lshl_b32 s82, s60, 2
    s_waitcnt lgkmcnt(8)
    v_mfma_f32_32x32x16_bf16 v[64:79], v[36:39], v[188:191], v[64:79]
    v_add_u32 v58, s82, v59
    s_waitcnt vmcnt(16)
    v_cvt_pk_bf16_f32 v144, -v60, -v60
    s_waitcnt lgkmcnt(6)
    v_mfma_f32_32x32x16_bf16 v[80:95], v[40:43], v[188:191], v[80:95]
    v_lshlrev_b32 v56, 16, v144
    v_add_f32 v56, v60, v56
    s_waitcnt lgkmcnt(4)
    v_mfma_f32_32x32x16_bf16 v[96:111], v[44:47], v[188:191], v[96:111]
    v_cvt_pk_bf16_f32 v56, -v56, -v56
    v_cmp_gt_u32 vcc, 32, v0
    s_waitcnt lgkmcnt(2)
    v_mfma_f32_32x32x16_bf16 v[112:127], v[48:51], v[188:191], v[112:127]
    v_cndmask_b32 v144, v56, v144, vcc
    v_mov_b32 v145, v144
    v_mfma_f32_16x16x32_bf16 v[176:179], v[160:163], v[48:51], v[176:179]
    v_mov_b32 v146, v144
    v_mov_b32 v147, v144
    s_waitcnt lgkmcnt(0)
    v_mfma_f32_32x32x16_bf16 v[128:143], v[52:55], v[188:191], v[128:143]
    v_max_f32 v60, 0x0da24260, v61
    s_mul_i32 s39, s79, 40960
    v_cvt_pk_bf16_f32 v56, v164, v164
    v_lshlrev_b32 v56, 16, v56
    v_sub_f32 v56, v164, v56
    v_cvt_pk_bf16_f32 v20, v164, v56
    ds_write_b32 v58, v20 offset:0
    v_cvt_pk_bf16_f32 v56, v180, v180
    v_lshlrev_b32 v56, 16, v56
    v_sub_f32 v56, v180, v56
    v_cvt_pk_bf16_f32 v24, v180, v56
    ds_write_b32 v58, v24 offset:2048
    v_cvt_pk_bf16_f32 v56, v168, v168
    v_lshlrev_b32 v56, 16, v56
    v_sub_f32 v56, v168, v56
    v_cvt_pk_bf16_f32 v21, v168, v56
    ds_write_b32 v58, v21 offset:512
    v_cvt_pk_bf16_f32 v56, v172, v172
    v_lshlrev_b32 v56, 16, v56
    v_sub_f32 v56, v172, v56
    v_cvt_pk_bf16_f32 v22, v172, v56
    ds_write_b32 v58, v22 offset:1024
    v_cvt_pk_bf16_f32 v56, v176, v176
    v_lshlrev_b32 v56, 16, v56
    v_sub_f32 v56, v176, v56
    v_cvt_pk_bf16_f32 v23, v176, v56
    ds_write_b32 v58, v23 offset:1536
    s_waitcnt lgkmcnt(0)
    s_barrier
    ds_read_b128 v[28:31], v59 offset:0
    ds_read_b128 v[32:35], v59 offset:512
    ds_read_b128 v[36:39], v59 offset:1024
    ds_read_b128 v[40:43], v59 offset:1536
    ds_read_b128 v[44:47], v59 offset:2048
    s_waitcnt lgkmcnt(4)
    v_mfma_f32_32x32x16_bf16 v[64:79], v[28:31], v[144:147], v[64:79]
    s_waitcnt lgkmcnt(3)
    v_mfma_f32_32x32x16_bf16 v[80:95], v[32:35], v[144:147], v[80:95]
    s_waitcnt lgkmcnt(2)
    v_mfma_f32_32x32x16_bf16 v[96:111], v[36:39], v[144:147], v[96:111]
    s_waitcnt lgkmcnt(1)
    v_mfma_f32_32x32x16_bf16 v[112:127], v[40:43], v[144:147], v[112:127]
    s_waitcnt lgkmcnt(0)
    v_mfma_f32_32x32x16_bf16 v[128:143], v[44:47], v[144:147], v[128:143]
    s_cmp_lt_u32 s62, 12
    s_cbranch_scc1 L_p1_qkv
    v_mul_f32 v56, v60, v60
    v_mov_b32 v57, 0x3f800054
    v_fmac_f32 v57, 0xb727c5ac, v56
    v_rsq_f32 v57, v57
    s_nop 0
    v_mul_f32 v60, v60, v57
    v_mul_f32 v58, v60, v60
    v_mul_f32 v58, v58, v60
    v_mul_f32 v58, 0xbdd2d3e8, v58
    v_rcp_f32 v62, v60
    v_mul_f32 v56, 0xc0135761, v60
    s_sub_u32 s91, s62, 12
    s_mul_i32 s91, s91, 10240
    s_add_u32 s91, s91, s39
    s_add_u32 s91, s91, 2621440
    v_pk_mul_f32 v[160:161], v[64:65], v[64:65]
    v_pk_mul_f32 v[162:163], v[66:67], v[66:67]
    v_pk_mul_f32 v[164:165], v[68:69], v[68:69]
    v_pk_mul_f32 v[166:167], v[70:71], v[70:71]
    v_pk_mul_f32 v[168:169], v[72:73], v[72:73]
    v_pk_mul_f32 v[170:171], v[74:75], v[74:75]
    v_pk_mul_f32 v[172:173], v[76:77], v[76:77]
    v_pk_mul_f32 v[174:175], v[78:79], v[78:79]
    v_pk_fma_f32 v[160:161], v[160:161], v[58:59], v[56:57] op_sel_hi:[1,0,0]
    v_pk_fma_f32 v[162:163], v[162:163], v[58:59], v[56:57] op_sel_hi:[1,0,0]
    v_pk_fma_f32 v[164:165], v[164:165], v[58:59], v[56:57] op_sel_hi:[1,0,0]
    v_pk_fma_f32 v[166:167], v[166:167], v[58:59], v[56:57] op_sel_hi:[1,0,0]
    v_pk_fma_f32 v[168:169], v[168:169], v[58:59], v[56:57] op_sel_hi:[1,0,0]
    v_pk_fma_f32 v[170:171], v[170:171], v[58:59], v[56:57] op_sel_hi:[1,0,0]
    v_pk_fma_f32 v[172:173], v[172:173], v[58:59], v[56:57] op_sel_hi:[1,0,0]
    v_pk_fma_f32 v[174:175], v[174:175], v[58:59], v[56:57] op_sel_hi:[1,0,0]
    v_pk_mul_f32 v[160:161], v[160:161], v[64:65]
    v_pk_mul_f32 v[162:163], v[162:163], v[66:67]
    v_pk_mul_f32 v[164:165], v[164:165], v[68:69]
    v_pk_mul_f32 v[166:167], v[166:167], v[70:71]
    s_add_u32 m0, s66, 20480
    s_nop 0
    buffer_load_dwordx4 v248, s[44:47], s67 offen offset:0  lds
    v_pk_mul_f32 v[168:169], v[168:169], v[72:73]
    v_pk_mul_f32 v[170:171], v[170:171], v[74:75]
    v_pk_mul_f32 v[172:173], v[172:173], v[76:77]
    v_pk_mul_f32 v[174:175], v[174:175], v[78:79]
    v_exp_f32 v160, v160
    v_exp_f32 v161, v161
    v_exp_f32 v162, v162
    v_exp_f32 v163, v163
    v_exp_f32 v164, v164
    v_exp_f32 v165, v165
    v_exp_f32 v166, v166
    v_exp_f32 v167, v167
    buffer_load_dwordx4 v249, s[44:47], s67 offen offset:1024  lds
    v_exp_f32 v168, v168
    v_exp_f32 v169, v169
    v_exp_f32 v170, v170
    v_exp_f32 v171, v171
    v_exp_f32 v172, v172
    v_exp_f32 v173, v173
    v_exp_f32 v174, v174
    v_exp_f32 v175, v175
    v_pk_fma_f32 v[160:161], v[160:161], v[62:63], v[62:63] op_sel_hi:[1,0,0]
    v_pk_fma_f32 v[162:163], v[162:163], v[62:63], v[62:63] op_sel_hi:[1,0,0]
    v_pk_fma_f32 v[164:165], v[164:165], v[62:63], v[62:63] op_sel_hi:[1,0,0]
    v_pk_fma_f32 v[166:167], v[166:167], v[62:63], v[62:63] op_sel_hi:[1,0,0]
    buffer_load_dwordx4 v250, s[44:47], s67 offen offset:2048  lds
    v_pk_fma_f32 v[168:169], v[168:169], v[62:63], v[62:63] op_sel_hi:[1,0,0]
    v_pk_fma_f32 v[170:171], v[170:171], v[62:63], v[62:63] op_sel_hi:[1,0,0]
    v_pk_fma_f32 v[172:173], v[172:173], v[62:63], v[62:63] op_sel_hi:[1,0,0]
    v_pk_fma_f32 v[174:175], v[174:175], v[62:63], v[62:63] op_sel_hi:[1,0,0]
    v_rcp_f32 v160, v160
    v_rcp_f32 v161, v161
    v_rcp_f32 v162, v162
    v_rcp_f32 v163, v163
    v_rcp_f32 v164, v164
    v_rcp_f32 v165, v165
    v_rcp_f32 v166, v166
    v_rcp_f32 v167, v167
    buffer_load_dwordx4 v251, s[44:47], s67 offen offset:3072  lds
    v_rcp_f32 v168, v168
    v_rcp_f32 v169, v169
    v_rcp_f32 v170, v170
    v_rcp_f32 v171, v171
    v_rcp_f32 v172, v172
    v_rcp_f32 v173, v173
    v_rcp_f32 v174, v174
    v_rcp_f32 v175, v175
    v_pk_mul_f32 v[64:65], v[64:65], v[160:161]
    v_pk_mul_f32 v[66:67], v[66:67], v[162:163]
    v_pk_mul_f32 v[68:69], v[68:69], v[164:165]
    v_pk_mul_f32 v[70:71], v[70:71], v[166:167]
    s_add_u32 m0, s66, 21504
    s_nop 0
    buffer_load_dwordx4 v252, s[44:47], s67 offen offset:3072  lds
    v_pk_mul_f32 v[72:73], v[72:73], v[168:169]
    v_pk_mul_f32 v[74:75], v[74:75], v[170:171]
    v_pk_mul_f32 v[76:77], v[76:77], v[172:173]
    v_pk_mul_f32 v[78:79], v[78:79], v[174:175]
    v_cvt_pk_bf16_f32 v24, v64, v65
    v_cvt_pk_bf16_f32 v25, v66, v67
    v_cvt_pk_bf16_f32 v26, v68, v69
    v_cvt_pk_bf16_f32 v27, v70, v71
    v_cvt_pk_bf16_f32 v28, v72, v73
    v_cvt_pk_bf16_f32 v29, v74, v75
    v_cvt_pk_bf16_f32 v30, v76, v77
    v_cvt_pk_bf16_f32 v31, v78, v79
    buffer_store_dwordx4 v[24:27], v4, s[40:43], s91 offen offset:0 sc1
    buffer_store_dwordx4 v[28:31], v4, s[40:43], s91 offen offset:1024 sc1
    v_pk_mul_f32 v[160:161], v[80:81], v[80:81]
    v_pk_mul_f32 v[162:163], v[82:83], v[82:83]
    v_pk_mul_f32 v[164:165], v[84:85], v[84:85]
    v_pk_mul_f32 v[166:167], v[86:87], v[86:87]
    v_pk_mul_f32 v[168:169], v[88:89], v[88:89]
    v_pk_mul_f32 v[170:171], v[90:91], v[90:91]
    v_pk_mul_f32 v[172:173], v[92:93], v[92:93]
    v_pk_mul_f32 v[174:175], v[94:95], v[94:95]
    s_add_u32 s67, s67, s68
    s_cmp_ge_u32 s67, s69
    s_cselect_b32 s67, s70, s67
    v_pk_fma_f32 v[160:161], v[160:161], v[58:59], v[56:57] op_sel_hi:[1,0,0]
    v_pk_fma_f32 v[162:163], v[162:163], v[58:59], v[56:57] op_sel_hi:[1,0,0]
    v_pk_fma_f32 v[164:165], v[164:165], v[58:59], v[56:57] op_sel_hi:[1,0,0]
    v_pk_fma_f32 v[166:167], v[166:167], v[58:59], v[56:57] op_sel_hi:[1,0,0]
    v_pk_fma_f32 v[168:169], v[168:169], v[58:59], v[56:57] op_sel_hi:[1,0,0]
    v_pk_fma_f32 v[170:171], v[170:171], v[58:59], v[56:57] op_sel_hi:[1,0,0]
    v_pk_fma_f32 v[172:173], v[172:173], v[58:59], v[56:57] op_sel_hi:[1,0,0]
    v_pk_fma_f32 v[174:175], v[174:175], v[58:59], v[56:57] op_sel_hi:[1,0,0]
    v_pk_mul_f32 v[160:161], v[160:161], v[80:81]
    v_pk_mul_f32 v[162:163], v[162:163], v[82:83]
    v_pk_mul_f32 v[164:165], v[164:165], v[84:85]
    v_pk_mul_f32 v[166:167], v[166:167], v[86:87]
    v_pk_mul_f32 v[168:169], v[168:169], v[88:89]
    v_pk_mul_f32 v[170:171], v[170:171], v[90:91]
    v_pk_mul_f32 v[172:173], v[172:173], v[92:93]
    v_pk_mul_f32 v[174:175], v[174:175], v[94:95]
    v_exp_f32 v160, v160
    v_exp_f32 v161, v161
    s_add_u32 m0, s66, 40960
    s_nop 0
    buffer_load_dwordx4 v248, s[44:47], s67 offen offset:0  lds
    v_exp_f32 v162, v162
    v_exp_f32 v163, v163
    v_exp_f32 v164, v164
    v_exp_f32 v165, v165
    v_exp_f32 v166, v166
    v_exp_f32 v167, v167
    v_exp_f32 v168, v168
    v_exp_f32 v169, v169
    v_exp_f32 v170, v170
    v_exp_f32 v171, v171
    buffer_load_dwordx4 v249, s[44:47], s67 offen offset:1024  lds
    v_exp_f32 v172, v172
    v_exp_f32 v173, v173
    v_exp_f32 v174, v174
    v_exp_f32 v175, v175
    v_pk_fma_f32 v[160:161], v[160:161], v[62:63], v[62:63] op_sel_hi:[1,0,0]
    v_pk_fma_f32 v[162:163], v[162:163], v[62:63], v[62:63] op_sel_hi:[1,0,0]
    v_pk_fma_f32 v[164:165], v[164:165], v[62:63], v[62:63] op_sel_hi:[1,0,0]
    v_pk_fma_f32 v[166:167], v[166:167], v[62:63], v[62:63] op_sel_hi:[1,0,0]
    v_pk_fma_f32 v[168:169], v[168:169], v[62:63], v[62:63] op_sel_hi:[1,0,0]
    v_pk_fma_f32 v[170:171], v[170:171], v[62:63], v[62:63] op_sel_hi:[1,0,0]
    v_pk_fma_f32 v[172:173], v[172:173], v[62:63], v[62:63] op_sel_hi:[1,0,0]
    v_pk_fma_f32 v[174:175], v[174:175], v[62:63], v[62:63] op_sel_hi:[1,0,0]
    v_rcp_f32 v160, v160
    v_rcp_f32 v161, v161
    buffer_load_dwordx4 v250, s[44:47], s67 offen offset:2048  lds
    v_rcp_f32 v162, v162
    v_rcp_f32 v163, v163
    v_rcp_f32 v164, v164
    v_rcp_f32 v165, v165
    v_rcp_f32 v166, v166
    v_rcp_f32 v167, v167
    v_rcp_f32 v168, v168
    v_rcp_f32 v169, v169
    v_rcp_f32 v170, v170
    v_rcp_f32 v171, v171
    buffer_load_dwordx4 v251, s[44:47], s67 offen offset:3072  lds
    v_rcp_f32 v172, v172
    v_rcp_f32 v173, v173
    v_rcp_f32 v174, v174
    v_rcp_f32 v175, v175
    v_pk_mul_f32 v[80:81], v[80:81], v[160:161]
    v_pk_mul_f32 v[82:83], v[82:83], v[162:163]
    v_pk_mul_f32 v[84:85], v[84:85], v[164:165]
    v_pk_mul_f32 v[86:87], v[86:87], v[166:167]
    v_pk_mul_f32 v[88:89], v[88:89], v[168:169]
    v_pk_mul_f32 v[90:91], v[90:91], v[170:171]
    v_pk_mul_f32 v[92:93], v[92:93], v[172:173]
    v_pk_mul_f32 v[94:95], v[94:95], v[174:175]
    v_cvt_pk_bf16_f32 v32, v80, v81
    v_cvt_pk_bf16_f32 v33, v82, v83
    v_cvt_pk_bf16_f32 v34, v84, v85
    v_cvt_pk_bf16_f32 v35, v86, v87
    s_add_u32 m0, s66, 41984
    s_nop 0
    buffer_load_dwordx4 v252, s[44:47], s67 offen offset:3072  lds
    v_cvt_pk_bf16_f32 v36, v88, v89
    v_cvt_pk_bf16_f32 v37, v90, v91
    v_cvt_pk_bf16_f32 v38, v92, v93
    v_cvt_pk_bf16_f32 v39, v94, v95
    buffer_store_dwordx4 v[32:35], v4, s[40:43], s91 offen offset:2048 sc1
    buffer_store_dwordx4 v[36:39], v4, s[40:43], s91 offen offset:3072 sc1
    v_pk_mul_f32 v[160:161], v[96:97], v[96:97]
    v_pk_mul_f32 v[162:163], v[98:99], v[98:99]
    v_pk_mul_f32 v[164:165], v[100:101], v[100:101]
    v_pk_mul_f32 v[166:167], v[102:103], v[102:103]
    v_pk_mul_f32 v[168:169], v[104:105], v[104:105]
    v_pk_mul_f32 v[170:171], v[106:107], v[106:107]
    v_pk_mul_f32 v[172:173], v[108:109], v[108:109]
    v_pk_mul_f32 v[174:175], v[110:111], v[110:111]
    v_pk_fma_f32 v[160:161], v[160:161], v[58:59], v[56:57] op_sel_hi:[1,0,0]
    v_pk_fma_f32 v[162:163], v[162:163], v[58:59], v[56:57] op_sel_hi:[1,0,0]
    v_pk_fma_f32 v[164:165], v[164:165], v[58:59], v[56:57] op_sel_hi:[1,0,0]
    v_pk_fma_f32 v[166:167], v[166:167], v[58:59], v[56:57] op_sel_hi:[1,0,0]
    v_pk_fma_f32 v[168:169], v[168:169], v[58:59], v[56:57] op_sel_hi:[1,0,0]
    v_pk_fma_f32 v[170:171], v[170:171], v[58:59], v[56:57] op_sel_hi:[1,0,0]
    v_pk_fma_f32 v[172:173], v[172:173], v[58:59], v[56:57] op_sel_hi:[1,0,0]
    v_pk_fma_f32 v[174:175], v[174:175], v[58:59], v[56:57] op_sel_hi:[1,0,0]
    s_add_u32 s67, s67, s68
    s_cmp_ge_u32 s67, s69
    s_cselect_b32 s67, s70, s67
    v_pk_mul_f32 v[160:161], v[160:161], v[96:97]
    v_pk_mul_f32 v[162:163], v[162:163], v[98:99]
    v_pk_mul_f32 v[164:165], v[164:165], v[100:101]
    v_pk_mul_f32 v[166:167], v[166:167], v[102:103]
    v_pk_mul_f32 v[168:169], v[168:169], v[104:105]
    v_pk_mul_f32 v[170:171], v[170:171], v[106:107]
    v_pk_mul_f32 v[172:173], v[172:173], v[108:109]
    v_pk_mul_f32 v[174:175], v[174:175], v[110:111]
    v_exp_f32 v160, v160
    v_exp_f32 v161, v161
    v_exp_f32 v162, v162
    v_exp_f32 v163, v163
    v_exp_f32 v164, v164
    v_exp_f32 v165, v165
    s_add_u32 m0, s66, 61440
    s_nop 0
    buffer_load_dwordx4 v248, s[44:47], s67 offen offset:0  lds
    v_exp_f32 v166, v166
    v_exp_f32 v167, v167
    v_exp_f32 v168, v168
    v_exp_f32 v169, v169
    v_exp_f32 v170, v170
    v_exp_f32 v171, v171
    v_exp_f32 v172, v172
    v_exp_f32 v173, v173
    v_exp_f32 v174, v174
    v_exp_f32 v175, v175
    buffer_load_dwordx4 v249, s[44:47], s67 offen offset:1024  lds
    v_pk_fma_f32 v[160:161], v[160:161], v[62:63], v[62:63] op_sel_hi:[1,0,0]
    v_pk_fma_f32 v[162:163], v[162:163], v[62:63], v[62:63] op_sel_hi:[1,0,0]
    v_pk_fma_f32 v[164:165], v[164:165], v[62:63], v[62:63] op_sel_hi:[1,0,0]
    v_pk_fma_f32 v[166:167], v[166:167], v[62:63], v[62:63] op_sel_hi:[1,0,0]
    v_pk_fma_f32 v[168:169], v[168:169], v[62:63], v[62:63] op_sel_hi:[1,0,0]
    v_pk_fma_f32 v[170:171], v[170:171], v[62:63], v[62:63] op_sel_hi:[1,0,0]
    v_pk_fma_f32 v[172:173], v[172:173], v[62:63], v[62:63] op_sel_hi:[1,0,0]
    v_pk_fma_f32 v[174:175], v[174:175], v[62:63], v[62:63] op_sel_hi:[1,0,0]
    v_rcp_f32 v160, v160
    v_rcp_f32 v161, v161
    v_rcp_f32 v162, v162
    v_rcp_f32 v163, v163
    v_rcp_f32 v164, v164
    v_rcp_f32 v165, v165
    buffer_load_dwordx4 v250, s[44:47], s67 offen offset:2048  lds
    v_rcp_f32 v166, v166
    v_rcp_f32 v167, v167
    v_rcp_f32 v168, v168
    v_rcp_f32 v169, v169
    v_rcp_f32 v170, v170
    v_rcp_f32 v171, v171
    v_rcp_f32 v172, v172
    v_rcp_f32 v173, v173
    v_rcp_f32 v174, v174
    v_rcp_f32 v175, v175
    buffer_load_dwordx4 v251, s[44:47], s67 offen offset:3072  lds
    v_pk_mul_f32 v[96:97], v[96:97], v[160:161]
    v_pk_mul_f32 v[98:99], v[98:99], v[162:163]
    v_pk_mul_f32 v[100:101], v[100:101], v[164:165]
    v_pk_mul_f32 v[102:103], v[102:103], v[166:167]
    v_pk_mul_f32 v[104:105], v[104:105], v[168:169]
    v_pk_mul_f32 v[106:107], v[106:107], v[170:171]
    v_pk_mul_f32 v[108:109], v[108:109], v[172:173]
    v_pk_mul_f32 v[110:111], v[110:111], v[174:175]
    v_cvt_pk_bf16_f32 v24, v96, v97
    v_cvt_pk_bf16_f32 v25, v98, v99
    v_cvt_pk_bf16_f32 v26, v100, v101
    v_cvt_pk_bf16_f32 v27, v102, v103
    v_cvt_pk_bf16_f32 v28, v104, v105
    v_cvt_pk_bf16_f32 v29, v106, v107
    v_cvt_pk_bf16_f32 v30, v108, v109
    v_cvt_pk_bf16_f32 v31, v110, v111
    s_add_u32 s91, s91, 4096
    buffer_store_dwordx4 v[24:27], v4, s[40:43], s91 offen offset:0 sc1
    buffer_store_dwordx4 v[28:31], v4, s[40:43], s91 offen offset:1024 sc1
    v_pk_mul_f32 v[160:161], v[112:113], v[112:113]
    v_pk_mul_f32 v[162:163], v[114:115], v[114:115]
    v_pk_mul_f32 v[164:165], v[116:117], v[116:117]
    v_pk_mul_f32 v[166:167], v[118:119], v[118:119]
    s_add_u32 m0, s66, 62464
    s_nop 0
    buffer_load_dwordx4 v252, s[44:47], s67 offen offset:3072  lds
    v_pk_mul_f32 v[168:169], v[120:121], v[120:121]
    v_pk_mul_f32 v[170:171], v[122:123], v[122:123]
    v_pk_mul_f32 v[172:173], v[124:125], v[124:125]
    v_pk_mul_f32 v[174:175], v[126:127], v[126:127]
    v_pk_fma_f32 v[160:161], v[160:161], v[58:59], v[56:57] op_sel_hi:[1,0,0]
    v_pk_fma_f32 v[162:163], v[162:163], v[58:59], v[56:57] op_sel_hi:[1,0,0]
    v_pk_fma_f32 v[164:165], v[164:165], v[58:59], v[56:57] op_sel_hi:[1,0,0]
    v_pk_fma_f32 v[166:167], v[166:167], v[58:59], v[56:57] op_sel_hi:[1,0,0]
    v_pk_fma_f32 v[168:169], v[168:169], v[58:59], v[56:57] op_sel_hi:[1,0,0]
    v_pk_fma_f32 v[170:171], v[170:171], v[58:59], v[56:57] op_sel_hi:[1,0,0]
    v_pk_fma_f32 v[172:173], v[172:173], v[58:59], v[56:57] op_sel_hi:[1,0,0]
    v_pk_fma_f32 v[174:175], v[174:175], v[58:59], v[56:57] op_sel_hi:[1,0,0]
    v_pk_mul_f32 v[160:161], v[160:161], v[112:113]
    v_pk_mul_f32 v[162:163], v[162:163], v[114:115]
    v_pk_mul_f32 v[164:165], v[164:165], v[116:117]
    v_pk_mul_f32 v[166:167], v[166:167], v[118:119]
    v_pk_mul_f32 v[168:169], v[168:169], v[120:121]
    v_pk_mul_f32 v[170:171], v[170:171], v[122:123]
    v_pk_mul_f32 v[172:173], v[172:173], v[124:125]
    v_pk_mul_f32 v[174:175], v[174:175], v[126:127]
    s_add_u32 s67, s67, s68
    s_cmp_ge_u32 s67, s69
    s_cselect_b32 s67, s70, s67
    v_exp_f32 v160, v160
    v_exp_f32 v161, v161
    v_exp_f32 v162, v162
    v_exp_f32 v163, v163
    v_exp_f32 v164, v164
    v_exp_f32 v165, v165
    v_exp_f32 v166, v166
    v_exp_f32 v167, v167
    v_exp_f32 v168, v168
    v_exp_f32 v169, v169
    v_exp_f32 v170, v170
    v_exp_f32 v171, v171
    v_exp_f32 v172, v172
    v_exp_f32 v173, v173
    v_exp_f32 v174, v174
    v_exp_f32 v175, v175
    v_pk_fma_f32 v[160:161], v[160:161], v[62:63], v[62:63] op_sel_hi:[1,0,0]
    v_pk_fma_f32 v[162:163], v[162:163], v[62:63], v[62:63] op_sel_hi:[1,0,0]
    v_pk_fma_f32 v[164:165], v[164:165], v[62:63], v[62:63] op_sel_hi:[1,0,0]
    v_pk_fma_f32 v[166:167], v[166:167], v[62:63], v[62:63] op_sel_hi:[1,0,0]
    v_pk_fma_f32 v[168:169], v[168:169], v[62:63], v[62:63] op_sel_hi:[1,0,0]
    v_pk_fma_f32 v[170:171], v[170:171], v[62:63], v[62:63] op_sel_hi:[1,0,0]
    v_pk_fma_f32 v[172:173], v[172:173], v[62:63], v[62:63] op_sel_hi:[1,0,0]
    v_pk_fma_f32 v[174:175], v[174:175], v[62:63], v[62:63] op_sel_hi:[1,0,0]
    v_rcp_f32 v160, v160
    v_rcp_f32 v161, v161
    v_rcp_f32 v162, v162
    v_rcp_f32 v163, v163
    v_rcp_f32 v164, v164
    v_rcp_f32 v165, v165
    v_rcp_f32 v166, v166
    v_rcp_f32 v167, v167
    v_rcp_f32 v168, v168
    v_rcp_f32 v169, v169
    v_rcp_f32 v170, v170
    v_rcp_f32 v171, v171
    v_rcp_f32 v172, v172
    v_rcp_f32 v173, v173
    v_rcp_f32 v174, v174
    v_rcp_f32 v175, v175
    v_pk_mul_f32 v[112:113], v[112:113], v[160:161]
    v_pk_mul_f32 v[114:115], v[114:115], v[162:163]
    v_pk_mul_f32 v[116:117], v[116:117], v[164:165]
    v_pk_mul_f32 v[118:119], v[118:119], v[166:167]
    v_pk_mul_f32 v[120:121], v[120:121], v[168:169]
    v_pk_mul_f32 v[122:123], v[122:123], v[170:171]
    v_pk_mul_f32 v[124:125], v[124:125], v[172:173]
    v_pk_mul_f32 v[126:127], v[126:127], v[174:175]
    v_cvt_pk_bf16_f32 v32, v112, v113
    v_cvt_pk_bf16_f32 v33, v114, v115
    v_cvt_pk_bf16_f32 v34, v116, v117
    v_cvt_pk_bf16_f32 v35, v118, v119
    v_cvt_pk_bf16_f32 v36, v120, v121
    v_cvt_pk_bf16_f32 v37, v122, v123
    v_cvt_pk_bf16_f32 v38, v124, v125
    v_cvt_pk_bf16_f32 v39, v126, v127
    buffer_store_dwordx4 v[32:35], v4, s[40:43], s91 offen offset:2048 sc1
    buffer_store_dwordx4 v[36:39], v4, s[40:43], s91 offen offset:3072 sc1
    v_pk_mul_f32 v[160:161], v[128:129], v[128:129]
    v_pk_mul_f32 v[162:163], v[130:131], v[130:131]
    v_pk_mul_f32 v[164:165], v[132:133], v[132:133]
    v_pk_mul_f32 v[166:167], v[134:135], v[134:135]
    v_pk_mul_f32 v[168:169], v[136:137], v[136:137]
    v_pk_mul_f32 v[170:171], v[138:139], v[138:139]
    v_pk_mul_f32 v[172:173], v[140:141], v[140:141]
    v_pk_mul_f32 v[174:175], v[142:143], v[142:143]
    v_pk_fma_f32 v[160:161], v[160:161], v[58:59], v[56:57] op_sel_hi:[1,0,0]
    v_pk_fma_f32 v[162:163], v[162:163], v[58:59], v[56:57] op_sel_hi:[1,0,0]
    v_pk_fma_f32 v[164:165], v[164:165], v[58:59], v[56:57] op_sel_hi:[1,0,0]
    v_pk_fma_f32 v[166:167], v[166:167], v[58:59], v[56:57] op_sel_hi:[1,0,0]
    v_pk_fma_f32 v[168:169], v[168:169], v[58:59], v[56:57] op_sel_hi:[1,0,0]
    v_pk_fma_f32 v[170:171], v[170:171], v[58:59], v[56:57] op_sel_hi:[1,0,0]
    v_pk_fma_f32 v[172:173], v[172:173], v[58:59], v[56:57] op_sel_hi:[1,0,0]
    v_pk_fma_f32 v[174:175], v[174:175], v[58:59], v[56:57] op_sel_hi:[1,0,0]
    v_pk_mul_f32 v[160:161], v[160:161], v[128:129]
    v_pk_mul_f32 v[162:163], v[162:163], v[130:131]
    v_pk_mul_f32 v[164:165], v[164:165], v[132:133]
    v_pk_mul_f32 v[166:167], v[166:167], v[134:135]
    v_pk_mul_f32 v[168:169], v[168:169], v[136:137]
    v_pk_mul_f32 v[170:171], v[170:171], v[138:139]
    v_pk_mul_f32 v[172:173], v[172:173], v[140:141]
    v_pk_mul_f32 v[174:175], v[174:175], v[142:143]
    v_exp_f32 v160, v160
    v_exp_f32 v161, v161
    v_exp_f32 v162, v162
    v_exp_f32 v163, v163
    v_exp_f32 v164, v164
    v_exp_f32 v165, v165
    v_exp_f32 v166, v166
    v_exp_f32 v167, v167
    v_exp_f32 v168, v168
    v_exp_f32 v169, v169
    v_exp_f32 v170, v170
    v_exp_f32 v171, v171
    v_exp_f32 v172, v172
    v_exp_f32 v173, v173
    v_exp_f32 v174, v174
    v_exp_f32 v175, v175
    v_pk_fma_f32 v[160:161], v[160:161], v[62:63], v[62:63] op_sel_hi:[1,0,0]
    v_pk_fma_f32 v[162:163], v[162:163], v[62:63], v[62:63] op_sel_hi:[1,0,0]
    v_pk_fma_f32 v[164:165], v[164:165], v[62:63], v[62:63] op_sel_hi:[1,0,0]
    v_pk_fma_f32 v[166:167], v[166:167], v[62:63], v[62:63] op_sel_hi:[1,0,0]
    v_pk_fma_f32 v[168:169], v[168:169], v[62:63], v[62:63] op_sel_hi:[1,0,0]
    v_pk_fma_f32 v[170:171], v[170:171], v[62:63], v[62:63] op_sel_hi:[1,0,0]
    v_pk_fma_f32 v[172:173], v[172:173], v[62:63], v[62:63] op_sel_hi:[1,0,0]
    v_pk_fma_f32 v[174:175], v[174:175], v[62:63], v[62:63] op_sel_hi:[1,0,0]
    v_rcp_f32 v160, v160
    v_rcp_f32 v161, v161
    v_rcp_f32 v162, v162
    v_rcp_f32 v163, v163
    v_rcp_f32 v164, v164
    v_rcp_f32 v165, v165
    v_rcp_f32 v166, v166
    v_rcp_f32 v167, v167
    v_rcp_f32 v168, v168
    v_rcp_f32 v169, v169
    v_rcp_f32 v170, v170
    v_rcp_f32 v171, v171
    v_rcp_f32 v172, v172
    v_rcp_f32 v173, v173
    v_rcp_f32 v174, v174
    v_rcp_f32 v175, v175
    v_pk_mul_f32 v[128:129], v[128:129], v[160:161]
    v_pk_mul_f32 v[130:131], v[130:131], v[162:163]
    v_pk_mul_f32 v[132:133], v[132:133], v[164:165]
    v_pk_mul_f32 v[134:135], v[134:135], v[166:167]
    v_pk_mul_f32 v[136:137], v[136:137], v[168:169]
    v_pk_mul_f32 v[138:139], v[138:139], v[170:171]
    v_pk_mul_f32 v[140:141], v[140:141], v[172:173]
    v_pk_mul_f32 v[142:143], v[142:143], v[174:175]
    v_cvt_pk_bf16_f32 v24, v128, v129
    v_cvt_pk_bf16_f32 v25, v130, v131
    v_cvt_pk_bf16_f32 v26, v132, v133
    v_cvt_pk_bf16_f32 v27, v134, v135
    v_cvt_pk_bf16_f32 v28, v136, v137
    v_cvt_pk_bf16_f32 v29, v138, v139
    v_cvt_pk_bf16_f32 v30, v140, v141
    v_cvt_pk_bf16_f32 v31, v142, v143
    s_add_u32 s91, s91, 4096
    buffer_store_dwordx4 v[24:27], v4, s[40:43], s91 offen offset:0 sc1
    buffer_store_dwordx4 v[28:31], v4, s[40:43], s91 offen offset:1024 sc1
    s_branch L_p1_done
L_p1_qkv:
    v_mul_f32 v56, 0x3fb8aa3b, v60
    v_rcp_f32 v58, v60
    s_nop 0
    v_mul_f32 v58, 0x358637bd, v58
    s_cmp_ge_u32 s63, 4
    s_cbranch_scc1 L_p1_kv
    s_mul_i32 s91, s63, 10240
    s_mul_i32 s82, s98, 40960
    s_add_u32 s91, s91, s82
    s_add_u32 s91, s91, 0
    s_add_u32 s85, s66, 102400
    v_add_u32 v146, s85, v4
    s_mul_i32 s86, s77, 10240
    s_sub_u32 s85, s85, s86
    v_add_u32 v144, s85, v224
    v_add_u32 v145, s85, v225
    s_add_u32 s86, s100, 1024
    s_add_u32 s87, s100, 983040
    s_add_u32 s88, s87, 1024
    v_pk_mul_f32 v[160:161], v[64:65], v[56:57] op_sel_hi:[1,0]
    v_pk_mul_f32 v[162:163], v[66:67], v[56:57] op_sel_hi:[1,0]
    v_pk_mul_f32 v[164:165], v[68:69], v[56:57] op_sel_hi:[1,0]
    v_pk_mul_f32 v[166:167], v[70:71], v[56:57] op_sel_hi:[1,0]
    v_pk_mul_f32 v[168:169], v[72:73], v[56:57] op_sel_hi:[1,0]
    v_pk_mul_f32 v[170:171], v[74:75], v[56:57] op_sel_hi:[1,0]
    v_pk_mul_f32 v[172:173], v[76:77], v[56:57] op_sel_hi:[1,0]
    s_waitcnt vmcnt(14)
    ds_write_b128 v146, a[120:123] offset:0
    v_pk_mul_f32 v[174:175], v[78:79], v[56:57] op_sel_hi:[1,0]
    v_exp_f32_e64 v160, v160 clamp
    v_exp_f32_e64 v161, v161 clamp
    v_exp_f32_e64 v162, v162 clamp
    s_add_u32 m0, s66, 20480
    s_waitcnt vmcnt(13)
    ds_write_b128 v146, a[124:127] offset:1024
    v_exp_f32_e64 v163, v163 clamp
    v_exp_f32_e64 v164, v164 clamp
    v_exp_f32_e64 v165, v165 clamp
    v_exp_f32_e64 v166, v166 clamp
    buffer_load_dwordx4 v248, s[44:47], s67 offen offset:0  lds
    v_exp_f32_e64 v167, v167 clamp
    v_exp_f32_e64 v168, v168 clamp
    v_exp_f32_e64 v169, v169 clamp
    v_exp_f32_e64 v170, v170 clamp
    s_waitcnt vmcnt(13)
    ds_write_b128 v146, a[128:131] offset:2048
    v_exp_f32_e64 v171, v171 clamp
    v_exp_f32_e64 v172, v172 clamp
    v_exp_f32_e64 v173, v173 clamp
    v_exp_f32_e64 v174, v174 clamp
    buffer_load_dwordx4 v249, s[44:47], s67 offen offset:1024  lds
    v_exp_f32_e64 v175, v175 clamp
    v_max_f32 v64, v58, v64
    v_max_f32 v65, v58, v65
    v_max_f32 v66, v58, v66
    v_max_f32 v67, v58, v67
    v_max_f32 v68, v58, v68
    s_waitcnt vmcnt(13)
    ds_write_b128 v146, a[132:135] offset:3072
    v_max_f32 v69, v58, v69
    v_max_f32 v70, v58, v70
    v_max_f32 v71, v58, v71
    v_max_f32 v72, v58, v72
    v_max_f32 v73, v58, v73
    v_max_f32 v74, v58, v74
    v_max_f32 v75, v58, v75
    buffer_load_dwordx4 v250, s[44:47], s67 offen offset:2048  lds
    v_max_f32 v76, v58, v76
    v_max_f32 v77, v58, v77
    v_max_f32 v78, v58, v78
    v_max_f32 v79, v58, v79
    v_pk_fma_f32 v[64:65], v[64:65], v[60:61], v[160:161] op_sel_hi:[1,0,1]
    v_pk_fma_f32 v[66:67], v[66:67], v[60:61], v[162:163] op_sel_hi:[1,0,1]
    v_pk_fma_f32 v[68:69], v[68:69], v[60:61], v[164:165] op_sel_hi:[1,0,1]
    s_waitcnt vmcnt(13)
    ds_write_b128 v146, a[136:139] offset:4096
    v_pk_fma_f32 v[70:71], v[70:71], v[60:61], v[166:167] op_sel_hi:[1,0,1]
    v_pk_fma_f32 v[72:73], v[72:73], v[60:61], v[168:169] op_sel_hi:[1,0,1]
    v_pk_fma_f32 v[74:75], v[74:75], v[60:61], v[170:171] op_sel_hi:[1,0,1]
    v_pk_fma_f32 v[76:77], v[76:77], v[60:61], v[172:173] op_sel_hi:[1,0,1]
    v_pk_fma_f32 v[78:79], v[78:79], v[60:61], v[174:175] op_sel_hi:[1,0,1]
    v_cvt_pk_bf16_f32 v24, v64, v65
    v_cvt_pk_bf16_f32 v25, v66, v67
    buffer_load_dwordx4 v251, s[44:47], s67 offen offset:3072  lds
    v_cvt_pk_bf16_f32 v26, v68, v69
    v_cvt_pk_bf16_f32 v27, v70, v71
    v_cvt_pk_bf16_f32 v28, v72, v73
    v_cvt_pk_bf16_f32 v29, v74, v75
    v_cvt_pk_bf16_f32 v30, v76, v77
    v_cvt_pk_bf16_f32 v31, v78, v79
    buffer_store_dwordx4 v[24:27], v4, s[40:43], s91 offen offset:0 sc1
    buffer_store_dwordx4 v[28:31], v4, s[40:43], s91 offen offset:1024 sc1
    v_pk_mul_f32 v[160:161], v[80:81], v[56:57] op_sel_hi:[1,0]
    s_waitcnt vmcnt(15)
    ds_write_b128 v146, a[140:143] offset:20480
    v_pk_mul_f32 v[162:163], v[82:83], v[56:57] op_sel_hi:[1,0]
    v_pk_mul_f32 v[164:165], v[84:85], v[56:57] op_sel_hi:[1,0]
    v_pk_mul_f32 v[166:167], v[86:87], v[56:57] op_sel_hi:[1,0]
    v_pk_mul_f32 v[168:169], v[88:89], v[56:57] op_sel_hi:[1,0]
    v_pk_mul_f32 v[170:171], v[90:91], v[56:57] op_sel_hi:[1,0]
    v_pk_mul_f32 v[172:173], v[92:93], v[56:57] op_sel_hi:[1,0]
    v_pk_mul_f32 v[174:175], v[94:95], v[56:57] op_sel_hi:[1,0]
    s_add_u32 m0, s66, 21504
    s_waitcnt vmcnt(14)
    ds_write_b128 v146, a[144:147] offset:21504
    v_exp_f32_e64 v160, v160 clamp
    v_exp_f32_e64 v161, v161 clamp
    v_exp_f32_e64 v162, v162 clamp
    v_exp_f32_e64 v163, v163 clamp
    buffer_load_dwordx4 v252, s[44:47], s67 offen offset:3072  lds
    v_exp_f32_e64 v164, v164 clamp
    v_exp_f32_e64 v165, v165 clamp
    v_exp_f32_e64 v166, v166 clamp
    v_exp_f32_e64 v167, v167 clamp
    s_waitcnt vmcnt(14)
    ds_write_b128 v146, a[148:151] offset:22528
    v_exp_f32_e64 v168, v168 clamp
    v_exp_f32_e64 v169, v169 clamp
    v_exp_f32_e64 v170, v170 clamp
    v_exp_f32_e64 v171, v171 clamp
    s_add_u32 s67, s67, s68
    s_waitcnt vmcnt(13)
    ds_write_b128 v146, a[152:155] offset:23552
    v_exp_f32_e64 v172, v172 clamp
    v_exp_f32_e64 v173, v173 clamp
    v_exp_f32_e64 v174, v174 clamp
    v_exp_f32_e64 v175, v175 clamp
    s_cmp_ge_u32 s67, s69
    s_cselect_b32 s67, s70, s67
    v_max_f32 v80, v58, v80
    v_max_f32 v81, v58, v81
    v_max_f32 v82, v58, v82
    v_max_f32 v83, v58, v83
    v_max_f32 v84, v58, v84
    v_max_f32 v85, v58, v85
    v_max_f32 v86, v58, v86
    s_waitcnt vmcnt(12)
    ds_write_b128 v146, a[156:159] offset:24576
    v_max_f32 v87, v58, v87
    v_max_f32 v88, v58, v88
    v_max_f32 v89, v58, v89
    v_max_f32 v90, v58, v90
    v_max_f32 v91, v58, v91
    v_max_f32 v92, v58, v92
    v_max_f32 v93, v58, v93
    s_add_u32 m0, s66, 40960
    ds_read_b64_tr_b16 a[80:81], v145 offset:0
    ds_read_b64_tr_b16 a[82:83], v145 offset:1280
    v_max_f32 v94, v58, v94
    v_max_f32 v95, v58, v95
    v_pk_fma_f32 v[80:81], v[80:81], v[60:61], v[160:161] op_sel_hi:[1,0,1]
    v_pk_fma_f32 v[82:83], v[82:83], v[60:61], v[162:163] op_sel_hi:[1,0,1]
    v_pk_fma_f32 v[84:85], v[84:85], v[60:61], v[164:165] op_sel_hi:[1,0,1]
    v_pk_fma_f32 v[86:87], v[86:87], v[60:61], v[166:167] op_sel_hi:[1,0,1]
    v_pk_fma_f32 v[88:89], v[88:89], v[60:61], v[168:169] op_sel_hi:[1,0,1]
    buffer_load_dwordx4 v248, s[44:47], s67 offen offset:0  lds
    v_pk_fma_f32 v[90:91], v[90:91], v[60:61], v[170:171] op_sel_hi:[1,0,1]
    v_pk_fma_f32 v[92:93], v[92:93], v[60:61], v[172:173] op_sel_hi:[1,0,1]
    v_pk_fma_f32 v[94:95], v[94:95], v[60:61], v[174:175] op_sel_hi:[1,0,1]
    v_cvt_pk_bf16_f32 v32, v80, v81
    v_cvt_pk_bf16_f32 v33, v82, v83
    v_cvt_pk_bf16_f32 v34, v84, v85
    v_cvt_pk_bf16_f32 v35, v86, v87
    ds_read_b64_tr_b16 a[84:85], v145 offset:16
    ds_read_b64_tr_b16 a[86:87], v145 offset:1296
    v_cvt_pk_bf16_f32 v36, v88, v89
    v_cvt_pk_bf16_f32 v37, v90, v91
    v_cvt_pk_bf16_f32 v38, v92, v93
    v_cvt_pk_bf16_f32 v39, v94, v95
    buffer_store_dwordx4 v[32:35], v4, s[40:43], s91 offen offset:2048 sc1
    buffer_store_dwordx4 v[36:39], v4, s[40:43], s91 offen offset:3072 sc1
    v_pk_mul_f32 v[160:161], v[96:97], v[56:57] op_sel_hi:[1,0]
    v_pk_mul_f32 v[162:163], v[98:99], v[56:57] op_sel_hi:[1,0]
    v_pk_mul_f32 v[164:165], v[100:101], v[56:57] op_sel_hi:[1,0]
    buffer_load_dwordx4 v249, s[44:47], s67 offen offset:1024  lds
    v_pk_mul_f32 v[166:167], v[102:103], v[56:57] op_sel_hi:[1,0]
    v_pk_mul_f32 v[168:169], v[104:105], v[56:57] op_sel_hi:[1,0]
    v_pk_mul_f32 v[170:171], v[106:107], v[56:57] op_sel_hi:[1,0]
    v_pk_mul_f32 v[172:173], v[108:109], v[56:57] op_sel_hi:[1,0]
    v_pk_mul_f32 v[174:175], v[110:111], v[56:57] op_sel_hi:[1,0]
    v_exp_f32_e64 v160, v160 clamp
    ds_read_b64_tr_b16 a[88:89], v145 offset:64
    ds_read_b64_tr_b16 a[90:91], v145 offset:1344
    v_exp_f32_e64 v161, v161 clamp
    v_exp_f32_e64 v162, v162 clamp
    v_exp_f32_e64 v163, v163 clamp
    v_exp_f32_e64 v164, v164 clamp
    buffer_load_dwordx4 v250, s[44:47], s67 offen offset:2048  lds
    v_exp_f32_e64 v165, v165 clamp
    v_exp_f32_e64 v166, v166 clamp
    v_exp_f32_e64 v167, v167 clamp
    v_exp_f32_e64 v168, v168 clamp
    ds_read_b64_tr_b16 a[92:93], v145 offset:80
    ds_read_b64_tr_b16 a[94:95], v145 offset:1360
    v_exp_f32_e64 v169, v169 clamp
    v_exp_f32_e64 v170, v170 clamp
    v_exp_f32_e64 v171, v171 clamp
    v_exp_f32_e64 v172, v172 clamp
    buffer_load_dwordx4 v251, s[44:47], s67 offen offset:3072  lds
    v_exp_f32_e64 v173, v173 clamp
    v_exp_f32_e64 v174, v174 clamp
    v_exp_f32_e64 v175, v175 clamp
    v_max_f32 v96, v58, v96
    ds_read_b64_tr_b16 a[96:97], v144 offset:128
    ds_read_b64_tr_b16 a[98:99], v144 offset:1408
    v_max_f32 v97, v58, v97
    v_max_f32 v98, v58, v98
    v_max_f32 v99, v58, v99
    v_max_f32 v100, v58, v100
    v_max_f32 v101, v58, v101
    v_max_f32 v102, v58, v102
    v_max_f32 v103, v58, v103
    s_add_u32 m0, s66, 41984
    ds_read_b64_tr_b16 a[100:101], v145 offset:20480
    ds_read_b64_tr_b16 a[102:103], v145 offset:21760
    v_max_f32 v104, v58, v104
    v_max_f32 v105, v58, v105
    v_max_f32 v106, v58, v106
    v_max_f32 v107, v58, v107
    v_max_f32 v108, v58, v108
    v_max_f32 v109, v58, v109
    v_max_f32 v110, v58, v110
    buffer_load_dwordx4 v252, s[44:47], s67 offen offset:3072  lds
    v_max_f32 v111, v58, v111
    v_pk_fma_f32 v[96:97], v[96:97], v[60:61], v[160:161] op_sel_hi:[1,0,1]
    v_pk_fma_f32 v[98:99], v[98:99], v[60:61], v[162:163] op_sel_hi:[1,0,1]
    v_pk_fma_f32 v[100:101], v[100:101], v[60:61], v[164:165] op_sel_hi:[1,0,1]
    v_pk_fma_f32 v[102:103], v[102:103], v[60:61], v[166:167] op_sel_hi:[1,0,1]
    v_pk_fma_f32 v[104:105], v[104:105], v[60:61], v[168:169] op_sel_hi:[1,0,1]
    v_pk_fma_f32 v[106:107], v[106:107], v[60:61], v[170:171] op_sel_hi:[1,0,1]
    ds_read_b64_tr_b16 a[104:105], v145 offset:20496
    ds_read_b64_tr_b16 a[106:107], v145 offset:21776
    v_pk_fma_f32 v[108:109], v[108:109], v[60:61], v[172:173] op_sel_hi:[1,0,1]
    v_pk_fma_f32 v[110:111], v[110:111], v[60:61], v[174:175] op_sel_hi:[1,0,1]
    v_cvt_pk_bf16_f32 v24, v96, v97
    v_cvt_pk_bf16_f32 v25, v98, v99
    v_cvt_pk_bf16_f32 v26, v100, v101
    v_cvt_pk_bf16_f32 v27, v102, v103
    v_cvt_pk_bf16_f32 v28, v104, v105
    s_add_u32 s67, s67, s68
    ds_read_b64_tr_b16 a[108:109], v145 offset:20544
    ds_read_b64_tr_b16 a[110:111], v145 offset:21824
    v_cvt_pk_bf16_f32 v29, v106, v107
    v_cvt_pk_bf16_f32 v30, v108, v109
    v_cvt_pk_bf16_f32 v31, v110, v111
    s_add_u32 s91, s91, 4096
    buffer_store_dwordx4 v[24:27], v4, s[40:43], s91 offen offset:0 sc1
    buffer_store_dwordx4 v[28:31], v4, s[40:43], s91 offen offset:1024 sc1
    v_pk_mul_f32 v[160:161], v[112:113], v[56:57] op_sel_hi:[1,0]
    v_pk_mul_f32 v[162:163], v[114:115], v[56:57] op_sel_hi:[1,0]
    v_pk_mul_f32 v[164:165], v[116:117], v[56:57] op_sel_hi:[1,0]
    v_pk_mul_f32 v[166:167], v[118:119], v[56:57] op_sel_hi:[1,0]
    s_cmp_ge_u32 s67, s69
    s_cselect_b32 s67, s70, s67
    v_pk_mul_f32 v[168:169], v[120:121], v[56:57] op_sel_hi:[1,0]
    v_pk_mul_f32 v[170:171], v[122:123], v[56:57] op_sel_hi:[1,0]
    v_pk_mul_f32 v[172:173], v[124:125], v[56:57] op_sel_hi:[1,0]
    v_pk_mul_f32 v[174:175], v[126:127], v[56:57] op_sel_hi:[1,0]
    v_exp_f32_e64 v160, v160 clamp
    v_exp_f32_e64 v161, v161 clamp
    ds_read_b64_tr_b16 a[112:113], v145 offset:20560
    ds_read_b64_tr_b16 a[114:115], v145 offset:21840
    v_exp_f32_e64 v162, v162 clamp
    v_exp_f32_e64 v163, v163 clamp
    v_exp_f32_e64 v164, v164 clamp
    v_exp_f32_e64 v165, v165 clamp
    s_add_u32 m0, s66, 61440
    ds_read_b64_tr_b16 a[116:117], v144 offset:20608
    ds_read_b64_tr_b16 a[118:119], v144 offset:21888
    v_exp_f32_e64 v166, v166 clamp
    v_exp_f32_e64 v167, v167 clamp
    v_exp_f32_e64 v168, v168 clamp
    v_exp_f32_e64 v169, v169 clamp
    buffer_load_dwordx4 v248, s[44:47], s67 offen offset:0  lds
    v_exp_f32_e64 v170, v170 clamp
    v_exp_f32_e64 v171, v171 clamp
    v_exp_f32_e64 v172, v172 clamp
    v_exp_f32_e64 v173, v173 clamp
    buffer_load_dwordx4 v249, s[44:47], s67 offen offset:1024  lds
    v_exp_f32_e64 v174, v174 clamp
    v_exp_f32_e64 v175, v175 clamp
    v_max_f32 v112, v58, v112
    v_max_f32 v113, v58, v113
    v_max_f32 v114, v58, v114
    buffer_load_dwordx4 v250, s[44:47], s67 offen offset:2048  lds
    v_max_f32 v115, v58, v115
    v_max_f32 v116, v58, v116
    v_max_f32 v117, v58, v117
    v_max_f32 v118, v58, v118
    v_max_f32 v119, v58, v119
    v_max_f32 v120, v58, v120
    v_max_f32 v121, v58, v121
    buffer_load_dwordx4 v251, s[44:47], s67 offen offset:3072  lds
    v_max_f32 v122, v58, v122
    v_max_f32 v123, v58, v123
    v_max_f32 v124, v58, v124
    v_max_f32 v125, v58, v125
    v_max_f32 v126, v58, v126
    v_max_f32 v127, v58, v127
    v_pk_fma_f32 v[112:113], v[112:113], v[60:61], v[160:161] op_sel_hi:[1,0,1]
    s_add_u32 m0, s66, 62464
    s_nop 0
    buffer_load_dwordx4 v252, s[44:47], s67 offen offset:3072  lds
    v_pk_fma_f32 v[114:115], v[114:115], v[60:61], v[162:163] op_sel_hi:[1,0,1]
    v_pk_fma_f32 v[116:117], v[116:117], v[60:61], v[164:165] op_sel_hi:[1,0,1]
    v_pk_fma_f32 v[118:119], v[118:119], v[60:61], v[166:167] op_sel_hi:[1,0,1]
    v_pk_fma_f32 v[120:121], v[120:121], v[60:61], v[168:169] op_sel_hi:[1,0,1]
    v_pk_fma_f32 v[122:123], v[122:123], v[60:61], v[170:171] op_sel_hi:[1,0,1]
    v_pk_fma_f32 v[124:125], v[124:125], v[60:61], v[172:173] op_sel_hi:[1,0,1]
    v_pk_fma_f32 v[126:127], v[126:127], v[60:61], v[174:175] op_sel_hi:[1,0,1]
    s_add_u32 s67, s67, s68
    s_cmp_ge_u32 s67, s69
    s_cselect_b32 s67, s70, s67
    v_cvt_pk_bf16_f32 v32, v112, v113
    v_cvt_pk_bf16_f32 v33, v114, v115
    v_cvt_pk_bf16_f32 v34, v116, v117
    v_cvt_pk_bf16_f32 v35, v118, v119
    v_cvt_pk_bf16_f32 v36, v120, v121
    v_cvt_pk_bf16_f32 v37, v122, v123
    v_cvt_pk_bf16_f32 v38, v124, v125
    s_waitcnt lgkmcnt(15)
    buffer_store_dwordx4 a[80:83], v4, s[40:43], s100 offen offset:0 sc1
    v_cvt_pk_bf16_f32 v39, v126, v127
    buffer_store_dwordx4 v[32:35], v4, s[40:43], s91 offen offset:2048 sc1
    buffer_store_dwordx4 v[36:39], v4, s[40:43], s91 offen offset:3072 sc1
    v_pk_mul_f32 v[160:161], v[128:129], v[56:57] op_sel_hi:[1,0]
    v_pk_mul_f32 v[162:163], v[130:131], v[56:57] op_sel_hi:[1,0]
    v_pk_mul_f32 v[164:165], v[132:133], v[56:57] op_sel_hi:[1,0]
    v_pk_mul_f32 v[166:167], v[134:135], v[56:57] op_sel_hi:[1,0]
    v_pk_mul_f32 v[168:169], v[136:137], v[56:57] op_sel_hi:[1,0]
    v_pk_mul_f32 v[170:171], v[138:139], v[56:57] op_sel_hi:[1,0]
    buffer_store_dwordx4 a[84:87], v4, s[40:43], s100 offen offset:1024 sc1
    v_pk_mul_f32 v[172:173], v[140:141], v[56:57] op_sel_hi:[1,0]
    v_pk_mul_f32 v[174:175], v[142:143], v[56:57] op_sel_hi:[1,0]
    v_exp_f32_e64 v160, v160 clamp
    v_exp_f32_e64 v161, v161 clamp
    v_exp_f32_e64 v162, v162 clamp
    s_waitcnt lgkmcnt(14)
    buffer_store_dwordx4 a[88:91], v4, s[40:43], s100 offen offset:2048 sc1
    v_exp_f32_e64 v163, v163 clamp
    v_exp_f32_e64 v164, v164 clamp
    v_exp_f32_e64 v165, v165 clamp
    v_exp_f32_e64 v166, v166 clamp
    s_waitcnt lgkmcnt(12)
    buffer_store_dwordx4 a[92:95], v4, s[40:43], s100 offen offset:3072 sc1
    v_exp_f32_e64 v167, v167 clamp
    v_exp_f32_e64 v168, v168 clamp
    v_exp_f32_e64 v169, v169 clamp
    v_exp_f32_e64 v170, v170 clamp
    s_waitcnt lgkmcnt(10)
    buffer_store_dwordx4 a[96:99], v4, s[40:43], s86 offen offset:3072 sc1
    v_exp_f32_e64 v171, v171 clamp
    v_exp_f32_e64 v172, v172 clamp
    v_exp_f32_e64 v173, v173 clamp
    v_exp_f32_e64 v174, v174 clamp
    s_waitcnt lgkmcnt(8)
    buffer_store_dwordx4 a[100:103], v4, s[40:43], s87 offen offset:0 sc1
    v_exp_f32_e64 v175, v175 clamp
    v_max_f32 v128, v58, v128
    v_max_f32 v129, v58, v129
    v_max_f32 v130, v58, v130
    v_max_f32 v131, v58, v131
    v_max_f32 v132, v58, v132
    s_waitcnt lgkmcnt(6)
    buffer_store_dwordx4 a[104:107], v4, s[40:43], s87 offen offset:1024 sc1
    v_max_f32 v133, v58, v133
    v_max_f32 v134, v58, v134
    v_max_f32 v135, v58, v135
    v_max_f32 v136, v58, v136
    v_max_f32 v137, v58, v137
    v_max_f32 v138, v58, v138
    v_max_f32 v139, v58, v139
    s_waitcnt lgkmcnt(4)
    buffer_store_dwordx4 a[108:111], v4, s[40:43], s87 offen offset:2048 sc1
    v_max_f32 v140, v58, v140
    v_max_f32 v141, v58, v141
    v_max_f32 v142, v58, v142
    v_max_f32 v143, v58, v143
    v_pk_fma_f32 v[128:129], v[128:129], v[60:61], v[160:161] op_sel_hi:[1,0,1]
    v_pk_fma_f32 v[130:131], v[130:131], v[60:61], v[162:163] op_sel_hi:[1,0,1]
    v_pk_fma_f32 v[132:133], v[132:133], v[60:61], v[164:165] op_sel_hi:[1,0,1]
    s_waitcnt lgkmcnt(2)
    buffer_store_dwordx4 a[112:115], v4, s[40:43], s87 offen offset:3072 sc1
    v_pk_fma_f32 v[134:135], v[134:135], v[60:61], v[166:167] op_sel_hi:[1,0,1]
    v_pk_fma_f32 v[136:137], v[136:137], v[60:61], v[168:169] op_sel_hi:[1,0,1]
    v_pk_fma_f32 v[138:139], v[138:139], v[60:61], v[170:171] op_sel_hi:[1,0,1]
    v_pk_fma_f32 v[140:141], v[140:141], v[60:61], v[172:173] op_sel_hi:[1,0,1]
    v_pk_fma_f32 v[142:143], v[142:143], v[60:61], v[174:175] op_sel_hi:[1,0,1]
    v_cvt_pk_bf16_f32 v24, v128, v129
    v_cvt_pk_bf16_f32 v25, v130, v131
    s_waitcnt lgkmcnt(0)
    buffer_store_dwordx4 a[116:119], v4, s[40:43], s88 offen offset:3072 sc1
    v_cvt_pk_bf16_f32 v26, v132, v133
    v_cvt_pk_bf16_f32 v27, v134, v135
    v_cvt_pk_bf16_f32 v28, v136, v137
    v_cvt_pk_bf16_f32 v29, v138, v139
    v_cvt_pk_bf16_f32 v30, v140, v141
    v_cvt_pk_bf16_f32 v31, v142, v143
    s_add_u32 s91, s91, 4096
    buffer_store_dwordx4 v[24:27], v4, s[40:43], s91 offen offset:0 sc1
    buffer_store_dwordx4 v[28:31], v4, s[40:43], s91 offen offset:1024 sc1
    s_branch L_p1_done
L_p1_kv:
    s_lshl_b32 s90, s60, 12
    s_add_u32 s90, s90, 144384
    s_lshl_b32 s82, s60, 5
    v_and_b32 v62, 31, v0
    v_add_u32 v62, s82, v62
    v_mul_u32_u24 v62, 328, v62
    v_add_u32 v62, 102400, v62
    v_lshrrev_b32 v63, 5, v0
    v_lshl_add_u32 v63, v63, 3, v62
    v_mov_b32 v182, 0x3f803f80
    v_mov_b32 v183, 0x3f803f80
    ds_write_b64 v62, v[182:183] offset:320
    v_pk_mul_f32 v[160:161], v[64:65], v[56:57] op_sel_hi:[1,0]
    v_pk_mul_f32 v[162:163], v[66:67], v[56:57] op_sel_hi:[1,0]
    s_add_u32 m0, s66, 20480
    s_nop 0
    buffer_load_dwordx4 v248, s[44:47], s67 offen offset:0  lds
    v_pk_mul_f32 v[164:165], v[68:69], v[56:57] op_sel_hi:[1,0]
    v_pk_mul_f32 v[166:167], v[70:71], v[56:57] op_sel_hi:[1,0]
    v_pk_mul_f32 v[168:169], v[72:73], v[56:57] op_sel_hi:[1,0]
    v_pk_mul_f32 v[170:171], v[74:75], v[56:57] op_sel_hi:[1,0]
    v_pk_mul_f32 v[172:173], v[76:77], v[56:57] op_sel_hi:[1,0]
    v_pk_mul_f32 v[174:175], v[78:79], v[56:57] op_sel_hi:[1,0]
    v_pk_mul_f32 v[176:177], v[80:81], v[56:57] op_sel_hi:[1,0]
    v_pk_mul_f32 v[178:179], v[82:83], v[56:57] op_sel_hi:[1,0]
    v_exp_f32_e64 v160, v160 clamp
    buffer_load_dwordx4 v249, s[44:47], s67 offen offset:1024  lds
    v_exp_f32_e64 v161, v161 clamp
    v_exp_f32_e64 v162, v162 clamp
    v_exp_f32_e64 v163, v163 clamp
    v_exp_f32_e64 v164, v164 clamp
    v_exp_f32_e64 v165, v165 clamp
    buffer_load_dwordx4 v250, s[44:47], s67 offen offset:2048  lds
    v_exp_f32_e64 v166, v166 clamp
    v_exp_f32_e64 v167, v167 clamp
    v_exp_f32_e64 v168, v168 clamp
    v_exp_f32_e64 v169, v169 clamp
    v_exp_f32_e64 v170, v170 clamp
    buffer_load_dwordx4 v251, s[44:47], s67 offen offset:3072  lds
    v_exp_f32_e64 v171, v171 clamp
    v_exp_f32_e64 v172, v172 clamp
    v_exp_f32_e64 v173, v173 clamp
    v_exp_f32_e64 v174, v174 clamp
    v_exp_f32_e64 v175, v175 clamp
    s_add_u32 m0, s66, 21504
    s_nop 0
    buffer_load_dwordx4 v252, s[44:47], s67 offen offset:3072  lds
    v_exp_f32_e64 v176, v176 clamp
    v_exp_f32_e64 v177, v177 clamp
    v_exp_f32_e64 v178, v178 clamp
    v_exp_f32_e64 v179, v179 clamp
    v_max_f32 v64, v58, v64
    v_max_f32 v65, v58, v65
    s_add_u32 s67, s67, s68
    s_cmp_ge_u32 s67, s69
    s_cselect_b32 s67, s70, s67
    v_max_f32 v66, v58, v66
    v_max_f32 v67, v58, v67
    v_max_f32 v68, v58, v68
    v_max_f32 v69, v58, v69
    v_max_f32 v70, v58, v70
    v_max_f32 v71, v58, v71
    v_max_f32 v72, v58, v72
    v_max_f32 v73, v58, v73
    v_max_f32 v74, v58, v74
    v_max_f32 v75, v58, v75
    s_add_u32 m0, s66, 40960
    s_nop 0
    buffer_load_dwordx4 v248, s[44:47], s67 offen offset:0  lds
    v_max_f32 v76, v58, v76
    v_max_f32 v77, v58, v77
    v_max_f32 v78, v58, v78
    v_max_f32 v79, v58, v79
    v_max_f32 v80, v58, v80
    v_max_f32 v81, v58, v81
    v_max_f32 v82, v58, v82
    v_max_f32 v83, v58, v83
    v_pk_fma_f32 v[64:65], v[64:65], v[60:61], v[160:161] op_sel_hi:[1,0,1]
    v_pk_fma_f32 v[66:67], v[66:67], v[60:61], v[162:163] op_sel_hi:[1,0,1]
    buffer_load_dwordx4 v249, s[44:47], s67 offen offset:1024  lds
    v_pk_fma_f32 v[68:69], v[68:69], v[60:61], v[164:165] op_sel_hi:[1,0,1]
    v_pk_fma_f32 v[70:71], v[70:71], v[60:61], v[166:167] op_sel_hi:[1,0,1]
    v_pk_fma_f32 v[72:73], v[72:73], v[60:61], v[168:169] op_sel_hi:[1,0,1]
    v_pk_fma_f32 v[74:75], v[74:75], v[60:61], v[170:171] op_sel_hi:[1,0,1]
    v_pk_fma_f32 v[76:77], v[76:77], v[60:61], v[172:173] op_sel_hi:[1,0,1]
    v_pk_fma_f32 v[78:79], v[78:79], v[60:61], v[174:175] op_sel_hi:[1,0,1]
    v_pk_fma_f32 v[80:81], v[80:81], v[60:61], v[176:177] op_sel_hi:[1,0,1]
    v_pk_fma_f32 v[82:83], v[82:83], v[60:61], v[178:179] op_sel_hi:[1,0,1]
    v_cvt_pk_bf16_f32 v16, v64, v65
    v_cvt_pk_bf16_f32 v17, v66, v67
    buffer_load_dwordx4 v250, s[44:47], s67 offen offset:2048  lds
    v_cvt_pk_bf16_f32 v18, v68, v69
    v_cvt_pk_bf16_f32 v19, v70, v71
    v_cvt_pk_bf16_f32 v20, v72, v73
    v_cvt_pk_bf16_f32 v21, v74, v75
    v_cvt_pk_bf16_f32 v22, v76, v77
    v_cvt_pk_bf16_f32 v23, v78, v79
    v_cvt_pk_bf16_f32 v24, v80, v81
    v_cvt_pk_bf16_f32 v25, v82, v83
    v_pk_mul_f32 v[104:105], v[104:105], v[60:61] op_sel_hi:[1,0]
    v_pk_mul_f32 v[106:107], v[106:107], v[60:61] op_sel_hi:[1,0]
    buffer_load_dwordx4 v251, s[44:47], s67 offen offset:3072  lds
    v_pk_mul_f32 v[108:109], v[108:109], v[60:61] op_sel_hi:[1,0]
    v_pk_mul_f32 v[110:111], v[110:111], v[60:61] op_sel_hi:[1,0]
    v_pk_mul_f32 v[112:113], v[112:113], v[60:61] op_sel_hi:[1,0]
    v_pk_mul_f32 v[114:115], v[114:115], v[60:61] op_sel_hi:[1,0]
    ds_write_b64 v63, v[16:17] offset:0
    v_pk_mul_f32 v[116:117], v[116:117], v[60:61] op_sel_hi:[1,0]
    v_pk_mul_f32 v[118:119], v[118:119], v[60:61] op_sel_hi:[1,0]
    v_pk_mul_f32 v[120:121], v[120:121], v[60:61] op_sel_hi:[1,0]
    v_pk_mul_f32 v[122:123], v[122:123], v[60:61] op_sel_hi:[1,0]
    v_pk_mul_f32 v[124:125], v[124:125], v[60:61] op_sel_hi:[1,0]
    v_pk_mul_f32 v[126:127], v[126:127], v[60:61] op_sel_hi:[1,0]
    s_add_u32 m0, s66, 41984
    s_nop 0
    buffer_load_dwordx4 v252, s[44:47], s67 offen offset:3072  lds
    ds_write_b64 v63, v[18:19] offset:16
    v_pk_mul_f32 v[128:129], v[128:129], v[60:61] op_sel_hi:[1,0]
    v_pk_mul_f32 v[130:131], v[130:131], v[60:61] op_sel_hi:[1,0]
    v_pk_mul_f32 v[132:133], v[132:133], v[60:61] op_sel_hi:[1,0]
    v_pk_mul_f32 v[134:135], v[134:135], v[60:61] op_sel_hi:[1,0]
    v_pk_mul_f32 v[136:137], v[136:137], v[60:61] op_sel_hi:[1,0]
    v_pk_mul_f32 v[138:139], v[138:139], v[60:61] op_sel_hi:[1,0]
    ds_write_b64 v63, v[20:21] offset:32
    v_pk_mul_f32 v[140:141], v[140:141], v[60:61] op_sel_hi:[1,0]
    v_pk_mul_f32 v[142:143], v[142:143], v[60:61] op_sel_hi:[1,0]
    v_cvt_pk_bf16_f32 v36, v104, v105
    v_cvt_pk_bf16_f32 v37, v106, v107
    s_add_u32 s67, s67, s68
    s_cmp_ge_u32 s67, s69
    s_cselect_b32 s67, s70, s67
    v_cvt_pk_bf16_f32 v38, v108, v109
    v_cvt_pk_bf16_f32 v39, v110, v111
    ds_write_b64 v63, v[22:23] offset:48
    v_cvt_pk_bf16_f32 v40, v112, v113
    v_cvt_pk_bf16_f32 v41, v114, v115
    v_cvt_pk_bf16_f32 v42, v116, v117
    v_cvt_pk_bf16_f32 v43, v118, v119
    v_cvt_pk_bf16_f32 v44, v120, v121
    v_cvt_pk_bf16_f32 v45, v122, v123
    ds_write_b64 v63, v[24:25] offset:64
    v_cvt_pk_bf16_f32 v46, v124, v125
    v_cvt_pk_bf16_f32 v47, v126, v127
    s_add_u32 m0, s66, 61440
    s_nop 0
    buffer_load_dwordx4 v248, s[44:47], s67 offen offset:0  lds
    v_cvt_pk_bf16_f32 v48, v128, v129
    v_cvt_pk_bf16_f32 v49, v130, v131
    v_cvt_pk_bf16_f32 v50, v132, v133
    v_cvt_pk_bf16_f32 v51, v134, v135
    v_cvt_pk_bf16_f32 v52, v136, v137
    v_cvt_pk_bf16_f32 v53, v138, v139
    v_cvt_pk_bf16_f32 v54, v140, v141
    v_cvt_pk_bf16_f32 v55, v142, v143
    v_pk_mul_f32 v[160:161], v[84:85], v[56:57] op_sel_hi:[1,0]
    v_pk_mul_f32 v[162:163], v[86:87], v[56:57] op_sel_hi:[1,0]
    buffer_load_dwordx4 v249, s[44:47], s67 offen offset:1024  lds
    ds_write_b64 v63, v[36:37] offset:160
    v_pk_mul_f32 v[164:165], v[88:89], v[56:57] op_sel_hi:[1,0]
    v_pk_mul_f32 v[166:167], v[90:91], v[56:57] op_sel_hi:[1,0]
    v_pk_mul_f32 v[168:169], v[92:93], v[56:57] op_sel_hi:[1,0]
    v_pk_mul_f32 v[170:171], v[94:95], v[56:57] op_sel_hi:[1,0]
    v_pk_mul_f32 v[172:173], v[96:97], v[56:57] op_sel_hi:[1,0]
    v_pk_mul_f32 v[174:175], v[98:99], v[56:57] op_sel_hi:[1,0]
    ds_write_b64 v63, v[38:39] offset:176
    v_pk_mul_f32 v[176:177], v[100:101], v[56:57] op_sel_hi:[1,0]
    v_pk_mul_f32 v[178:179], v[102:103], v[56:57] op_sel_hi:[1,0]
    v_exp_f32_e64 v160, v160 clamp
    buffer_load_dwordx4 v250, s[44:47], s67 offen offset:2048  lds
    v_exp_f32_e64 v161, v161 clamp
    v_exp_f32_e64 v162, v162 clamp
    v_exp_f32_e64 v163, v163 clamp
    ds_write_b64 v63, v[40:41] offset:192
    v_exp_f32_e64 v164, v164 clamp
    v_exp_f32_e64 v165, v165 clamp
    buffer_load_dwordx4 v251, s[44:47], s67 offen offset:3072  lds
    v_exp_f32_e64 v166, v166 clamp
    v_exp_f32_e64 v167, v167 clamp
    v_exp_f32_e64 v168, v168 clamp
    v_exp_f32_e64 v169, v169 clamp
    ds_write_b64 v63, v[42:43] offset:208
    v_exp_f32_e64 v170, v170 clamp
    s_add_u32 m0, s66, 62464
    s_nop 0
    buffer_load_dwordx4 v252, s[44:47], s67 offen offset:3072  lds
    v_exp_f32_e64 v171, v171 clamp
    v_exp_f32_e64 v172, v172 clamp
    v_exp_f32_e64 v173, v173 clamp
    v_exp_f32_e64 v174, v174 clamp
    v_exp_f32_e64 v175, v175 clamp
    s_add_u32 s67, s67, s68
    s_cmp_ge_u32 s67, s69
    s_cselect_b32 s67, s70, s67
    ds_write_b64 v63, v[44:45] offset:224
    v_exp_f32_e64 v176, v176 clamp
    v_exp_f32_e64 v177, v177 clamp
    v_exp_f32_e64 v178, v178 clamp
    v_exp_f32_e64 v179, v179 clamp
    v_max_f32 v84, v58, v84
    v_max_f32 v85, v58, v85
    ds_write_b64 v63, v[46:47] offset:240
    v_max_f32 v86, v58, v86
    v_max_f32 v87, v58, v87
    v_max_f32 v88, v58, v88
    v_max_f32 v89, v58, v89
    v_max_f32 v90, v58, v90
    v_max_f32 v91, v58, v91
    ds_write_b64 v63, v[48:49] offset:256
    v_max_f32 v92, v58, v92
    v_max_f32 v93, v58, v93
    v_max_f32 v94, v58, v94
    v_max_f32 v95, v58, v95
    v_max_f32 v96, v58, v96
    v_max_f32 v97, v58, v97
    ds_write_b64 v63, v[50:51] offset:272
    v_max_f32 v98, v58, v98
    v_max_f32 v99, v58, v99
    v_max_f32 v100, v58, v100
    v_max_f32 v101, v58, v101
    v_max_f32 v102, v58, v102
    v_max_f32 v103, v58, v103
    ds_write_b64 v63, v[52:53] offset:288
    v_pk_fma_f32 v[84:85], v[84:85], v[60:61], v[160:161] op_sel_hi:[1,0,1]
    v_pk_fma_f32 v[86:87], v[86:87], v[60:61], v[162:163] op_sel_hi:[1,0,1]
    v_pk_fma_f32 v[88:89], v[88:89], v[60:61], v[164:165] op_sel_hi:[1,0,1]
    v_pk_fma_f32 v[90:91], v[90:91], v[60:61], v[166:167] op_sel_hi:[1,0,1]
    v_pk_fma_f32 v[92:93], v[92:93], v[60:61], v[168:169] op_sel_hi:[1,0,1]
    v_pk_fma_f32 v[94:95], v[94:95], v[60:61], v[170:171] op_sel_hi:[1,0,1]
    ds_write_b64 v63, v[54:55] offset:304
    v_pk_fma_f32 v[96:97], v[96:97], v[60:61], v[172:173] op_sel_hi:[1,0,1]
    v_pk_fma_f32 v[98:99], v[98:99], v[60:61], v[174:175] op_sel_hi:[1,0,1]
    v_pk_fma_f32 v[100:101], v[100:101], v[60:61], v[176:177] op_sel_hi:[1,0,1]
    v_pk_fma_f32 v[102:103], v[102:103], v[60:61], v[178:179] op_sel_hi:[1,0,1]
    v_cvt_pk_bf16_f32 v26, v84, v85
    v_cvt_pk_bf16_f32 v27, v86, v87
    v_cvt_pk_bf16_f32 v28, v88, v89
    v_cvt_pk_bf16_f32 v29, v90, v91
    v_cvt_pk_bf16_f32 v30, v92, v93
    v_cvt_pk_bf16_f32 v31, v94, v95
    v_cvt_pk_bf16_f32 v32, v96, v97
    v_cvt_pk_bf16_f32 v33, v98, v99
    v_cvt_pk_bf16_f32 v34, v100, v101
    v_cvt_pk_bf16_f32 v35, v102, v103
    ds_write_b64 v63, v[26:27] offset:80
    ds_write_b64 v63, v[28:29] offset:96
    ds_write_b64 v63, v[30:31] offset:112
    ds_write_b64 v63, v[32:33] offset:128
    ds_write_b64 v63, v[34:35] offset:144
    v_bfe_u32 v60, v0, 2, 2
    v_lshrrev_b32 v61, 5, v0
    v_lshl_add_u32 v60, v61, 2, v60
    v_lshlrev_b32 v145, 7, v60
    v_mul_u32_u24 v60, 328, v60
    v_add_u32 v60, 102400, v60
    v_bfe_u32 v61, v0, 4, 1
    v_and_b32 v62, 3, v0
    v_lshl_add_u32 v61, v61, 2, v62
    v_lshlrev_b32 v62, 3, v61
    v_add_u32 v145, v145, v62
    v_add_u32 v145, s90, v145
    v_add_u32 v63, s82, v62
    v_add_u32 v63, v63, v60
    s_mul_i32 s83, s60, 40
    s_add_u32 s83, s83, 160
    v_add_u32 v62, s83, v62
    v_cmp_gt_u32 vcc, 5, v61
    v_mov_b32 v61, 320
    s_nop 0
    v_cndmask_b32 v62, v61, v62, vcc
    v_add_u32 v62, v62, v60
    s_waitcnt lgkmcnt(0)
    s_barrier
    ds_read_b64_tr_b16 v[64:65], v63 offset:0
    ds_read_b64_tr_b16 v[68:69], v62 offset:0
    ds_read_b64_tr_b16 v[66:67], v63 offset:2624
    ds_read_b64_tr_b16 v[70:71], v62 offset:2624
    ds_read_b64_tr_b16 v[72:73], v63 offset:5248
    ds_read_b64_tr_b16 v[76:77], v62 offset:5248
    ds_read_b64_tr_b16 v[74:75], v63 offset:7872
    ds_read_b64_tr_b16 v[78:79], v62 offset:7872
    ds_read_b64_tr_b16 v[80:81], v63 offset:10496
    ds_read_b64_tr_b16 v[84:85], v62 offset:10496
    ds_read_b64_tr_b16 v[82:83], v63 offset:13120
    ds_read_b64_tr_b16 v[86:87], v62 offset:13120
    ds_read_b64_tr_b16 v[88:89], v63 offset:15744
    ds_read_b64_tr_b16 v[92:93], v62 offset:15744
    ds_read_b64_tr_b16 v[90:91], v63 offset:18368
    ds_read_b64_tr_b16 v[94:95], v62 offset:18368
    ds_read_b64_tr_b16 v[96:97], v63 offset:20992
    ds_read_b64_tr_b16 v[100:101], v62 offset:20992
    ds_read_b64_tr_b16 v[98:99], v63 offset:23616
    ds_read_b64_tr_b16 v[102:103], v62 offset:23616
    ds_read_b64_tr_b16 v[104:105], v63 offset:26240
    ds_read_b64_tr_b16 v[108:109], v62 offset:26240
    ds_read_b64_tr_b16 v[106:107], v63 offset:28864
    ds_read_b64_tr_b16 v[110:111], v62 offset:28864
    ds_read_b64_tr_b16 v[112:113], v63 offset:31488
    ds_read_b64_tr_b16 v[116:117], v62 offset:31488
    ds_read_b64_tr_b16 v[114:115], v63 offset:34112
    ds_read_b64_tr_b16 v[118:119], v62 offset:34112
    ds_read_b64_tr_b16 v[120:121], v63 offset:36736
    ds_read_b64_tr_b16 v[124:125], v62 offset:36736
    ds_read_b64_tr_b16 v[122:123], v63 offset:39360
    ds_read_b64_tr_b16 v[126:127], v62 offset:39360
    v_add_u32 v16, s90, v236
    v_add_u32 v17, s90, v237
    v_add_u32 v18, s90, v238
    v_add_u32 v19, s90, v239
    v_and_b32 v20, 31, v0
    v_cmp_gt_u32 vcc, 21, v20
    s_nop 1
    v_cndmask_b32 v16, v197, v16, vcc
    v_cndmask_b32 v17, v197, v17, vcc
    v_cndmask_b32 v18, v197, v18, vcc
    v_cndmask_b32 v19, v197, v19, vcc
    v_lshlrev_b32 v21, 2, v0
    v_add_u32 v20, s90, v21
    v_cmp_gt_u32 vcc, 36, v0
    s_nop 1
    v_cndmask_b32 v22, v197, v21, vcc
    s_waitcnt lgkmcnt(15)
    v_mfma_f32_32x32x16_bf16 v[160:175], v[64:67], v[68:71], 0
    v_mfma_f32_32x32x16_bf16 v[160:175], v[72:75], v[76:79], v[160:175]
    v_mfma_f32_32x32x16_bf16 v[160:175], v[80:83], v[84:87], v[160:175]
    v_mfma_f32_32x32x16_bf16 v[160:175], v[88:91], v[92:95], v[160:175]
    s_waitcnt lgkmcnt(12)
    v_mfma_f32_32x32x16_bf16 v[160:175], v[96:99], v[100:103], v[160:175]
    s_waitcnt lgkmcnt(8)
    v_mfma_f32_32x32x16_bf16 v[160:175], v[104:107], v[108:111], v[160:175]
    s_waitcnt lgkmcnt(4)
    v_mfma_f32_32x32x16_bf16 v[160:175], v[112:115], v[116:119], v[160:175]
    s_waitcnt lgkmcnt(0)
    v_mfma_f32_32x32x16_bf16 v[160:175], v[120:123], v[124:127], v[160:175]
    s_sub_u32 s82, s63, 4
    s_lshl_b32 s82, s82, 2
    s_add_u32 s82, s82, s60
    s_lshl_b32 s82, s82, 11
    s_add_u32 s82, s82, 21495808
    s_nop 6
    ds_write_b128 v16, v[160:163]
    ds_write_b128 v17, v[164:167]
    ds_write_b128 v18, v[168:171]
    ds_write_b128 v19, v[172:175]
    ds_read_b32 v176, v20 offset:0
    ds_read_b32 v177, v20 offset:256
    ds_read_b32 v178, v20 offset:512
    ds_read_b32 v179, v20 offset:768
    ds_read_b32 v180, v20 offset:1024
    ds_read_b32 v181, v20 offset:1280
    ds_read_b32 v182, v20 offset:1536
    s_waitcnt lgkmcnt(6)
    buffer_atomic_add_f32 v176, v21, s[40:43], s82 offen offset:0
    s_waitcnt lgkmcnt(5)
    buffer_atomic_add_f32 v177, v21, s[40:43], s82 offen offset:256
    s_waitcnt lgkmcnt(4)
    buffer_atomic_add_f32 v178, v21, s[40:43], s82 offen offset:512
    s_waitcnt lgkmcnt(3)
    buffer_atomic_add_f32 v179, v21, s[40:43], s82 offen offset:768
    s_waitcnt lgkmcnt(2)
    buffer_atomic_add_f32 v180, v21, s[40:43], s82 offen offset:1024
    s_waitcnt lgkmcnt(1)
    buffer_atomic_add_f32 v181, v21, s[40:43], s82 offen offset:1280
    s_waitcnt lgkmcnt(0)
    buffer_atomic_add_f32 v182, v22, s[40:43], s82 offen offset:1536
    v_cmp_gt_u32 vcc, 32, v0
    v_add_u32 v144, s90, v4
    s_waitcnt vmcnt(36)
    ds_write_b128 v144, a[120:123] offset:0
    s_waitcnt vmcnt(35)
    ds_write_b128 v144, a[124:127] offset:1024
    s_waitcnt vmcnt(34)
    ds_write_b128 v144, a[128:131] offset:2048
    s_waitcnt vmcnt(33)
    ds_write_b128 v144, a[132:135] offset:3072
    ds_read_b64_tr_b16 v[24:25], v145 offset:0
    ds_read_b64_tr_b16 v[26:27], v145 offset:1024
    ds_read_b64_tr_b16 v[28:29], v145 offset:64
    ds_read_b64_tr_b16 v[30:31], v145 offset:1088
    ds_read_b64_tr_b16 v[32:33], v145 offset:2048
    ds_read_b64_tr_b16 v[34:35], v145 offset:3072
    ds_read_b64_tr_b16 v[36:37], v145 offset:2112
    ds_read_b64_tr_b16 v[38:39], v145 offset:3136
    v_mov_b32 v20, 0x3f803f80
    v_mov_b32 v21, 0x3f803f80
    v_mov_b32 v22, 0x3f803f80
    v_mov_b32 v23, 0x3f803f80
    s_waitcnt lgkmcnt(6)
    s_nop 0
    v_mfma_f32_32x32x16_bf16 v[96:111], v[20:23], v[24:27], 0
    s_waitcnt lgkmcnt(4)
    v_mfma_f32_32x32x16_bf16 v[112:127], v[20:23], v[28:31], 0
    s_waitcnt lgkmcnt(2)
    v_mfma_f32_32x32x16_bf16 v[96:111], v[20:23], v[32:35], v[96:111]
    s_waitcnt lgkmcnt(0)
    v_mfma_f32_32x32x16_bf16 v[112:127], v[20:23], v[36:39], v[112:127]
    v_lshlrev_b32 v56, 2, v0
    s_nop 10
    v_cndmask_b32 v96, v112, v96, vcc
    buffer_atomic_add_f32 v96, v56, s[40:43], s100 offen
L_p1_done:
    s_nop 1
    s_mov_b32 s82, 0xffff0000
    v_lshlrev_b32 v64, 16, v212
    v_and_b32 v65, s82, v212
    v_lshlrev_b32 v66, 16, v213
    v_and_b32 v67, s82, v213
    v_lshlrev_b32 v68, 16, v214
    v_and_b32 v69, s82, v214
    v_lshlrev_b32 v70, 16, v215
    v_and_b32 v71, s82, v215
    v_lshlrev_b32 v72, 16, v216
    v_and_b32 v73, s82, v216
    v_lshlrev_b32 v74, 16, v217
    v_and_b32 v75, s82, v217
    v_lshlrev_b32 v76, 16, v218
    v_and_b32 v77, s82, v218
    v_lshlrev_b32 v78, 16, v219
    v_and_b32 v79, s82, v219
    v_lshlrev_b32 v80, 16, v220
    v_and_b32 v81, s82, v220
    v_lshlrev_b32 v82, 16, v221
    v_and_b32 v83, s82, v221
    v_mul_f32 v62, v222, v223
    v_mov_b32 v60, v223
    v_pk_fma_f32 v[64:65], v[64:65], v[60:61], v[62:63] op_sel_hi:[1,0,0] neg_lo:[0,0,1] neg_hi:[0,0,1]
    v_pk_fma_f32 v[66:67], v[66:67], v[60:61], v[62:63] op_sel_hi:[1,0,0] neg_lo:[0,0,1] neg_hi:[0,0,1]
    v_pk_fma_f32 v[68:69], v[68:69], v[60:61], v[62:63] op_sel_hi:[1,0,0] neg_lo:[0,0,1] neg_hi:[0,0,1]
    v_pk_fma_f32 v[70:71], v[70:71], v[60:61], v[62:63] op_sel_hi:[1,0,0] neg_lo:[0,0,1] neg_hi:[0,0,1]
    v_pk_fma_f32 v[72:73], v[72:73], v[60:61], v[62:63] op_sel_hi:[1,0,0] neg_lo:[0,0,1] neg_hi:[0,0,1]
    v_pk_fma_f32 v[74:75], v[74:75], v[60:61], v[62:63] op_sel_hi:[1,0,0] neg_lo:[0,0,1] neg_hi:[0,0,1]
    v_pk_fma_f32 v[76:77], v[76:77], v[60:61], v[62:63] op_sel_hi:[1,0,0] neg_lo:[0,0,1] neg_hi:[0,0,1]
    v_pk_fma_f32 v[78:79], v[78:79], v[60:61], v[62:63] op_sel_hi:[1,0,0] neg_lo:[0,0,1] neg_hi:[0,0,1]
    v_pk_fma_f32 v[80:81], v[80:81], v[60:61], v[62:63] op_sel_hi:[1,0,0] neg_lo:[0,0,1] neg_hi:[0,0,1]
    v_pk_fma_f32 v[82:83], v[82:83], v[60:61], v[62:63] op_sel_hi:[1,0,0] neg_lo:[0,0,1] neg_hi:[0,0,1]
    s_waitcnt lgkmcnt(0)
    s_add_u32 m0, s66, 81920
    s_nop 0
    buffer_load_dwordx4 v248, s[44:47], s67 offen offset:0  lds
    buffer_load_dwordx4 v249, s[44:47], s67 offen offset:1024  lds
    buffer_load_dwordx4 v250, s[44:47], s67 offen offset:2048  lds
    buffer_load_dwordx4 v251, s[44:47], s67 offen offset:3072  lds
    s_add_u32 m0, s66, 82944
    s_nop 0
    buffer_load_dwordx4 v252, s[44:47], s67 offen offset:3072  lds
    s_add_u32 s67, s67, s68
    s_cmp_ge_u32 s67, s69
    s_cselect_b32 s67, s70, s67
    s_cmp_ge_u32 s62, 12
    s_cbranch_scc1 L_p3s_8
    s_mov_b32 s44, s28
    s_mov_b32 s45, s29
    s_mov_b32 s46, 1966080
    s_mov_b32 s47, 0x20000
    v_lshrrev_b32 v58, 4, v0
    v_bfe_u32 v59, v0, 2, 2
    v_xor_b32 v59, v59, v58
    v_mul_u32_u24 v58, 3072, v58
    v_lshl_add_u32 v58, v59, 6, v58
    v_and_b32 v59, 3, v0
    v_lshl_add_u32 v5, v59, 4, v58
    v_add_u32 v6, 11264, v5
    v_add_u32 v7, 22528, v5
    v_add_u32 v8, 33792, v5
    v_mov_b32 v9, v197
    s_mov_b32 s68, 196608
    s_mul_i32 s82, s60, 49152
    s_lshl_b32 s83, s62, 8
    s_branch L_p3e_9
L_p3s_8:
    s_mov_b32 s44, s20
    s_mov_b32 s45, s21
    s_mov_b32 s46, 819200
    s_mov_b32 s47, 0x20000
    s_mov_b32 s68, 81920
    s_mul_i32 s82, s60, 20480
    s_sub_u32 s83, s62, 12
    s_mul_i32 s83, s83, 320
L_p3e_9:
    s_add_u32 s82, s82, s83
    s_mov_b32 s70, s82
    s_mul_i32 s69, s68, 10
    s_add_u32 s69, s69, s82
    s_mul_i32 s67, s99, s68
    s_add_u32 s67, s67, s82
    s_cmp_lt_u32 s62, 12
    s_cbranch_scc1 L_nh_10
    s_waitcnt vmcnt(5)
    s_barrier
    s_cmp_gt_u32 s60, 1
    s_cbranch_scc1 L_fs_11
    s_mov_b64 exec, 1
    s_cmp_eq_u32 s60, 0
    s_cbranch_scc1 L_fs_12
    s_lshl_b32 s93, s65, 2
    s_add_u32 s93, s93, 22087680
    buffer_store_dword v15, v4, s[40:43], s93 offen sc1
    s_branch L_fs_11
L_fs_12:
    s_lshl_b32 s92, s61, 9
    s_lshl_b32 s93, s62, 2
    s_add_u32 s92, s92, s93
    s_add_u32 s92, s92, 22020224
    buffer_store_dword v15, v4, s[40:43], s92 offen
L_fs_11:
    s_mov_b64 exec, -1
L_nh_10:
    s_waitcnt vmcnt(5)
    s_cmp_lg_u32 s60, 0
    s_cbranch_scc1 L_wd_13
    s_mov_b32 s84, 2
    v_lshlrev_b32 v1, 2, v0
    s_lshl_b32 s82, s61, 9
    s_lshl_b32 s83, s84, 6
    s_add_u32 s82, s82, s83
    s_add_u32 s82, s82, 22020096
    s_mov_b64 exec, 61440
    s_mov_b32 s85, 0
    s_cmp_eq_u32 s64, 0
    s_cbranch_scc1 L_wsl_14
L_wf_15:
    buffer_load_dword v2, v1, s[40:43], s82 offen sc1
    s_add_u32 s85, s85, 1
    s_waitcnt vmcnt(0)
    v_cmp_ne_u32 vcc, v2, v15
    s_cbranch_vccz L_wd_13
    s_cmp_lt_u32 s85, 96
    s_cbranch_scc1 L_wf_15
    s_mov_b32 s64, 0
L_wsl_14:
    s_lshl_b32 s82, s61, 6
    s_lshl_b32 s83, s84, 10
    s_add_u32 s82, s82, s83
    s_add_u32 s82, s82, 22085632
L_ws_16:
    buffer_load_dword v2, v1, s[40:43], s82 offen sc1
    s_add_u32 s85, s85, 1
    s_waitcnt vmcnt(0)
    v_cmp_ne_u32 vcc, v2, v15
    s_cbranch_vccz L_wd_13
    s_cmp_lt_u32 s85, 400000
    s_cbranch_scc1 L_ws_16
L_wd_13:
    s_mov_b64 exec, -1
    s_barrier
    s_lshl_b32 s82, s63, 7
    s_and_b32 s83, s98, 60
    s_add_u32 s82, s82, s83
    s_add_u32 s82, s82, 22093824
    s_cmp_lg_u32 s60, 3
    s_cbranch_scc1 L_f1_17
    s_mov_b64 exec, 1
    buffer_store_dword v15, v4, s[40:43], s82 offen sc1
    s_mov_b64 exec, -1
L_f1_17:
    buffer_load_dwordx4 a[0:3], v10, s[40:43], s74 offen offset:0 sc1
    buffer_load_dwordx4 a[4:7], v11, s[40:43], s74 offen offset:0 sc1
    buffer_load_dwordx4 a[8:11], v10, s[40:43], s74 offen offset:2048 sc1
    buffer_load_dwordx4 a[12:15], v11, s[40:43], s74 offen offset:2048 sc1
    s_add_u32 s74, s74, 4096
    s_cmp_ge_u32 s74, s75
    s_cselect_b32 s74, s76, s74
    buffer_load_dwordx4 a[16:19], v10, s[40:43], s74 offen offset:0 sc1
    buffer_load_dwordx4 a[20:23], v11, s[40:43], s74 offen offset:0 sc1
    buffer_load_dwordx4 a[24:27], v10, s[40:43], s74 offen offset:2048 sc1
    buffer_load_dwordx4 a[28:31], v11, s[40:43], s74 offen offset:2048 sc1
    s_add_u32 s74, s74, 4096
    s_cmp_ge_u32 s74, s75
    s_cselect_b32 s74, s76, s74
    buffer_load_dwordx4 a[32:35], v10, s[40:43], s74 offen offset:0 sc1
    buffer_load_dwordx4 a[36:39], v11, s[40:43], s74 offen offset:0 sc1
    buffer_load_dwordx4 a[40:43], v10, s[40:43], s74 offen offset:2048 sc1
    buffer_load_dwordx4 a[44:47], v11, s[40:43], s74 offen offset:2048 sc1
    s_add_u32 s74, s74, 4096
    s_cmp_ge_u32 s74, s75
    s_cselect_b32 s74, s76, s74
    s_barrier
    ds_read_b64_tr_b16 v[16:17], v225 offset:0
    ds_read_b64_tr_b16 v[18:19], v225 offset:1280
    ds_read_b64_tr_b16 v[20:21], v225 offset:16
    ds_read_b64_tr_b16 v[22:23], v225 offset:1296
    ds_read_b64_tr_b16 v[24:25], v225 offset:64
    ds_read_b64_tr_b16 v[26:27], v225 offset:1344
    ds_read_b64_tr_b16 v[28:29], v225 offset:80
    ds_read_b64_tr_b16 v[30:31], v225 offset:1360
    ds_read_b64_tr_b16 v[32:33], v224 offset:128
    ds_read_b64_tr_b16 v[34:35], v224 offset:1408
    s_waitcnt vmcnt(11) lgkmcnt(8)
    v_mfma_f32_16x16x32_bf16 v[64:67], v[16:19], a[0:3], v[64:67]
    ds_read_b64_tr_b16 v[36:37], v225 offset:5120
    ds_read_b64_tr_b16 v[38:39], v225 offset:6400
    s_waitcnt vmcnt(10)
    v_mfma_f32_16x16x32_bf16 v[84:87], v[16:19], a[4:7], 0
    ds_read_b64_tr_b16 v[40:41], v225 offset:5136
    s_waitcnt lgkmcnt(9)
    v_mfma_f32_16x16x32_bf16 v[68:71], v[20:23], a[0:3], v[68:71]
    ds_read_b64_tr_b16 v[42:43], v225 offset:6416
    buffer_load_dwordx4 a[48:51], v10, s[40:43], s74 offen offset:0 sc1
    v_mfma_f32_16x16x32_bf16 v[88:91], v[20:23], a[4:7], 0
    ds_read_b64_tr_b16 v[44:45], v225 offset:5184
    s_waitcnt lgkmcnt(9)
    v_mfma_f32_16x16x32_bf16 v[72:75], v[24:27], a[0:3], v[72:75]
    ds_read_b64_tr_b16 v[46:47], v225 offset:6464
    buffer_load_dwordx4 a[52:55], v11, s[40:43], s74 offen offset:0 sc1
    v_mfma_f32_16x16x32_bf16 v[92:95], v[24:27], a[4:7], 0
    ds_read_b64_tr_b16 v[48:49], v225 offset:5200
    s_waitcnt lgkmcnt(9)
    v_mfma_f32_16x16x32_bf16 v[76:79], v[28:31], a[0:3], v[76:79]
    ds_read_b64_tr_b16 v[50:51], v225 offset:6480
    v_mfma_f32_16x16x32_bf16 v[96:99], v[28:31], a[4:7], 0
    ds_read_b64_tr_b16 v[52:53], v224 offset:5248
    s_waitcnt lgkmcnt(9)
    v_mfma_f32_16x16x32_bf16 v[80:83], v[32:35], a[0:3], v[80:83]
    ds_read_b64_tr_b16 v[54:55], v224 offset:6528
    buffer_load_dwordx4 a[56:59], v10, s[40:43], s74 offen offset:2048 sc1
    v_mfma_f32_16x16x32_bf16 v[100:103], v[32:35], a[4:7], 0
    s_waitcnt vmcnt(12) lgkmcnt(8)
    v_mfma_f32_16x16x32_bf16 v[64:67], v[36:39], a[8:11], v[64:67]
    s_waitcnt vmcnt(11)
    v_mfma_f32_16x16x32_bf16 v[84:87], v[36:39], a[12:15], v[84:87]
    ds_read_b64_tr_b16 v[16:17], v225 offset:20480
    s_waitcnt lgkmcnt(7)
    v_mfma_f32_16x16x32_bf16 v[68:71], v[40:43], a[8:11], v[68:71]
    ds_read_b64_tr_b16 v[18:19], v225 offset:21760
    ds_read_b64_tr_b16 v[20:21], v225 offset:20496
    v_mfma_f32_16x16x32_bf16 v[88:91], v[40:43], a[12:15], v[88:91]
    ds_read_b64_tr_b16 v[22:23], v225 offset:21776
    s_waitcnt lgkmcnt(8)
    v_mfma_f32_16x16x32_bf16 v[72:75], v[44:47], a[8:11], v[72:75]
    ds_read_b64_tr_b16 v[24:25], v225 offset:20544
    ds_read_b64_tr_b16 v[26:27], v225 offset:21824
    v_mfma_f32_16x16x32_bf16 v[92:95], v[44:47], a[12:15], v[92:95]
    ds_read_b64_tr_b16 v[28:29], v225 offset:20560
    s_waitcnt lgkmcnt(9)
    v_mfma_f32_16x16x32_bf16 v[76:79], v[48:51], a[8:11], v[76:79]
    ds_read_b64_tr_b16 v[30:31], v225 offset:21840
    buffer_load_dwordx4 a[60:63], v11, s[40:43], s74 offen offset:2048 sc1
    v_mfma_f32_16x16x32_bf16 v[96:99], v[48:51], a[12:15], v[96:99]
    ds_read_b64_tr_b16 v[32:33], v224 offset:20608
    s_add_u32 s74, s74, 4096
    s_waitcnt lgkmcnt(9)
    v_mfma_f32_16x16x32_bf16 v[80:83], v[52:55], a[8:11], v[80:83]
    ds_read_b64_tr_b16 v[34:35], v224 offset:21888
    s_cmp_ge_u32 s74, s75
    s_cselect_b32 s74, s76, s74
    v_mfma_f32_16x16x32_bf16 v[100:103], v[52:55], a[12:15], v[100:103]
    s_waitcnt vmcnt(11) lgkmcnt(8)
    v_mfma_f32_16x16x32_bf16 v[64:67], v[16:19], a[16:19], v[64:67]
    ds_read_b64_tr_b16 v[36:37], v225 offset:25600
    ds_read_b64_tr_b16 v[38:39], v225 offset:26880
    s_waitcnt vmcnt(10)
    v_mfma_f32_16x16x32_bf16 v[84:87], v[16:19], a[20:23], v[84:87]
    ds_read_b64_tr_b16 v[40:41], v225 offset:25616
    s_waitcnt lgkmcnt(9)
    v_mfma_f32_16x16x32_bf16 v[68:71], v[20:23], a[16:19], v[68:71]
    ds_read_b64_tr_b16 v[42:43], v225 offset:26896
    buffer_load_dwordx4 a[64:67], v10, s[40:43], s74 offen offset:0 sc1
    v_mfma_f32_16x16x32_bf16 v[88:91], v[20:23], a[20:23], v[88:91]
    ds_read_b64_tr_b16 v[44:45], v225 offset:25664
    s_waitcnt lgkmcnt(9)
    v_mfma_f32_16x16x32_bf16 v[72:75], v[24:27], a[16:19], v[72:75]
    ds_read_b64_tr_b16 v[46:47], v225 offset:26944
    buffer_load_dwordx4 a[68:71], v11, s[40:43], s74 offen offset:0 sc1
    v_mfma_f32_16x16x32_bf16 v[92:95], v[24:27], a[20:23], v[92:95]
    ds_read_b64_tr_b16 v[48:49], v225 offset:25680
    s_waitcnt lgkmcnt(9)
    v_mfma_f32_16x16x32_bf16 v[76:79], v[28:31], a[16:19], v[76:79]
    ds_read_b64_tr_b16 v[50:51], v225 offset:26960
    v_mfma_f32_16x16x32_bf16 v[96:99], v[28:31], a[20:23], v[96:99]
    ds_read_b64_tr_b16 v[52:53], v224 offset:25728
    s_waitcnt lgkmcnt(9)
    v_mfma_f32_16x16x32_bf16 v[80:83], v[32:35], a[16:19], v[80:83]
    ds_read_b64_tr_b16 v[54:55], v224 offset:27008
    buffer_load_dwordx4 a[72:75], v10, s[40:43], s74 offen offset:2048 sc1
    v_mfma_f32_16x16x32_bf16 v[100:103], v[32:35], a[20:23], v[100:103]
    s_waitcnt vmcnt(12) lgkmcnt(8)
    v_mfma_f32_16x16x32_bf16 v[64:67], v[36:39], a[24:27], v[64:67]
    s_waitcnt vmcnt(11)
    v_mfma_f32_16x16x32_bf16 v[84:87], v[36:39], a[28:31], v[84:87]
    ds_read_b64_tr_b16 v[16:17], v225 offset:40960
    s_waitcnt lgkmcnt(7)
    v_mfma_f32_16x16x32_bf16 v[68:71], v[40:43], a[24:27], v[68:71]
    ds_read_b64_tr_b16 v[18:19], v225 offset:42240
    ds_read_b64_tr_b16 v[20:21], v225 offset:40976
    v_mfma_f32_16x16x32_bf16 v[88:91], v[40:43], a[28:31], v[88:91]
    ds_read_b64_tr_b16 v[22:23], v225 offset:42256
    s_waitcnt lgkmcnt(8)
    v_mfma_f32_16x16x32_bf16 v[72:75], v[44:47], a[24:27], v[72:75]
    ds_read_b64_tr_b16 v[24:25], v225 offset:41024
    ds_read_b64_tr_b16 v[26:27], v225 offset:42304
    v_mfma_f32_16x16x32_bf16 v[92:95], v[44:47], a[28:31], v[92:95]
    ds_read_b64_tr_b16 v[28:29], v225 offset:41040
    s_waitcnt lgkmcnt(9)
    v_mfma_f32_16x16x32_bf16 v[76:79], v[48:51], a[24:27], v[76:79]
    ds_read_b64_tr_b16 v[30:31], v225 offset:42320
    buffer_load_dwordx4 a[76:79], v11, s[40:43], s74 offen offset:2048 sc1
    v_mfma_f32_16x16x32_bf16 v[96:99], v[48:51], a[28:31], v[96:99]
    ds_read_b64_tr_b16 v[32:33], v224 offset:41088
    s_add_u32 s74, s74, 4096
    s_waitcnt lgkmcnt(9)
    v_mfma_f32_16x16x32_bf16 v[80:83], v[52:55], a[24:27], v[80:83]
    ds_read_b64_tr_b16 v[34:35], v224 offset:42368
    s_cmp_ge_u32 s74, s75
    s_cselect_b32 s74, s76, s74
    v_mfma_f32_16x16x32_bf16 v[100:103], v[52:55], a[28:31], v[100:103]
    s_waitcnt vmcnt(11) lgkmcnt(8)
    v_mfma_f32_16x16x32_bf16 v[64:67], v[16:19], a[32:35], v[64:67]
    ds_read_b64_tr_b16 v[36:37], v225 offset:46080
    ds_read_b64_tr_b16 v[38:39], v225 offset:47360
    s_add_u32 m0, s66, 143360
    s_waitcnt vmcnt(10)
    v_mfma_f32_16x16x32_bf16 v[84:87], v[16:19], a[36:39], v[84:87]
    ds_read_b64_tr_b16 v[40:41], v225 offset:46096
    s_waitcnt lgkmcnt(9)
    v_mfma_f32_16x16x32_bf16 v[68:71], v[20:23], a[32:35], v[68:71]
    ds_read_b64_tr_b16 v[42:43], v225 offset:47376
    buffer_load_dwordx4 v5, s[44:47], s67 offen offset:0  lds
    v_mfma_f32_16x16x32_bf16 v[88:91], v[20:23], a[36:39], v[88:91]
    ds_read_b64_tr_b16 v[44:45], v225 offset:46144
    s_waitcnt lgkmcnt(9)
    v_mfma_f32_16x16x32_bf16 v[72:75], v[24:27], a[32:35], v[72:75]
    ds_read_b64_tr_b16 v[46:47], v225 offset:47424
    buffer_load_dwordx4 v6, s[44:47], s67 offen offset:1024  lds
    v_mfma_f32_16x16x32_bf16 v[92:95], v[24:27], a[36:39], v[92:95]
    ds_read_b64_tr_b16 v[48:49], v225 offset:46160
    s_waitcnt lgkmcnt(9)
    v_mfma_f32_16x16x32_bf16 v[76:79], v[28:31], a[32:35], v[76:79]
    ds_read_b64_tr_b16 v[50:51], v225 offset:47440
    buffer_load_dwordx4 v7, s[44:47], s67 offen offset:2048  lds
    v_mfma_f32_16x16x32_bf16 v[96:99], v[28:31], a[36:39], v[96:99]
    ds_read_b64_tr_b16 v[52:53], v224 offset:46208
    s_waitcnt lgkmcnt(9)
    v_mfma_f32_16x16x32_bf16 v[80:83], v[32:35], a[32:35], v[80:83]
    ds_read_b64_tr_b16 v[54:55], v224 offset:47488
    v_mfma_f32_16x16x32_bf16 v[100:103], v[32:35], a[36:39], v[100:103]
    buffer_load_dwordx4 v8, s[44:47], s67 offen offset:3072  lds
    s_waitcnt vmcnt(13) lgkmcnt(8)
    v_mfma_f32_16x16x32_bf16 v[64:67], v[36:39], a[40:43], v[64:67]
    s_waitcnt vmcnt(12)
    v_mfma_f32_16x16x32_bf16 v[84:87], v[36:39], a[44:47], v[84:87]
    ds_read_b64_tr_b16 v[16:17], v227 offset:0
    s_waitcnt lgkmcnt(7)
    v_mfma_f32_16x16x32_bf16 v[68:71], v[40:43], a[40:43], v[68:71]
    ds_read_b64_tr_b16 v[18:19], v227 offset:1280
    ds_read_b64_tr_b16 v[20:21], v227 offset:16
    s_add_u32 m0, s66, 144384
    v_mfma_f32_16x16x32_bf16 v[88:91], v[40:43], a[44:47], v[88:91]
    ds_read_b64_tr_b16 v[22:23], v227 offset:1296
    s_waitcnt lgkmcnt(8)
    v_mfma_f32_16x16x32_bf16 v[72:75], v[44:47], a[40:43], v[72:75]
    ds_read_b64_tr_b16 v[24:25], v227 offset:64
    ds_read_b64_tr_b16 v[26:27], v227 offset:1344
    v_mfma_f32_16x16x32_bf16 v[92:95], v[44:47], a[44:47], v[92:95]
    ds_read_b64_tr_b16 v[28:29], v227 offset:80
    s_waitcnt lgkmcnt(9)
    v_mfma_f32_16x16x32_bf16 v[76:79], v[48:51], a[40:43], v[76:79]
    ds_read_b64_tr_b16 v[30:31], v227 offset:1360
    buffer_load_dwordx4 v9, s[44:47], s67 offen offset:3072  lds
    v_mfma_f32_16x16x32_bf16 v[96:99], v[48:51], a[44:47], v[96:99]
    ds_read_b64_tr_b16 v[32:33], v226 offset:128
    s_add_u32 s67, s67, s68
    s_waitcnt lgkmcnt(9)
    v_mfma_f32_16x16x32_bf16 v[80:83], v[52:55], a[40:43], v[80:83]
    ds_read_b64_tr_b16 v[34:35], v226 offset:1408
    s_cmp_ge_u32 s67, s69
    s_cselect_b32 s67, s70, s67
    v_mfma_f32_16x16x32_bf16 v[100:103], v[52:55], a[44:47], v[100:103]
    s_waitcnt vmcnt(12) lgkmcnt(8)
    v_mfma_f32_16x16x32_bf16 v[64:67], v[16:19], a[48:51], v[64:67]
    ds_read_b64_tr_b16 v[36:37], v227 offset:5120
    ds_read_b64_tr_b16 v[38:39], v227 offset:6400
    s_add_u32 m0, s66, 122880
    s_waitcnt vmcnt(11)
    v_mfma_f32_16x16x32_bf16 v[84:87], v[16:19], a[52:55], v[84:87]
    ds_read_b64_tr_b16 v[40:41], v227 offset:5136
    s_waitcnt lgkmcnt(9)
    v_mfma_f32_16x16x32_bf16 v[68:71], v[20:23], a[48:51], v[68:71]
    ds_read_b64_tr_b16 v[42:43], v227 offset:6416
    buffer_load_dwordx4 v5, s[44:47], s67 offen offset:0  lds
    v_mfma_f32_16x16x32_bf16 v[88:91], v[20:23], a[52:55], v[88:91]
    ds_read_b64_tr_b16 v[44:45], v227 offset:5184
    s_waitcnt lgkmcnt(9)
    v_mfma_f32_16x16x32_bf16 v[72:75], v[24:27], a[48:51], v[72:75]
    ds_read_b64_tr_b16 v[46:47], v227 offset:6464
    buffer_load_dwordx4 v6, s[44:47], s67 offen offset:1024  lds
    v_mfma_f32_16x16x32_bf16 v[92:95], v[24:27], a[52:55], v[92:95]
    ds_read_b64_tr_b16 v[48:49], v227 offset:5200
    s_waitcnt lgkmcnt(9)
    v_mfma_f32_16x16x32_bf16 v[76:79], v[28:31], a[48:51], v[76:79]
    ds_read_b64_tr_b16 v[50:51], v227 offset:6480
    buffer_load_dwordx4 v7, s[44:47], s67 offen offset:2048  lds
    v_mfma_f32_16x16x32_bf16 v[96:99], v[28:31], a[52:55], v[96:99]
    ds_read_b64_tr_b16 v[52:53], v226 offset:5248
    s_waitcnt lgkmcnt(9)
    v_mfma_f32_16x16x32_bf16 v[80:83], v[32:35], a[48:51], v[80:83]
    ds_read_b64_tr_b16 v[54:55], v226 offset:6528
    v_mfma_f32_16x16x32_bf16 v[100:103], v[32:35], a[52:55], v[100:103]
    buffer_load_dwordx4 v8, s[44:47], s67 offen offset:3072  lds
    s_waitcnt vmcnt(14) lgkmcnt(8)
    v_mfma_f32_16x16x32_bf16 v[64:67], v[36:39], a[56:59], v[64:67]
    s_barrier
    s_waitcnt vmcnt(13)
    v_mfma_f32_16x16x32_bf16 v[84:87], v[36:39], a[60:63], v[84:87]
    ds_read_b64_tr_b16 v[16:17], v227 offset:20480
    s_waitcnt lgkmcnt(7)
    v_mfma_f32_16x16x32_bf16 v[68:71], v[40:43], a[56:59], v[68:71]
    ds_read_b64_tr_b16 v[18:19], v227 offset:21760
    ds_read_b64_tr_b16 v[20:21], v227 offset:20496
    s_add_u32 m0, s66, 123904
    v_mfma_f32_16x16x32_bf16 v[88:91], v[40:43], a[60:63], v[88:91]
    ds_read_b64_tr_b16 v[22:23], v227 offset:21776
    s_waitcnt lgkmcnt(8)
    v_mfma_f32_16x16x32_bf16 v[72:75], v[44:47], a[56:59], v[72:75]
    ds_read_b64_tr_b16 v[24:25], v227 offset:20544
    ds_read_b64_tr_b16 v[26:27], v227 offset:21824
    v_mfma_f32_16x16x32_bf16 v[92:95], v[44:47], a[60:63], v[92:95]
    ds_read_b64_tr_b16 v[28:29], v227 offset:20560
    s_waitcnt lgkmcnt(9)
    v_mfma_f32_16x16x32_bf16 v[76:79], v[48:51], a[56:59], v[76:79]
    ds_read_b64_tr_b16 v[30:31], v227 offset:21840
    buffer_load_dwordx4 v9, s[44:47], s67 offen offset:3072  lds
    v_mfma_f32_16x16x32_bf16 v[96:99], v[48:51], a[60:63], v[96:99]
    ds_read_b64_tr_b16 v[32:33], v226 offset:20608
    s_add_u32 s67, s67, s68
    s_waitcnt lgkmcnt(9)
    v_mfma_f32_16x16x32_bf16 v[80:83], v[52:55], a[56:59], v[80:83]
    ds_read_b64_tr_b16 v[34:35], v226 offset:21888
    s_cmp_ge_u32 s67, s69
    s_cselect_b32 s67, s70, s67
    v_mfma_f32_16x16x32_bf16 v[100:103], v[52:55], a[60:63], v[100:103]
    s_waitcnt vmcnt(13) lgkmcnt(8)
    v_mfma_f32_16x16x32_bf16 v[64:67], v[16:19], a[64:67], v[64:67]
    ds_read_b64_tr_b16 v[36:37], v227 offset:25600
    ds_read_b64_tr_b16 v[38:39], v227 offset:26880
    s_add_u32 m0, s66, 102400
    s_waitcnt vmcnt(12)
    v_mfma_f32_16x16x32_bf16 v[84:87], v[16:19], a[68:71], v[84:87]
    ds_read_b64_tr_b16 v[40:41], v227 offset:25616
    s_waitcnt lgkmcnt(9)
    v_mfma_f32_16x16x32_bf16 v[68:71], v[20:23], a[64:67], v[68:71]
    ds_read_b64_tr_b16 v[42:43], v227 offset:26896
    buffer_load_dwordx4 v5, s[44:47], s67 offen offset:0  lds
    v_mfma_f32_16x16x32_bf16 v[88:91], v[20:23], a[68:71], v[88:91]
    ds_read_b64_tr_b16 v[44:45], v227 offset:25664
    s_waitcnt lgkmcnt(9)
    v_mfma_f32_16x16x32_bf16 v[72:75], v[24:27], a[64:67], v[72:75]
    ds_read_b64_tr_b16 v[46:47], v227 offset:26944
    buffer_load_dwordx4 v6, s[44:47], s67 offen offset:1024  lds
    v_mfma_f32_16x16x32_bf16 v[92:95], v[24:27], a[68:71], v[92:95]
    ds_read_b64_tr_b16 v[48:49], v227 offset:25680
    s_waitcnt lgkmcnt(9)
    v_mfma_f32_16x16x32_bf16 v[76:79], v[28:31], a[64:67], v[76:79]
    ds_read_b64_tr_b16 v[50:51], v227 offset:26960
    buffer_load_dwordx4 v7, s[44:47], s67 offen offset:2048  lds
    v_mfma_f32_16x16x32_bf16 v[96:99], v[28:31], a[68:71], v[96:99]
    ds_read_b64_tr_b16 v[52:53], v226 offset:25728
    s_waitcnt lgkmcnt(9)
    v_mfma_f32_16x16x32_bf16 v[80:83], v[32:35], a[64:67], v[80:83]
    ds_read_b64_tr_b16 v[54:55], v226 offset:27008
    v_mfma_f32_16x16x32_bf16 v[100:103], v[32:35], a[68:71], v[100:103]
    buffer_load_dwordx4 v8, s[44:47], s67 offen offset:3072  lds
    s_waitcnt vmcnt(15) lgkmcnt(8)
    v_mfma_f32_16x16x32_bf16 v[64:67], v[36:39], a[72:75], v[64:67]
    s_waitcnt vmcnt(14)
    v_mfma_f32_16x16x32_bf16 v[84:87], v[36:39], a[76:79], v[84:87]
    s_waitcnt lgkmcnt(6)
    v_mfma_f32_16x16x32_bf16 v[68:71], v[40:43], a[72:75], v[68:71]
    s_add_u32 m0, s66, 103424
    v_mfma_f32_16x16x32_bf16 v[88:91], v[40:43], a[76:79], v[88:91]
    buffer_load_dwordx4 v9, s[44:47], s67 offen offset:3072  lds
    s_waitcnt lgkmcnt(4)
    v_mfma_f32_16x16x32_bf16 v[72:75], v[44:47], a[72:75], v[72:75]
    v_mfma_f32_16x16x32_bf16 v[92:95], v[44:47], a[76:79], v[92:95]
    s_waitcnt lgkmcnt(2)
    v_mfma_f32_16x16x32_bf16 v[76:79], v[48:51], a[72:75], v[76:79]
    s_add_u32 s67, s67, s68
    v_mfma_f32_16x16x32_bf16 v[96:99], v[48:51], a[76:79], v[96:99]
    s_cmp_ge_u32 s67, s69
    s_cselect_b32 s67, s70, s67
    s_waitcnt lgkmcnt(0)
    v_mfma_f32_16x16x32_bf16 v[80:83], v[52:55], a[72:75], v[80:83]
    v_mfma_f32_16x16x32_bf16 v[100:103], v[52:55], a[76:79], v[100:103]
    ds_write_b128 v234, v[84:87] offset:0
    ds_write_b128 v234, v[88:91] offset:1024
    ds_write_b128 v234, v[92:95] offset:2048
    ds_write_b128 v234, v[96:99] offset:3072
    s_nop 3
    ds_write_b128 v234, v[100:103] offset:4096
    s_waitcnt lgkmcnt(0)
    s_barrier
    ds_read_b128 v[104:107], v235 offset:0
    ds_read_b128 v[108:111], v235 offset:1024
    ds_read_b128 v[112:115], v235 offset:2048
    ds_read_b128 v[116:119], v235 offset:3072
    ds_read_b128 v[120:123], v235 offset:4096
    s_waitcnt lgkmcnt(4)
    v_pk_add_f32 v[64:65], v[64:65], v[104:105]
    v_pk_add_f32 v[66:67], v[66:67], v[106:107]
    s_waitcnt lgkmcnt(3)
    v_pk_add_f32 v[68:69], v[68:69], v[108:109]
    v_pk_add_f32 v[70:71], v[70:71], v[110:111]
    s_waitcnt lgkmcnt(2)
    v_pk_add_f32 v[72:73], v[72:73], v[112:113]
    v_pk_add_f32 v[74:75], v[74:75], v[114:115]
    s_waitcnt lgkmcnt(1)
    v_pk_add_f32 v[76:77], v[76:77], v[116:117]
    v_pk_add_f32 v[78:79], v[78:79], v[118:119]
    s_waitcnt lgkmcnt(0)
    v_pk_add_f32 v[80:81], v[80:81], v[120:121]
    v_pk_add_f32 v[82:83], v[82:83], v[122:123]
    v_cvt_pk_bf16_f32 v212, v64, v65
    v_cvt_pk_bf16_f32 v213, v66, v67
    v_cvt_pk_bf16_f32 v214, v68, v69
    v_cvt_pk_bf16_f32 v215, v70, v71
    v_cvt_pk_bf16_f32 v216, v72, v73
    v_cvt_pk_bf16_f32 v217, v74, v75
    v_cvt_pk_bf16_f32 v218, v76, v77
    v_cvt_pk_bf16_f32 v219, v78, v79
    v_cvt_pk_bf16_f32 v220, v80, v81
    v_cvt_pk_bf16_f32 v221, v82, v83
    s_add_u32 s82, s38, 5242880
    s_add_u32 s83, s82, 4096
    buffer_store_dwordx4 v[212:215], v10, s[40:43], s82 offen sc1
    buffer_store_dwordx4 v[216:219], v10, s[40:43], s82 offen offset:2048 sc1
    buffer_store_dwordx2 v[220:221], v12, s[40:43], s83 offen sc1
    v_mov_b32 v26, 0x3f803f80
    v_mov_b32 v28, 0
    v_mov_b32 v29, 0
    v_dot2c_f32_bf16 v28, v212, v26
    v_dot2c_f32_bf16 v29, v212, v212
    v_dot2c_f32_bf16 v28, v213, v26
    v_dot2c_f32_bf16 v29, v213, v213
    v_dot2c_f32_bf16 v28, v214, v26
    v_dot2c_f32_bf16 v29, v214, v214
    v_dot2c_f32_bf16 v28, v215, v26
    v_dot2c_f32_bf16 v29, v215, v215
    v_dot2c_f32_bf16 v28, v216, v26
    v_dot2c_f32_bf16 v29, v216, v216
    v_dot2c_f32_bf16 v28, v217, v26
    v_dot2c_f32_bf16 v29, v217, v217
    v_dot2c_f32_bf16 v28, v218, v26
    v_dot2c_f32_bf16 v29, v218, v218
    v_dot2c_f32_bf16 v28, v219, v26
    v_dot2c_f32_bf16 v29, v219, v219
    v_dot2c_f32_bf16 v28, v220, v26
    v_dot2c_f32_bf16 v29, v220, v220
    v_dot2c_f32_bf16 v28, v221, v26
    v_dot2c_f32_bf16 v29, v221, v221
    s_nop 1
    v_mov_b32 v30, v28
    v_mov_b32 v31, v29
    s_nop 0
    v_permlane16_swap_b32 v28, v30
    v_permlane16_swap_b32 v29, v31
    v_add_f32 v28, v28, v30
    v_add_f32 v29, v29, v31
    v_mov_b32 v30, v28
    v_mov_b32 v31, v29
    s_nop 0
    v_permlane32_swap_b32 v28, v30
    v_permlane32_swap_b32 v29, v31
    v_add_f32 v28, v28, v30
    v_add_f32 v29, v29, v31
    s_lshl_b32 s82, s80, 1
    s_add_u32 s82, s82, s77
    s_lshl_b32 s82, s82, 7
    s_lshl_b32 s83, s81, 14
    s_add_u32 s82, s82, s83
    s_add_u32 s82, s82, 21823488
    buffer_store_dwordx2 v[28:29], v233, s[40:43], s82 offen sc1
    s_cmp_ge_u32 s62, 12
    s_cselect_b32 s82, 2621440, 0
    s_add_u32 s82, s82, s39
    s_add_u32 s82, s82, 5242880
    s_mov_b32 s76, s82
    s_add_u32 s75, s82, 40960
    s_mul_i32 s74, s99, 4096
    s_add_u32 s74, s74, s82
    s_mov_b32 s95, 22093824
    buffer_load_dword v144, v231, s[40:43], s95 offen sc1
    s_lshl_b32 s87, s81, 2
    s_add_u32 s87, s87, s60
    s_lshl_b32 s87, s87, 11
    s_add_u32 s87, s87, 21495808
    s_mul_i32 s86, s78, 40960
    s_sub_u32 s86, s38, s86
    s_lshl_b32 s88, s60, 10
    s_add_u32 s88, s88, s86
    s_add_u32 s88, s88, 0
    s_add_u32 s89, s88, 40960
    s_waitcnt vmcnt(1)
    s_barrier
    s_cmp_gt_u32 s60, 1
    s_cbranch_scc1 L_fs_18
    s_mov_b64 exec, 1
    s_cmp_eq_u32 s60, 0
    s_cbranch_scc1 L_fs_19
    s_lshl_b32 s93, s65, 2
    s_add_u32 s93, s93, 22088704
    buffer_store_dword v15, v4, s[40:43], s93 offen sc1
    s_branch L_fs_18
L_fs_19:
    s_lshl_b32 s92, s61, 9
    s_lshl_b32 s93, s62, 2
    s_add_u32 s92, s92, s93
    s_add_u32 s92, s92, 22020288
    buffer_store_dword v15, v4, s[40:43], s92 offen
L_fs_18:
    s_mov_b64 exec, -1
    s_waitcnt vmcnt(0)
    v_cmp_ne_u32 vcc, v144, v15
    s_cbranch_vccz L_fd_20
    s_mov_b32 s94, 0
    s_mov_b32 s95, 22093824
L_fl_21:
    s_sleep 3
    buffer_load_dword v144, v231, s[40:43], s95 offen sc1
    s_add_u32 s94, s94, 1
    s_waitcnt vmcnt(0)
    v_cmp_ne_u32 vcc, v144, v15
    s_cbranch_vccz L_fd_20
    s_cmp_lt_u32 s94, 400000
    s_cbranch_scc1 L_fl_21
L_fd_20:
    buffer_load_dwordx4 v[128:131], v236, s[40:43], s87 offen sc1
    buffer_load_dwordx4 v[132:135], v237, s[40:43], s87 offen sc1
    buffer_load_dwordx4 v[136:139], v238, s[40:43], s87 offen sc1
    buffer_load_dwordx4 v[140:143], v239, s[40:43], s87 offen sc1
    buffer_load_dwordx4 v[160:163], v4, s[40:43], s88 offen offset:0 sc1
    buffer_load_dwordx4 v[164:167], v4, s[40:43], s88 offen offset:1024 sc1
    buffer_load_dwordx4 v[168:171], v4, s[40:43], s89 offen offset:0 sc1
    buffer_load_dwordx4 v[172:175], v4, s[40:43], s89 offen offset:1024 sc1
    s_cmp_ge_u32 s62, 12
    s_cbranch_scc1 L_rs_22
    v_bfe_u32 v56, v0, 2, 2
    v_lshrrev_b32 v57, 5, v0
    v_lshl_add_u32 v58, v57, 2, v56
    v_mul_u32_u24 v58, 256, v58
    v_bfe_u32 v57, v0, 4, 1
    v_lshl_add_u32 v58, v57, 5, v58
    v_and_b32 v57, 3, v0
    v_lshl_add_u32 v58, v57, 3, v58
    v_lshl_add_u32 v58, v56, 6, v58
    v_add_u32 v148, 0, v58
    v_xor_b32 v149, 64, v148
    v_xor_b32 v150, 128, v148
    v_xor_b32 v151, 192, v148
    v_add_u32 v152, 61440, v58
    v_xor_b32 v153, 64, v152
    v_xor_b32 v154, 128, v152
    v_xor_b32 v155, 192, v152
    v_add_u32 v156, 122880, v58
    v_xor_b32 v157, 64, v156
    v_xor_b32 v158, 128, v156
    v_xor_b32 v159, 192, v156
    s_branch L_rs_23
L_rs_22:
    v_bfe_u32 v56, v0, 2, 2
    v_lshrrev_b32 v57, 5, v0
    v_lshl_add_u32 v58, v57, 2, v56
    v_mul_u32_u24 v58, 320, v58
    v_bfe_u32 v57, v0, 4, 1
    v_lshl_add_u32 v58, v57, 5, v58
    v_and_b32 v57, 3, v0
    v_lshl_add_u32 v58, v57, 3, v58
    v_add_u32 v148, 0, v58
    v_add_u32 v149, 61440, v58
    v_add_u32 v150, 122880, v58
L_rs_23:
    s_mul_i32 s83, s77, 3072
    s_add_u32 s82, s38, s83
    s_add_u32 s82, s82, 7864320
    s_cmp_eq_u32 s77, 0
    s_cselect_b32 s83, s82, 1073741824
    s_mov_b32 s90, s82
    s_mov_b32 s91, s83
    s_cmp_ge_u32 s62, 12
    s_cbranch_scc1 L_p3_s
    s_cmp_lg_u32 s60, 0
    s_cbranch_scc1 L_wd_24
    s_mov_b32 s84, 3
    v_lshlrev_b32 v1, 2, v0
    s_lshl_b32 s82, s61, 9
    s_lshl_b32 s83, s84, 6
    s_add_u32 s82, s82, s83
    s_add_u32 s82, s82, 22020096
    s_mov_b64 exec, 65535
    s_mov_b32 s85, 0
    s_cmp_eq_u32 s64, 0
    s_cbranch_scc1 L_wsl_25
L_wf_26:
    buffer_load_dword v2, v1, s[40:43], s82 offen sc1
    s_add_u32 s85, s85, 1
    s_waitcnt vmcnt(0)
    v_cmp_ne_u32 vcc, v2, v15
    s_cbranch_vccz L_wd_24
    s_cmp_lt_u32 s85, 96
    s_cbranch_scc1 L_wf_26
    s_mov_b32 s64, 0
L_wsl_25:
    s_lshl_b32 s82, s61, 6
    s_lshl_b32 s83, s84, 10
    s_add_u32 s82, s82, s83
    s_add_u32 s82, s82, 22085632
L_ws_27:
    buffer_load_dword v2, v1, s[40:43], s82 offen sc1
    s_add_u32 s85, s85, 1
    s_waitcnt vmcnt(0)
    v_cmp_ne_u32 vcc, v2, v15
    s_cbranch_vccz L_wd_24
    s_cmp_lt_u32 s85, 400000
    s_cbranch_scc1 L_ws_27
L_wd_24:
    s_mov_b64 exec, -1
    s_barrier
    buffer_load_dwordx4 a[0:3], v4, s[40:43], s74 offen offset:0 sc1
    buffer_load_dwordx4 a[4:7], v4, s[40:43], s74 offen offset:1024 sc1
    buffer_load_dwordx4 a[8:11], v4, s[40:43], s74 offen offset:2048 sc1
    buffer_load_dwordx4 a[12:15], v4, s[40:43], s74 offen offset:3072 sc1
    s_add_u32 s74, s74, 4096
    s_cmp_ge_u32 s74, s75
    s_cselect_b32 s74, s76, s74
    buffer_load_dwordx4 a[16:19], v4, s[40:43], s74 offen offset:0 sc1
    buffer_load_dwordx4 a[20:23], v4, s[40:43], s74 offen offset:1024 sc1
    buffer_load_dwordx4 a[24:27], v4, s[40:43], s74 offen offset:2048 sc1
    buffer_load_dwordx4 a[28:31], v4, s[40:43], s74 offen offset:3072 sc1
    s_add_u32 s74, s74, 4096
    s_cmp_ge_u32 s74, s75
    s_cselect_b32 s74, s76, s74
    s_waitcnt vmcnt(15)
    v_cvt_pk_bf16_f32 v32, v128, v129
    v_cvt_pk_bf16_f32 v33, v130, v131
    s_waitcnt vmcnt(14)
    v_cvt_pk_bf16_f32 v34, v132, v133
    v_cvt_pk_bf16_f32 v35, v134, v135
    s_waitcnt vmcnt(13)
    v_cvt_pk_bf16_f32 v36, v136, v137
    v_cvt_pk_bf16_f32 v37, v138, v139
    s_waitcnt vmcnt(12)
    v_cvt_pk_bf16_f32 v38, v140, v141
    v_cvt_pk_bf16_f32 v39, v142, v143
    s_waitcnt vmcnt(11)
    v_mfma_f32_32x32x16_bf16 v[64:79], v[32:35], v[160:163], 0
    s_waitcnt vmcnt(10)
    v_mfma_f32_32x32x16_bf16 v[64:79], v[36:39], v[164:167], v[64:79]
    s_waitcnt vmcnt(9)
    v_mfma_f32_32x32x16_bf16 v[80:95], v[32:35], v[168:171], 0
    s_waitcnt vmcnt(8)
    v_mfma_f32_32x32x16_bf16 v[80:95], v[36:39], v[172:175], v[80:95]
    s_nop 7
    v_add_f32 v76, 0x358637bd, v76
    v_rcp_f32 v76, v76
    s_nop 0
    v_pk_mul_f32 v[64:65], v[64:65], v[76:77] op_sel_hi:[1,0]
    v_pk_mul_f32 v[66:67], v[66:67], v[76:77] op_sel_hi:[1,0]
    v_pk_mul_f32 v[68:69], v[68:69], v[76:77] op_sel_hi:[1,0]
    v_pk_mul_f32 v[70:71], v[70:71], v[76:77] op_sel_hi:[1,0]
    v_pk_mul_f32 v[72:73], v[72:73], v[76:77] op_sel_hi:[1,0]
    v_pk_mul_f32 v[74:75], v[74:75], v[76:77] op_sel_hi:[1,0]
    v_cvt_pk_bf16_f32 v16, v64, v65
    v_cvt_pk_bf16_f32 v17, v66, v67
    v_cvt_pk_bf16_f32 v18, v68, v69
    v_cvt_pk_bf16_f32 v19, v70, v71
    v_cvt_pk_bf16_f32 v20, v72, v73
    v_cvt_pk_bf16_f32 v21, v74, v75
    ds_write_b64 v228, v[16:17] offset:0
    ds_write_b64 v229, v[18:19] offset:0
    ds_write_b64 v230, v[20:21] offset:0
    v_add_f32 v92, 0x358637bd, v92
    v_rcp_f32 v92, v92
    s_nop 0
    v_pk_mul_f32 v[80:81], v[80:81], v[92:93] op_sel_hi:[1,0]
    v_pk_mul_f32 v[82:83], v[82:83], v[92:93] op_sel_hi:[1,0]
    v_pk_mul_f32 v[84:85], v[84:85], v[92:93] op_sel_hi:[1,0]
    v_pk_mul_f32 v[86:87], v[86:87], v[92:93] op_sel_hi:[1,0]
    v_pk_mul_f32 v[88:89], v[88:89], v[92:93] op_sel_hi:[1,0]
    v_pk_mul_f32 v[90:91], v[90:91], v[92:93] op_sel_hi:[1,0]
    v_cvt_pk_bf16_f32 v22, v80, v81
    v_cvt_pk_bf16_f32 v23, v82, v83
    v_cvt_pk_bf16_f32 v24, v84, v85
    v_cvt_pk_bf16_f32 v25, v86, v87
    v_cvt_pk_bf16_f32 v26, v88, v89
    v_cvt_pk_bf16_f32 v27, v90, v91
    ds_write_b64 v228, v[22:23] offset:5120
    ds_write_b64 v229, v[24:25] offset:5120
    ds_write_b64 v230, v[26:27] offset:5120
    s_waitcnt lgkmcnt(0)
    s_barrier
    ds_read_b64_tr_b16 v[16:17], v156 offset:20480
    ds_read_b64_tr_b16 v[18:19], v156 offset:22528
    ds_read_b64_tr_b16 v[20:21], v157 offset:20480
    ds_read_b64_tr_b16 v[22:23], v157 offset:22528
    ds_read_b64_tr_b16 v[24:25], v158 offset:20480
    ds_read_b64_tr_b16 v[26:27], v158 offset:22528
    ds_read_b64_tr_b16 v[28:29], v159 offset:20480
    ds_read_b64_tr_b16 v[30:31], v159 offset:22528
    ds_read_b128 v[128:131], v232 offset:0
    ds_read_b128 v[132:135], v232 offset:1024
    ds_read_b128 v[136:139], v232 offset:2048
    s_waitcnt lgkmcnt(2)
    buffer_store_dwordx4 v[128:131], v4, s[40:43], s90 offen offset:0 sc1
    s_waitcnt lgkmcnt(1)
    buffer_store_dwordx4 v[132:135], v4, s[40:43], s90 offen offset:1024 sc1
    s_waitcnt lgkmcnt(0)
    buffer_store_dwordx4 v[136:139], v4, s[40:43], s91 offen offset:2048 sc1
    s_waitcnt vmcnt(10)
    v_mfma_f32_32x32x16_bf16 v[64:79], v[16:19], a[0:3], 0
    ds_read_b64_tr_b16 v[36:37], v156 offset:25600
    ds_read_b64_tr_b16 v[38:39], v156 offset:27648
    ds_read_b64_tr_b16 v[40:41], v157 offset:25600
    buffer_load_dwordx4 a[32:35], v4, s[40:43], s74 offen offset:0 sc1
    v_mfma_f32_32x32x16_bf16 v[80:95], v[20:23], a[0:3], 0
    ds_read_b64_tr_b16 v[42:43], v157 offset:27648
    ds_read_b64_tr_b16 v[44:45], v158 offset:25600
    ds_read_b64_tr_b16 v[46:47], v158 offset:27648
    buffer_load_dwordx4 a[36:39], v4, s[40:43], s74 offen offset:1024 sc1
    v_mfma_f32_32x32x16_bf16 v[96:111], v[24:27], a[0:3], 0
    ds_read_b64_tr_b16 v[48:49], v159 offset:25600
    ds_read_b64_tr_b16 v[50:51], v159 offset:27648
    buffer_load_dwordx4 a[40:43], v4, s[40:43], s74 offen offset:2048 sc1
    v_mfma_f32_32x32x16_bf16 v[112:127], v[28:31], a[0:3], 0
    buffer_load_dwordx4 a[44:47], v4, s[40:43], s74 offen offset:3072 sc1
    s_waitcnt vmcnt(13) lgkmcnt(6)
    v_mfma_f32_32x32x16_bf16 v[64:79], v[36:39], a[4:7], v[64:79]
    ds_read_b64_tr_b16 v[16:17], v156 offset:30720
    ds_read_b64_tr_b16 v[18:19], v156 offset:32768
    ds_read_b64_tr_b16 v[20:21], v157 offset:30720
    s_add_u32 s74, s74, 4096
    s_waitcnt lgkmcnt(7)
    v_mfma_f32_32x32x16_bf16 v[80:95], v[40:43], a[4:7], v[80:95]
    ds_read_b64_tr_b16 v[22:23], v157 offset:32768
    ds_read_b64_tr_b16 v[24:25], v158 offset:30720
    ds_read_b64_tr_b16 v[26:27], v158 offset:32768
    s_cmp_ge_u32 s74, s75
    s_cselect_b32 s74, s76, s74
    s_waitcnt lgkmcnt(8)
    v_mfma_f32_32x32x16_bf16 v[96:111], v[44:47], a[4:7], v[96:111]
    ds_read_b64_tr_b16 v[28:29], v159 offset:30720
    ds_read_b64_tr_b16 v[30:31], v159 offset:32768
    s_add_u32 m0, s66, 20480
    s_waitcnt lgkmcnt(8)
    v_mfma_f32_32x32x16_bf16 v[112:127], v[48:51], a[4:7], v[112:127]
    buffer_load_dwordx4 v5, s[44:47], s67 offen offset:0  lds
    s_waitcnt vmcnt(13) lgkmcnt(6)
    v_mfma_f32_32x32x16_bf16 v[64:79], v[16:19], a[8:11], v[64:79]
    ds_read_b64_tr_b16 v[36:37], v156 offset:35840
    ds_read_b64_tr_b16 v[38:39], v156 offset:37888
    ds_read_b64_tr_b16 v[40:41], v157 offset:35840
    buffer_load_dwordx4 v6, s[44:47], s67 offen offset:1024  lds
    s_waitcnt lgkmcnt(7)
    v_mfma_f32_32x32x16_bf16 v[80:95], v[20:23], a[8:11], v[80:95]
    ds_read_b64_tr_b16 v[42:43], v157 offset:37888
    ds_read_b64_tr_b16 v[44:45], v158 offset:35840
    ds_read_b64_tr_b16 v[46:47], v158 offset:37888
    buffer_load_dwordx4 v7, s[44:47], s67 offen offset:2048  lds
    s_waitcnt lgkmcnt(8)
    v_mfma_f32_32x32x16_bf16 v[96:111], v[24:27], a[8:11], v[96:111]
    ds_read_b64_tr_b16 v[48:49], v159 offset:35840
    ds_read_b64_tr_b16 v[50:51], v159 offset:37888
    s_waitcnt lgkmcnt(8)
    v_mfma_f32_32x32x16_bf16 v[112:127], v[28:31], a[8:11], v[112:127]
    buffer_load_dwordx4 v8, s[44:47], s67 offen offset:3072  lds
    s_waitcnt vmcnt(15) lgkmcnt(6)
    v_mfma_f32_32x32x16_bf16 v[64:79], v[36:39], a[12:15], v[64:79]
    s_barrier
    ds_read_b64_tr_b16 v[16:17], v156 offset:0
    ds_read_b64_tr_b16 v[18:19], v156 offset:2048
    s_add_u32 m0, s66, 21504
    s_waitcnt lgkmcnt(6)
    v_mfma_f32_32x32x16_bf16 v[80:95], v[40:43], a[12:15], v[80:95]
    ds_read_b64_tr_b16 v[20:21], v157 offset:0
    ds_read_b64_tr_b16 v[22:23], v157 offset:2048
    ds_read_b64_tr_b16 v[24:25], v158 offset:0
    ds_read_b64_tr_b16 v[26:27], v158 offset:2048
    buffer_load_dwordx4 v9, s[44:47], s67 offen offset:3072  lds
    s_waitcnt lgkmcnt(8)
    v_mfma_f32_32x32x16_bf16 v[96:111], v[44:47], a[12:15], v[96:111]
    ds_read_b64_tr_b16 v[28:29], v159 offset:0
    ds_read_b64_tr_b16 v[30:31], v159 offset:2048
    s_add_u32 s67, s67, s68
    s_cmp_ge_u32 s67, s69
    s_cselect_b32 s67, s70, s67
    s_waitcnt lgkmcnt(8)
    v_mfma_f32_32x32x16_bf16 v[112:127], v[48:51], a[12:15], v[112:127]
    s_waitcnt vmcnt(15) lgkmcnt(6)
    v_mfma_f32_32x32x16_bf16 v[64:79], v[16:19], a[16:19], v[64:79]
    ds_read_b64_tr_b16 v[36:37], v156 offset:5120
    ds_read_b64_tr_b16 v[38:39], v156 offset:7168
    ds_read_b64_tr_b16 v[40:41], v157 offset:5120
    buffer_load_dwordx4 a[48:51], v4, s[40:43], s74 offen offset:0 sc1
    s_waitcnt lgkmcnt(7)
    v_mfma_f32_32x32x16_bf16 v[80:95], v[20:23], a[16:19], v[80:95]
    ds_read_b64_tr_b16 v[42:43], v157 offset:7168
    ds_read_b64_tr_b16 v[44:45], v158 offset:5120
    ds_read_b64_tr_b16 v[46:47], v158 offset:7168
    buffer_load_dwordx4 a[52:55], v4, s[40:43], s74 offen offset:1024 sc1
    s_waitcnt lgkmcnt(8)
    v_mfma_f32_32x32x16_bf16 v[96:111], v[24:27], a[16:19], v[96:111]
    ds_read_b64_tr_b16 v[48:49], v159 offset:5120
    ds_read_b64_tr_b16 v[50:51], v159 offset:7168
    buffer_load_dwordx4 a[56:59], v4, s[40:43], s74 offen offset:2048 sc1
    s_waitcnt lgkmcnt(8)
    v_mfma_f32_32x32x16_bf16 v[112:127], v[28:31], a[16:19], v[112:127]
    buffer_load_dwordx4 a[60:63], v4, s[40:43], s74 offen offset:3072 sc1
    s_waitcnt vmcnt(18) lgkmcnt(6)
    v_mfma_f32_32x32x16_bf16 v[64:79], v[36:39], a[20:23], v[64:79]
    s_waitcnt vmcnt(13)
    s_barrier
    s_cmp_gt_u32 s60, 1
    s_cbranch_scc1 L_fs_28
    s_mov_b64 exec, 1
    s_cmp_eq_u32 s60, 0
    s_cbranch_scc1 L_fs_29
    s_lshl_b32 s93, s65, 2
    s_add_u32 s93, s93, 22089728
    buffer_store_dword v15, v4, s[40:43], s93 offen sc1
    s_branch L_fs_28
L_fs_29:
    s_lshl_b32 s92, s61, 9
    s_lshl_b32 s93, s62, 2
    s_add_u32 s92, s92, s93
    s_add_u32 s92, s92, 22020352
    buffer_store_dword v15, v4, s[40:43], s92 offen
L_fs_28:
    s_mov_b64 exec, -1
    s_waitcnt lgkmcnt(4)
    v_mfma_f32_32x32x16_bf16 v[80:95], v[40:43], a[20:23], v[80:95]
    ds_read_b64_tr_b16 v[16:17], v156 offset:10240
    ds_read_b64_tr_b16 v[18:19], v156 offset:12288
    ds_read_b64_tr_b16 v[20:21], v157 offset:10240
    ds_read_b64_tr_b16 v[22:23], v157 offset:12288
    ds_read_b64_tr_b16 v[24:25], v158 offset:10240
    s_add_u32 s74, s74, 4096
    s_waitcnt lgkmcnt(7)
    v_mfma_f32_32x32x16_bf16 v[96:111], v[44:47], a[20:23], v[96:111]
    ds_read_b64_tr_b16 v[26:27], v158 offset:12288
    ds_read_b64_tr_b16 v[28:29], v159 offset:10240
    ds_read_b64_tr_b16 v[30:31], v159 offset:12288
    s_cmp_ge_u32 s74, s75
    s_cselect_b32 s74, s76, s74
    s_add_u32 m0, s66, 40960
    s_waitcnt lgkmcnt(8)
    v_mfma_f32_32x32x16_bf16 v[112:127], v[48:51], a[20:23], v[112:127]
    buffer_load_dwordx4 v5, s[44:47], s67 offen offset:0  lds
    s_waitcnt lgkmcnt(6)
    v_mfma_f32_32x32x16_bf16 v[64:79], v[16:19], a[24:27], v[64:79]
    ds_read_b64_tr_b16 v[36:37], v156 offset:15360
    ds_read_b64_tr_b16 v[38:39], v156 offset:17408
    ds_read_b64_tr_b16 v[40:41], v157 offset:15360
    buffer_load_dwordx4 v6, s[44:47], s67 offen offset:1024  lds
    s_waitcnt lgkmcnt(7)
    v_mfma_f32_32x32x16_bf16 v[80:95], v[20:23], a[24:27], v[80:95]
    ds_read_b64_tr_b16 v[42:43], v157 offset:17408
    ds_read_b64_tr_b16 v[44:45], v158 offset:15360
    ds_read_b64_tr_b16 v[46:47], v158 offset:17408
    buffer_load_dwordx4 v7, s[44:47], s67 offen offset:2048  lds
    s_waitcnt lgkmcnt(8)
    v_mfma_f32_32x32x16_bf16 v[96:111], v[24:27], a[24:27], v[96:111]
    ds_read_b64_tr_b16 v[48:49], v159 offset:15360
    ds_read_b64_tr_b16 v[50:51], v159 offset:17408
    s_waitcnt lgkmcnt(8)
    v_mfma_f32_32x32x16_bf16 v[112:127], v[28:31], a[24:27], v[112:127]
    buffer_load_dwordx4 v8, s[44:47], s67 offen offset:3072  lds
    s_waitcnt lgkmcnt(6)
    v_mfma_f32_32x32x16_bf16 v[64:79], v[36:39], a[28:31], v[64:79]
    s_barrier
    ds_read_b64_tr_b16 v[16:17], v152 offset:40960
    ds_read_b64_tr_b16 v[18:19], v152 offset:43008
    s_add_u32 m0, s66, 41984
    s_waitcnt lgkmcnt(6)
    v_mfma_f32_32x32x16_bf16 v[80:95], v[40:43], a[28:31], v[80:95]
    ds_read_b64_tr_b16 v[20:21], v153 offset:40960
    ds_read_b64_tr_b16 v[22:23], v153 offset:43008
    ds_read_b64_tr_b16 v[24:25], v154 offset:40960
    ds_read_b64_tr_b16 v[26:27], v154 offset:43008
    buffer_load_dwordx4 v9, s[44:47], s67 offen offset:3072  lds
    s_waitcnt lgkmcnt(8)
    v_mfma_f32_32x32x16_bf16 v[96:111], v[44:47], a[28:31], v[96:111]
    ds_read_b64_tr_b16 v[28:29], v155 offset:40960
    ds_read_b64_tr_b16 v[30:31], v155 offset:43008
    s_add_u32 s67, s67, s68
    s_cmp_ge_u32 s67, s69
    s_cselect_b32 s67, s70, s67
    s_waitcnt lgkmcnt(8)
    v_mfma_f32_32x32x16_bf16 v[112:127], v[48:51], a[28:31], v[112:127]
    s_waitcnt vmcnt(17) lgkmcnt(6)
    v_mfma_f32_32x32x16_bf16 v[64:79], v[16:19], a[32:35], v[64:79]
    ds_read_b64_tr_b16 v[36:37], v152 offset:46080
    ds_read_b64_tr_b16 v[38:39], v152 offset:48128
    ds_read_b64_tr_b16 v[40:41], v153 offset:46080
    buffer_load_dwordx4 a[64:67], v4, s[40:43], s74 offen offset:0 sc1
    s_waitcnt lgkmcnt(7)
    v_mfma_f32_32x32x16_bf16 v[80:95], v[20:23], a[32:35], v[80:95]
    ds_read_b64_tr_b16 v[42:43], v153 offset:48128
    ds_read_b64_tr_b16 v[44:45], v154 offset:46080
    ds_read_b64_tr_b16 v[46:47], v154 offset:48128
    buffer_load_dwordx4 a[68:71], v4, s[40:43], s74 offen offset:1024 sc1
    s_waitcnt lgkmcnt(8)
    v_mfma_f32_32x32x16_bf16 v[96:111], v[24:27], a[32:35], v[96:111]
    ds_read_b64_tr_b16 v[48:49], v155 offset:46080
    ds_read_b64_tr_b16 v[50:51], v155 offset:48128
    buffer_load_dwordx4 a[72:75], v4, s[40:43], s74 offen offset:2048 sc1
    s_waitcnt lgkmcnt(8)
    v_mfma_f32_32x32x16_bf16 v[112:127], v[28:31], a[32:35], v[112:127]
    buffer_load_dwordx4 a[76:79], v4, s[40:43], s74 offen offset:3072 sc1
    s_waitcnt vmcnt(20) lgkmcnt(6)
    v_mfma_f32_32x32x16_bf16 v[64:79], v[36:39], a[36:39], v[64:79]
    ds_read_b64_tr_b16 v[16:17], v152 offset:51200
    ds_read_b64_tr_b16 v[18:19], v152 offset:53248
    ds_read_b64_tr_b16 v[20:21], v153 offset:51200
    s_add_u32 s74, s74, 4096
    s_waitcnt lgkmcnt(7)
    v_mfma_f32_32x32x16_bf16 v[80:95], v[40:43], a[36:39], v[80:95]
    ds_read_b64_tr_b16 v[22:23], v153 offset:53248
    ds_read_b64_tr_b16 v[24:25], v154 offset:51200
    ds_read_b64_tr_b16 v[26:27], v154 offset:53248
    s_cmp_ge_u32 s74, s75
    s_cselect_b32 s74, s76, s74
    s_waitcnt lgkmcnt(8)
    v_mfma_f32_32x32x16_bf16 v[96:111], v[44:47], a[36:39], v[96:111]
    ds_read_b64_tr_b16 v[28:29], v155 offset:51200
    ds_read_b64_tr_b16 v[30:31], v155 offset:53248
    s_add_u32 m0, s66, 61440
    s_waitcnt lgkmcnt(8)
    v_mfma_f32_32x32x16_bf16 v[112:127], v[48:51], a[36:39], v[112:127]
    buffer_load_dwordx4 v5, s[44:47], s67 offen offset:0  lds
    s_waitcnt vmcnt(20) lgkmcnt(6)
    v_mfma_f32_32x32x16_bf16 v[64:79], v[16:19], a[40:43], v[64:79]
    ds_read_b64_tr_b16 v[36:37], v152 offset:56320
    ds_read_b64_tr_b16 v[38:39], v152 offset:58368
    ds_read_b64_tr_b16 v[40:41], v153 offset:56320
    buffer_load_dwordx4 v6, s[44:47], s67 offen offset:1024  lds
    s_waitcnt lgkmcnt(7)
    v_mfma_f32_32x32x16_bf16 v[80:95], v[20:23], a[40:43], v[80:95]
    ds_read_b64_tr_b16 v[42:43], v153 offset:58368
    ds_read_b64_tr_b16 v[44:45], v154 offset:56320
    ds_read_b64_tr_b16 v[46:47], v154 offset:58368
    buffer_load_dwordx4 v7, s[44:47], s67 offen offset:2048  lds
    s_waitcnt lgkmcnt(8)
    v_mfma_f32_32x32x16_bf16 v[96:111], v[24:27], a[40:43], v[96:111]
    ds_read_b64_tr_b16 v[48:49], v155 offset:56320
    ds_read_b64_tr_b16 v[50:51], v155 offset:58368
    s_waitcnt lgkmcnt(8)
    v_mfma_f32_32x32x16_bf16 v[112:127], v[28:31], a[40:43], v[112:127]
    buffer_load_dwordx4 v8, s[44:47], s67 offen offset:3072  lds
    s_waitcnt vmcnt(22) lgkmcnt(6)
    v_mfma_f32_32x32x16_bf16 v[64:79], v[36:39], a[44:47], v[64:79]
    s_waitcnt vmcnt(17)
    s_barrier
    ds_read_b64_tr_b16 v[16:17], v148 offset:20480
    ds_read_b64_tr_b16 v[18:19], v148 offset:22528
    s_add_u32 m0, s66, 62464
    s_waitcnt lgkmcnt(6)
    v_mfma_f32_32x32x16_bf16 v[80:95], v[40:43], a[44:47], v[80:95]
    ds_read_b64_tr_b16 v[20:21], v149 offset:20480
    ds_read_b64_tr_b16 v[22:23], v149 offset:22528
    ds_read_b64_tr_b16 v[24:25], v150 offset:20480
    ds_read_b64_tr_b16 v[26:27], v150 offset:22528
    buffer_load_dwordx4 v9, s[44:47], s67 offen offset:3072  lds
    s_waitcnt lgkmcnt(8)
    v_mfma_f32_32x32x16_bf16 v[96:111], v[44:47], a[44:47], v[96:111]
    ds_read_b64_tr_b16 v[28:29], v151 offset:20480
    ds_read_b64_tr_b16 v[30:31], v151 offset:22528
    s_add_u32 s67, s67, s68
    s_cmp_ge_u32 s67, s69
    s_cselect_b32 s67, s70, s67
    s_waitcnt lgkmcnt(8)
    v_mfma_f32_32x32x16_bf16 v[112:127], v[48:51], a[44:47], v[112:127]
    s_waitcnt vmcnt(17) lgkmcnt(6)
    v_mfma_f32_32x32x16_bf16 v[64:79], v[16:19], a[48:51], v[64:79]
    ds_read_b64_tr_b16 v[36:37], v148 offset:25600
    ds_read_b64_tr_b16 v[38:39], v148 offset:27648
    ds_read_b64_tr_b16 v[40:41], v149 offset:25600
    buffer_load_dwordx4 a[80:83], v4, s[40:43], s74 offen offset:0 sc1
    s_waitcnt lgkmcnt(7)
    v_mfma_f32_32x32x16_bf16 v[80:95], v[20:23], a[48:51], v[80:95]
    ds_read_b64_tr_b16 v[42:43], v149 offset:27648
    ds_read_b64_tr_b16 v[44:45], v150 offset:25600
    ds_read_b64_tr_b16 v[46:47], v150 offset:27648
    buffer_load_dwordx4 a[84:87], v4, s[40:43], s74 offen offset:1024 sc1
    s_waitcnt lgkmcnt(8)
    v_mfma_f32_32x32x16_bf16 v[96:111], v[24:27], a[48:51], v[96:111]
    ds_read_b64_tr_b16 v[48:49], v151 offset:25600
    ds_read_b64_tr_b16 v[50:51], v151 offset:27648
    buffer_load_dwordx4 a[88:91], v4, s[40:43], s74 offen offset:2048 sc1
    buffer_load_dwordx4 a[92:95], v4, s[40:43], s74 offen offset:3072 sc1
    s_waitcnt lgkmcnt(8)
    v_mfma_f32_32x32x16_bf16 v[112:127], v[28:31], a[48:51], v[112:127]
    s_add_u32 s74, s74, 4096
    s_waitcnt vmcnt(20) lgkmcnt(6)
    v_mfma_f32_32x32x16_bf16 v[64:79], v[36:39], a[52:55], v[64:79]
    ds_read_b64_tr_b16 v[16:17], v148 offset:30720
    ds_read_b64_tr_b16 v[18:19], v148 offset:32768
    ds_read_b64_tr_b16 v[20:21], v149 offset:30720
    s_cmp_ge_u32 s74, s75
    s_cselect_b32 s74, s76, s74
    s_waitcnt lgkmcnt(7)
    v_mfma_f32_32x32x16_bf16 v[80:95], v[40:43], a[52:55], v[80:95]
    ds_read_b64_tr_b16 v[22:23], v149 offset:32768
    ds_read_b64_tr_b16 v[24:25], v150 offset:30720
    ds_read_b64_tr_b16 v[26:27], v150 offset:32768
    s_add_u32 m0, s66, 81920
    s_nop 0
    buffer_load_dwordx4 v5, s[44:47], s67 offen offset:0  lds
    s_waitcnt lgkmcnt(8)
    v_mfma_f32_32x32x16_bf16 v[96:111], v[44:47], a[52:55], v[96:111]
    ds_read_b64_tr_b16 v[28:29], v151 offset:30720
    ds_read_b64_tr_b16 v[30:31], v151 offset:32768
    buffer_load_dwordx4 v6, s[44:47], s67 offen offset:1024  lds
    s_waitcnt lgkmcnt(8)
    v_mfma_f32_32x32x16_bf16 v[112:127], v[48:51], a[52:55], v[112:127]
    buffer_load_dwordx4 v7, s[44:47], s67 offen offset:2048  lds
    s_waitcnt vmcnt(22) lgkmcnt(6)
    v_mfma_f32_32x32x16_bf16 v[64:79], v[16:19], a[56:59], v[64:79]
    ds_read_b64_tr_b16 v[36:37], v148 offset:35840
    ds_read_b64_tr_b16 v[38:39], v148 offset:37888
    ds_read_b64_tr_b16 v[40:41], v149 offset:35840
    buffer_load_dwordx4 v8, s[44:47], s67 offen offset:3072  lds
    s_waitcnt lgkmcnt(7)
    v_mfma_f32_32x32x16_bf16 v[80:95], v[20:23], a[56:59], v[80:95]
    ds_read_b64_tr_b16 v[42:43], v149 offset:37888
    ds_read_b64_tr_b16 v[44:45], v150 offset:35840
    ds_read_b64_tr_b16 v[46:47], v150 offset:37888
    s_add_u32 m0, s66, 82944
    s_waitcnt lgkmcnt(8)
    v_mfma_f32_32x32x16_bf16 v[96:111], v[24:27], a[56:59], v[96:111]
    ds_read_b64_tr_b16 v[48:49], v151 offset:35840
    ds_read_b64_tr_b16 v[50:51], v151 offset:37888
    buffer_load_dwordx4 v9, s[44:47], s67 offen offset:3072  lds
    s_waitcnt lgkmcnt(8)
    v_mfma_f32_32x32x16_bf16 v[112:127], v[28:31], a[56:59], v[112:127]
    s_add_u32 s67, s67, s68
    s_cmp_ge_u32 s67, s69
    s_cselect_b32 s67, s70, s67
    s_waitcnt vmcnt(23) lgkmcnt(6)
    v_mfma_f32_32x32x16_bf16 v[64:79], v[36:39], a[60:63], v[64:79]
    s_waitcnt vmcnt(18)
    s_barrier
    ds_read_b64_tr_b16 v[16:17], v148 offset:40960
    ds_read_b64_tr_b16 v[18:19], v148 offset:43008
    v_lshrrev_b32 v1, 2, v0
    s_waitcnt lgkmcnt(6)
    v_mfma_f32_32x32x16_bf16 v[80:95], v[40:43], a[60:63], v[80:95]
    ds_read_b64_tr_b16 v[20:21], v149 offset:40960
    ds_read_b64_tr_b16 v[22:23], v149 offset:43008
    ds_read_b64_tr_b16 v[24:25], v150 offset:40960
    ds_read_b64_tr_b16 v[26:27], v150 offset:43008
    v_lshlrev_b32 v1, 7, v1
    v_and_b32 v2, 3, v0
    s_waitcnt lgkmcnt(8)
    v_mfma_f32_32x32x16_bf16 v[96:111], v[44:47], a[60:63], v[96:111]
    ds_read_b64_tr_b16 v[28:29], v151 offset:40960
    ds_read_b64_tr_b16 v[30:31], v151 offset:43008
    v_lshl_add_u32 v1, v2, 4, v1
    v_min_u32 v1, 1456, v1
    s_waitcnt lgkmcnt(8)
    v_mfma_f32_32x32x16_bf16 v[112:127], v[48:51], a[60:63], v[112:127]
    s_mov_b32 s95, 22093824
    buffer_load_dwordx4 v[144:147], v1, s[40:43], s95 offen sc1
    s_waitcnt vmcnt(18) lgkmcnt(6)
    v_mfma_f32_32x32x16_bf16 v[64:79], v[16:19], a[64:67], v[64:79]
    ds_read_b64_tr_b16 v[36:37], v148 offset:46080
    ds_read_b64_tr_b16 v[38:39], v148 offset:48128
    ds_read_b64_tr_b16 v[40:41], v149 offset:46080
    buffer_load_dwordx4 a[96:99], v4, s[40:43], s74 offen offset:0 sc1
    s_waitcnt lgkmcnt(7)
    v_mfma_f32_32x32x16_bf16 v[80:95], v[20:23], a[64:67], v[80:95]
    ds_read_b64_tr_b16 v[42:43], v149 offset:48128
    ds_read_b64_tr_b16 v[44:45], v150 offset:46080
    ds_read_b64_tr_b16 v[46:47], v150 offset:48128
    buffer_load_dwordx4 a[100:103], v4, s[40:43], s74 offen offset:1024 sc1
    s_waitcnt lgkmcnt(8)
    v_mfma_f32_32x32x16_bf16 v[96:111], v[24:27], a[64:67], v[96:111]
    ds_read_b64_tr_b16 v[48:49], v151 offset:46080
    ds_read_b64_tr_b16 v[50:51], v151 offset:48128
    buffer_load_dwordx4 a[104:107], v4, s[40:43], s74 offen offset:2048 sc1
    s_waitcnt lgkmcnt(8)
    v_mfma_f32_32x32x16_bf16 v[112:127], v[28:31], a[64:67], v[112:127]
    buffer_load_dwordx4 a[108:111], v4, s[40:43], s74 offen offset:3072 sc1
    s_waitcnt vmcnt(21) lgkmcnt(6)
    v_mfma_f32_32x32x16_bf16 v[64:79], v[36:39], a[68:71], v[64:79]
    ds_read_b64_tr_b16 v[16:17], v148 offset:51200
    ds_read_b64_tr_b16 v[18:19], v148 offset:53248
    ds_read_b64_tr_b16 v[20:21], v149 offset:51200
    s_add_u32 s74, s74, 4096
    s_waitcnt lgkmcnt(7)
    v_mfma_f32_32x32x16_bf16 v[80:95], v[40:43], a[68:71], v[80:95]
    ds_read_b64_tr_b16 v[22:23], v149 offset:53248
    ds_read_b64_tr_b16 v[24:25], v150 offset:51200
    ds_read_b64_tr_b16 v[26:27], v150 offset:53248
    s_cmp_ge_u32 s74, s75
    s_cselect_b32 s74, s76, s74
    s_waitcnt lgkmcnt(8)
    v_mfma_f32_32x32x16_bf16 v[96:111], v[44:47], a[68:71], v[96:111]
    ds_read_b64_tr_b16 v[28:29], v151 offset:51200
    ds_read_b64_tr_b16 v[30:31], v151 offset:53248
    s_add_u32 m0, s66, 0
    s_waitcnt lgkmcnt(8)
    v_mfma_f32_32x32x16_bf16 v[112:127], v[48:51], a[68:71], v[112:127]
    buffer_load_dwordx4 v5, s[44:47], s67 offen offset:0  lds
    s_waitcnt vmcnt(21) lgkmcnt(6)
    v_mfma_f32_32x32x16_bf16 v[64:79], v[16:19], a[72:75], v[64:79]
    ds_read_b64_tr_b16 v[36:37], v148 offset:56320
    ds_read_b64_tr_b16 v[38:39], v148 offset:58368
    ds_read_b64_tr_b16 v[40:41], v149 offset:56320
    buffer_load_dwordx4 v6, s[44:47], s67 offen offset:1024  lds
    s_waitcnt lgkmcnt(7)
    v_mfma_f32_32x32x16_bf16 v[80:95], v[20:23], a[72:75], v[80:95]
    ds_read_b64_tr_b16 v[42:43], v149 offset:58368
    ds_read_b64_tr_b16 v[44:45], v150 offset:56320
    ds_read_b64_tr_b16 v[46:47], v150 offset:58368
    buffer_load_dwordx4 v7, s[44:47], s67 offen offset:2048  lds
    s_waitcnt lgkmcnt(8)
    v_mfma_f32_32x32x16_bf16 v[96:111], v[24:27], a[72:75], v[96:111]
    ds_read_b64_tr_b16 v[48:49], v151 offset:56320
    ds_read_b64_tr_b16 v[50:51], v151 offset:58368
    s_waitcnt lgkmcnt(8)
    v_mfma_f32_32x32x16_bf16 v[112:127], v[28:31], a[72:75], v[112:127]
    buffer_load_dwordx4 v8, s[44:47], s67 offen offset:3072  lds
    s_waitcnt vmcnt(23) lgkmcnt(6)
    v_mfma_f32_32x32x16_bf16 v[64:79], v[36:39], a[76:79], v[64:79]
    s_waitcnt vmcnt(18)
    s_barrier
    ds_read_b64_tr_b16 v[16:17], v152 offset:0
    ds_read_b64_tr_b16 v[18:19], v152 offset:2048
    s_add_u32 m0, s66, 1024
    s_waitcnt lgkmcnt(6)
    v_mfma_f32_32x32x16_bf16 v[80:95], v[40:43], a[76:79], v[80:95]
    ds_read_b64_tr_b16 v[20:21], v153 offset:0
    ds_read_b64_tr_b16 v[22:23], v153 offset:2048
    ds_read_b64_tr_b16 v[24:25], v154 offset:0
    ds_read_b64_tr_b16 v[26:27], v154 offset:2048
    buffer_load_dwordx4 v9, s[44:47], s67 offen offset:3072  lds
    s_waitcnt lgkmcnt(8)
    v_mfma_f32_32x32x16_bf16 v[96:111], v[44:47], a[76:79], v[96:111]
    ds_read_b64_tr_b16 v[28:29], v155 offset:0
    ds_read_b64_tr_b16 v[30:31], v155 offset:2048
    s_add_u32 s67, s67, s68
    s_cmp_ge_u32 s67, s69
    s_cselect_b32 s67, s70, s67
    s_waitcnt lgkmcnt(8)
    v_mfma_f32_32x32x16_bf16 v[112:127], v[48:51], a[76:79], v[112:127]
    s_waitcnt vmcnt(18) lgkmcnt(6)
    v_mfma_f32_32x32x16_bf16 v[64:79], v[16:19], a[80:83], v[64:79]
    ds_read_b64_tr_b16 v[36:37], v152 offset:5120
    ds_read_b64_tr_b16 v[38:39], v152 offset:7168
    ds_read_b64_tr_b16 v[40:41], v153 offset:5120
    buffer_load_dwordx4 a[112:115], v4, s[40:43], s74 offen offset:0 sc1
    s_waitcnt lgkmcnt(7)
    v_mfma_f32_32x32x16_bf16 v[80:95], v[20:23], a[80:83], v[80:95]
    ds_read_b64_tr_b16 v[42:43], v153 offset:7168
    ds_read_b64_tr_b16 v[44:45], v154 offset:5120
    ds_read_b64_tr_b16 v[46:47], v154 offset:7168
    buffer_load_dwordx4 a[116:119], v4, s[40:43], s74 offen offset:1024 sc1
    s_waitcnt lgkmcnt(8)
    v_mfma_f32_32x32x16_bf16 v[96:111], v[24:27], a[80:83], v[96:111]
    ds_read_b64_tr_b16 v[48:49], v155 offset:5120
    ds_read_b64_tr_b16 v[50:51], v155 offset:7168
    buffer_load_dwordx4 a[120:123], v4, s[40:43], s74 offen offset:2048 sc1
    buffer_load_dwordx4 a[124:127], v4, s[40:43], s74 offen offset:3072 sc1
    s_waitcnt lgkmcnt(8)
    v_mfma_f32_32x32x16_bf16 v[112:127], v[28:31], a[80:83], v[112:127]
    s_add_u32 s74, s74, 4096
    s_waitcnt vmcnt(21) lgkmcnt(6)
    v_mfma_f32_32x32x16_bf16 v[64:79], v[36:39], a[84:87], v[64:79]
    ds_read_b64_tr_b16 v[16:17], v152 offset:10240
    ds_read_b64_tr_b16 v[18:19], v152 offset:12288
    ds_read_b64_tr_b16 v[20:21], v153 offset:10240
    s_cmp_ge_u32 s74, s75
    s_cselect_b32 s74, s76, s74
    s_waitcnt lgkmcnt(7)
    v_mfma_f32_32x32x16_bf16 v[80:95], v[40:43], a[84:87], v[80:95]
    ds_read_b64_tr_b16 v[22:23], v153 offset:12288
    ds_read_b64_tr_b16 v[24:25], v154 offset:10240
    ds_read_b64_tr_b16 v[26:27], v154 offset:12288
    s_waitcnt lgkmcnt(8)
    v_mfma_f32_32x32x16_bf16 v[96:111], v[44:47], a[84:87], v[96:111]
    ds_read_b64_tr_b16 v[28:29], v155 offset:10240
    ds_read_b64_tr_b16 v[30:31], v155 offset:12288
    s_waitcnt lgkmcnt(8)
    v_mfma_f32_32x32x16_bf16 v[112:127], v[48:51], a[84:87], v[112:127]
    s_waitcnt vmcnt(20) lgkmcnt(6)
    v_mfma_f32_32x32x16_bf16 v[64:79], v[16:19], a[88:91], v[64:79]
    ds_read_b64_tr_b16 v[36:37], v152 offset:15360
    ds_read_b64_tr_b16 v[38:39], v152 offset:17408
    ds_read_b64_tr_b16 v[40:41], v153 offset:15360
    s_waitcnt lgkmcnt(7)
    v_mfma_f32_32x32x16_bf16 v[80:95], v[20:23], a[88:91], v[80:95]
    ds_read_b64_tr_b16 v[42:43], v153 offset:17408
    ds_read_b64_tr_b16 v[44:45], v154 offset:15360
    ds_read_b64_tr_b16 v[46:47], v154 offset:17408
    s_waitcnt lgkmcnt(8)
    v_mfma_f32_32x32x16_bf16 v[96:111], v[24:27], a[88:91], v[96:111]
    ds_read_b64_tr_b16 v[48:49], v155 offset:15360
    ds_read_b64_tr_b16 v[50:51], v155 offset:17408
    s_waitcnt lgkmcnt(8)
    v_mfma_f32_32x32x16_bf16 v[112:127], v[28:31], a[88:91], v[112:127]
    s_waitcnt vmcnt(19) lgkmcnt(6)
    v_mfma_f32_32x32x16_bf16 v[64:79], v[36:39], a[92:95], v[64:79]
    s_waitcnt vmcnt(14)
    s_barrier
    ds_read_b64_tr_b16 v[16:17], v152 offset:20480
    ds_read_b64_tr_b16 v[18:19], v152 offset:22528
    s_waitcnt lgkmcnt(6)
    v_mfma_f32_32x32x16_bf16 v[80:95], v[40:43], a[92:95], v[80:95]
    ds_read_b64_tr_b16 v[20:21], v153 offset:20480
    ds_read_b64_tr_b16 v[22:23], v153 offset:22528
    ds_read_b64_tr_b16 v[24:25], v154 offset:20480
    ds_read_b64_tr_b16 v[26:27], v154 offset:22528
    s_waitcnt vmcnt(13)
    v_xor_b32 v144, v144, v15
    v_xor_b32 v145, v145, v15
    v_xor_b32 v146, v146, v15
    v_xor_b32 v147, v147, v15
    v_or3_b32 v144, v144, v145, v146
    v_or_b32 v144, v144, v147
    v_cmp_ne_u32 vcc, 0, v144
    s_cbranch_vccz L_fd_30
    s_mov_b32 s94, 0
    s_mov_b32 s95, 22093824
L_fl_31:
    s_sleep 3
    buffer_load_dwordx4 v[144:147], v1, s[40:43], s95 offen sc1
    s_add_u32 s94, s94, 1
    s_waitcnt vmcnt(0)
    v_xor_b32 v144, v144, v15
    v_xor_b32 v145, v145, v15
    v_xor_b32 v146, v146, v15
    v_xor_b32 v147, v147, v15
    v_or3_b32 v144, v144, v145, v146
    v_or_b32 v144, v144, v147
    v_cmp_ne_u32 vcc, 0, v144
    s_cbranch_vccz L_fd_30
    s_cmp_lt_u32 s94, 400000
    s_cbranch_scc1 L_fl_31
L_fd_30:
    s_waitcnt lgkmcnt(8)
    v_mfma_f32_32x32x16_bf16 v[96:111], v[44:47], a[92:95], v[96:111]
    ds_read_b64_tr_b16 v[28:29], v155 offset:20480
    ds_read_b64_tr_b16 v[30:31], v155 offset:22528
    s_add_u32 m0, s66, 143360
    s_nop 0
    buffer_load_dwordx4 v5, s[44:47], s67 offen offset:0  lds
    s_waitcnt lgkmcnt(8)
    v_mfma_f32_32x32x16_bf16 v[112:127], v[48:51], a[92:95], v[112:127]
    buffer_load_dwordx4 v6, s[44:47], s67 offen offset:1024  lds
    buffer_load_dwordx4 v7, s[44:47], s67 offen offset:2048  lds
    buffer_load_dwordx4 v8, s[44:47], s67 offen offset:3072  lds
    s_add_u32 m0, s66, 144384
    s_nop 0
    buffer_load_dwordx4 v9, s[44:47], s67 offen offset:3072  lds
    s_add_u32 s67, s67, s68
    s_cmp_ge_u32 s67, s69
    s_cselect_b32 s67, s70, s67
    s_waitcnt vmcnt(17) lgkmcnt(6)
    v_mfma_f32_32x32x16_bf16 v[64:79], v[16:19], a[96:99], v[64:79]
    ds_read_b64_tr_b16 v[36:37], v152 offset:25600
    ds_read_b64_tr_b16 v[38:39], v152 offset:27648
    ds_read_b64_tr_b16 v[40:41], v153 offset:25600
    buffer_load_dwordx4 a[128:131], v4, s[40:43], s74 offen offset:0 sc1
    s_waitcnt lgkmcnt(7)
    v_mfma_f32_32x32x16_bf16 v[80:95], v[20:23], a[96:99], v[80:95]
    ds_read_b64_tr_b16 v[42:43], v153 offset:27648
    ds_read_b64_tr_b16 v[44:45], v154 offset:25600
    ds_read_b64_tr_b16 v[46:47], v154 offset:27648
    buffer_load_dwordx4 a[132:135], v4, s[40:43], s74 offen offset:1024 sc1
    s_waitcnt lgkmcnt(8)
    v_mfma_f32_32x32x16_bf16 v[96:111], v[24:27], a[96:99], v[96:111]
    ds_read_b64_tr_b16 v[48:49], v155 offset:25600
    ds_read_b64_tr_b16 v[50:51], v155 offset:27648
    buffer_load_dwordx4 a[136:139], v4, s[40:43], s74 offen offset:2048 sc1
    buffer_load_dwordx4 a[140:143], v4, s[40:43], s74 offen offset:3072 sc1
    s_waitcnt lgkmcnt(8)
    v_mfma_f32_32x32x16_bf16 v[112:127], v[28:31], a[96:99], v[112:127]
    s_add_u32 s74, s74, 4096
    s_cmp_ge_u32 s74, s75
    s_cselect_b32 s74, s76, s74
    s_add_u32 m0, s66, 122880
    s_waitcnt vmcnt(20) lgkmcnt(6)
    v_mfma_f32_32x32x16_bf16 v[64:79], v[36:39], a[100:103], v[64:79]
    ds_read_b64_tr_b16 v[16:17], v152 offset:30720
    ds_read_b64_tr_b16 v[18:19], v152 offset:32768
    ds_read_b64_tr_b16 v[20:21], v153 offset:30720
    buffer_load_dwordx4 v5, s[44:47], s67 offen offset:0  lds
    s_waitcnt lgkmcnt(7)
    v_mfma_f32_32x32x16_bf16 v[80:95], v[40:43], a[100:103], v[80:95]
    ds_read_b64_tr_b16 v[22:23], v153 offset:32768
    ds_read_b64_tr_b16 v[24:25], v154 offset:30720
    ds_read_b64_tr_b16 v[26:27], v154 offset:32768
    buffer_load_dwordx4 v6, s[44:47], s67 offen offset:1024  lds
    s_waitcnt lgkmcnt(8)
    v_mfma_f32_32x32x16_bf16 v[96:111], v[44:47], a[100:103], v[96:111]
    ds_read_b64_tr_b16 v[28:29], v155 offset:30720
    ds_read_b64_tr_b16 v[30:31], v155 offset:32768
    buffer_load_dwordx4 v7, s[44:47], s67 offen offset:2048  lds
    buffer_load_dwordx4 v8, s[44:47], s67 offen offset:3072  lds
    s_waitcnt lgkmcnt(8)
    v_mfma_f32_32x32x16_bf16 v[112:127], v[48:51], a[100:103], v[112:127]
    s_add_u32 m0, s66, 123904
    s_nop 0
    buffer_load_dwordx4 v9, s[44:47], s67 offen offset:3072  lds
    s_waitcnt vmcnt(24) lgkmcnt(6)
    v_mfma_f32_32x32x16_bf16 v[64:79], v[16:19], a[104:107], v[64:79]
    ds_read_b64_tr_b16 v[36:37], v152 offset:35840
    ds_read_b64_tr_b16 v[38:39], v152 offset:37888
    ds_read_b64_tr_b16 v[40:41], v153 offset:35840
    s_add_u32 s67, s67, s68
    s_cmp_ge_u32 s67, s69
    s_cselect_b32 s67, s70, s67
    s_waitcnt lgkmcnt(7)
    v_mfma_f32_32x32x16_bf16 v[80:95], v[20:23], a[104:107], v[80:95]
    ds_read_b64_tr_b16 v[42:43], v153 offset:37888
    ds_read_b64_tr_b16 v[44:45], v154 offset:35840
    ds_read_b64_tr_b16 v[46:47], v154 offset:37888
    v_and_b32 v56, 31, v0
    v_lshlrev_b32 v58, 2, v56
    v_lshlrev_b32 v56, 3, v56
    s_waitcnt lgkmcnt(8)
    v_mfma_f32_32x32x16_bf16 v[96:111], v[24:27], a[104:107], v[96:111]
    ds_read_b64_tr_b16 v[48:49], v155 offset:35840
    ds_read_b64_tr_b16 v[50:51], v155 offset:37888
    v_lshrrev_b32 v57, 5, v0
    v_lshl_add_u32 v56, v57, 16, v56
    s_lshl_b32 s82, s79, 8
    s_waitcnt lgkmcnt(8)
    v_mfma_f32_32x32x16_bf16 v[112:127], v[28:31], a[104:107], v[112:127]
    s_add_u32 s82, s82, 21823488
    buffer_load_dwordx2 v[160:161], v56, s[40:43], s82 offen sc1
    s_add_u32 s82, s82, 16384
    s_waitcnt vmcnt(24) lgkmcnt(6)
    v_mfma_f32_32x32x16_bf16 v[64:79], v[36:39], a[108:111], v[64:79]
    s_waitcnt vmcnt(19)
    s_barrier
    ds_read_b64_tr_b16 v[16:17], v148 offset:0
    ds_read_b64_tr_b16 v[18:19], v148 offset:2048
    buffer_load_dwordx2 v[162:163], v56, s[40:43], s82 offen sc1
    s_waitcnt lgkmcnt(6)
    v_mfma_f32_32x32x16_bf16 v[80:95], v[40:43], a[108:111], v[80:95]
    ds_read_b64_tr_b16 v[20:21], v149 offset:0
    ds_read_b64_tr_b16 v[22:23], v149 offset:2048
    ds_read_b64_tr_b16 v[24:25], v150 offset:0
    ds_read_b64_tr_b16 v[26:27], v150 offset:2048
    s_add_u32 s82, s82, 16384
    buffer_load_dwordx2 v[164:165], v56, s[40:43], s82 offen sc1
    s_waitcnt lgkmcnt(8)
    v_mfma_f32_32x32x16_bf16 v[96:111], v[44:47], a[108:111], v[96:111]
    ds_read_b64_tr_b16 v[28:29], v151 offset:0
    ds_read_b64_tr_b16 v[30:31], v151 offset:2048
    s_add_u32 s82, s82, 16384
    buffer_load_dwordx2 v[166:167], v56, s[40:43], s82 offen sc1
    s_lshl_b32 s82, s62, 9
    s_add_u32 s82, s82, 21626880
    s_waitcnt lgkmcnt(8)
    v_mfma_f32_32x32x16_bf16 v[112:127], v[48:51], a[108:111], v[112:127]
    buffer_load_dword v168, v58, s[40:43], s82 offen offset:0 sc1
    buffer_load_dword v169, v58, s[40:43], s82 offen offset:128 sc1
    buffer_load_dword v170, v58, s[40:43], s82 offen offset:256 sc1
    buffer_load_dword v171, v58, s[40:43], s82 offen offset:384 sc1
    s_waitcnt vmcnt(25) lgkmcnt(6)
    v_mfma_f32_32x32x16_bf16 v[64:79], v[16:19], a[112:115], v[64:79]
    ds_read_b64_tr_b16 v[36:37], v148 offset:5120
    ds_read_b64_tr_b16 v[38:39], v148 offset:7168
    ds_read_b64_tr_b16 v[40:41], v149 offset:5120
    buffer_load_dwordx4 a[144:147], v4, s[40:43], s74 offen offset:0 sc1
    s_waitcnt lgkmcnt(7)
    v_mfma_f32_32x32x16_bf16 v[80:95], v[20:23], a[112:115], v[80:95]
    ds_read_b64_tr_b16 v[42:43], v149 offset:7168
    ds_read_b64_tr_b16 v[44:45], v150 offset:5120
    ds_read_b64_tr_b16 v[46:47], v150 offset:7168
    s_waitcnt lgkmcnt(8)
    v_mfma_f32_32x32x16_bf16 v[96:111], v[24:27], a[112:115], v[96:111]
    ds_read_b64_tr_b16 v[48:49], v151 offset:5120
    ds_read_b64_tr_b16 v[50:51], v151 offset:7168
    buffer_load_dwordx4 a[148:151], v4, s[40:43], s74 offen offset:1024 sc1
    s_waitcnt lgkmcnt(8)
    v_mfma_f32_32x32x16_bf16 v[112:127], v[28:31], a[112:115], v[112:127]
    s_waitcnt vmcnt(26) lgkmcnt(6)
    v_mfma_f32_32x32x16_bf16 v[64:79], v[36:39], a[116:119], v[64:79]
    ds_read_b64_tr_b16 v[16:17], v148 offset:10240
    ds_read_b64_tr_b16 v[18:19], v148 offset:12288
    ds_read_b64_tr_b16 v[20:21], v149 offset:10240
    s_waitcnt lgkmcnt(7)
    v_mfma_f32_32x32x16_bf16 v[80:95], v[40:43], a[116:119], v[80:95]
    ds_read_b64_tr_b16 v[22:23], v149 offset:12288
    ds_read_b64_tr_b16 v[24:25], v150 offset:10240
    ds_read_b64_tr_b16 v[26:27], v150 offset:12288
    buffer_load_dwordx4 a[152:155], v4, s[40:43], s74 offen offset:2048 sc1
    s_waitcnt lgkmcnt(8)
    v_mfma_f32_32x32x16_bf16 v[96:111], v[44:47], a[116:119], v[96:111]
    ds_read_b64_tr_b16 v[28:29], v151 offset:10240
    ds_read_b64_tr_b16 v[30:31], v151 offset:12288
    s_waitcnt lgkmcnt(8)
    v_mfma_f32_32x32x16_bf16 v[112:127], v[48:51], a[116:119], v[112:127]
    s_waitcnt vmcnt(26) lgkmcnt(6)
    v_mfma_f32_32x32x16_bf16 v[64:79], v[16:19], a[120:123], v[64:79]
    ds_read_b64_tr_b16 v[36:37], v148 offset:15360
    ds_read_b64_tr_b16 v[38:39], v148 offset:17408
    ds_read_b64_tr_b16 v[40:41], v149 offset:15360
    buffer_load_dwordx4 a[156:159], v4, s[40:43], s74 offen offset:3072 sc1
    s_waitcnt lgkmcnt(7)
    v_mfma_f32_32x32x16_bf16 v[80:95], v[20:23], a[120:123], v[80:95]
    ds_read_b64_tr_b16 v[42:43], v149 offset:17408
    ds_read_b64_tr_b16 v[44:45], v150 offset:15360
    ds_read_b64_tr_b16 v[46:47], v150 offset:17408
    s_waitcnt lgkmcnt(8)
    v_mfma_f32_32x32x16_bf16 v[96:111], v[24:27], a[120:123], v[96:111]
    ds_read_b64_tr_b16 v[48:49], v151 offset:15360
    ds_read_b64_tr_b16 v[50:51], v151 offset:17408
    s_waitcnt lgkmcnt(8)
    v_mfma_f32_32x32x16_bf16 v[112:127], v[28:31], a[120:123], v[112:127]
    s_add_u32 s74, s74, 4096
    s_waitcnt vmcnt(26) lgkmcnt(6)
    v_mfma_f32_32x32x16_bf16 v[64:79], v[36:39], a[124:127], v[64:79]
    s_waitcnt vmcnt(21)
    s_barrier
    ds_read_b64_tr_b16 v[16:17], v156 offset:20480
    ds_read_b64_tr_b16 v[18:19], v156 offset:22528
    s_waitcnt lgkmcnt(6)
    v_mfma_f32_32x32x16_bf16 v[80:95], v[40:43], a[124:127], v[80:95]
    ds_read_b64_tr_b16 v[20:21], v157 offset:20480
    ds_read_b64_tr_b16 v[22:23], v157 offset:22528
    ds_read_b64_tr_b16 v[24:25], v158 offset:20480
    ds_read_b64_tr_b16 v[26:27], v158 offset:22528
    s_cmp_ge_u32 s74, s75
    s_cselect_b32 s74, s76, s74
    s_waitcnt lgkmcnt(8)
    v_mfma_f32_32x32x16_bf16 v[96:111], v[44:47], a[124:127], v[96:111]
    ds_read_b64_tr_b16 v[28:29], v159 offset:20480
    ds_read_b64_tr_b16 v[30:31], v159 offset:22528
    s_waitcnt lgkmcnt(8)
    v_mfma_f32_32x32x16_bf16 v[112:127], v[48:51], a[124:127], v[112:127]
    s_waitcnt vmcnt(20) lgkmcnt(6)
    v_mfma_f32_32x32x16_bf16 v[64:79], v[16:19], a[128:131], v[64:79]
    ds_read_b64_tr_b16 v[36:37], v156 offset:25600
    ds_read_b64_tr_b16 v[38:39], v156 offset:27648
    ds_read_b64_tr_b16 v[40:41], v157 offset:25600
    s_waitcnt vmcnt(10)
    v_add_f32 v160, v160, v162
    v_add_f32 v161, v161, v163
    s_waitcnt lgkmcnt(7)
    v_mfma_f32_32x32x16_bf16 v[80:95], v[20:23], a[128:131], v[80:95]
    ds_read_b64_tr_b16 v[42:43], v157 offset:27648
    ds_read_b64_tr_b16 v[44:45], v158 offset:25600
    ds_read_b64_tr_b16 v[46:47], v158 offset:27648
    s_waitcnt vmcnt(8)
    v_add_f32 v164, v164, v166
    v_add_f32 v165, v165, v167
    s_waitcnt lgkmcnt(8)
    v_mfma_f32_32x32x16_bf16 v[96:111], v[24:27], a[128:131], v[96:111]
    ds_read_b64_tr_b16 v[48:49], v159 offset:25600
    ds_read_b64_tr_b16 v[50:51], v159 offset:27648
    v_add_f32 v160, v160, v164
    v_add_f32 v161, v161, v165
    s_waitcnt lgkmcnt(8)
    v_mfma_f32_32x32x16_bf16 v[112:127], v[28:31], a[128:131], v[112:127]
    v_mov_b32 v162, v160
    v_mov_b32 v163, v161
    s_waitcnt lgkmcnt(6)
    v_mfma_f32_32x32x16_bf16 v[64:79], v[36:39], a[132:135], v[64:79]
    ds_read_b64_tr_b16 v[16:17], v156 offset:30720
    ds_read_b64_tr_b16 v[18:19], v156 offset:32768
    ds_read_b64_tr_b16 v[20:21], v157 offset:30720
    v_permlane32_swap_b32 v160, v162
    v_permlane32_swap_b32 v161, v163
    s_waitcnt lgkmcnt(7)
    v_mfma_f32_32x32x16_bf16 v[80:95], v[40:43], a[132:135], v[80:95]
    ds_read_b64_tr_b16 v[22:23], v157 offset:32768
    ds_read_b64_tr_b16 v[24:25], v158 offset:30720
    ds_read_b64_tr_b16 v[26:27], v158 offset:32768
    v_add_f32 v160, v160, v162
    v_add_f32 v161, v161, v163
    s_waitcnt lgkmcnt(8)
    v_mfma_f32_32x32x16_bf16 v[96:111], v[44:47], a[132:135], v[96:111]
    ds_read_b64_tr_b16 v[28:29], v159 offset:30720
    ds_read_b64_tr_b16 v[30:31], v159 offset:32768
    v_mul_f32 v160, 0x3acccccd, v160
    v_mul_f32 v161, 0x3acccccd, v161
    s_waitcnt lgkmcnt(8)
    v_mfma_f32_32x32x16_bf16 v[112:127], v[48:51], a[132:135], v[112:127]
    v_cvt_pk_bf16_f32 v172, -v160, -v160
    s_waitcnt lgkmcnt(6)
    v_mfma_f32_32x32x16_bf16 v[64:79], v[16:19], a[136:139], v[64:79]
    ds_read_b64_tr_b16 v[36:37], v156 offset:35840
    ds_read_b64_tr_b16 v[38:39], v156 offset:37888
    ds_read_b64_tr_b16 v[40:41], v157 offset:35840
    v_lshlrev_b32 v56, 16, v172
    v_add_f32 v56, v160, v56
    s_waitcnt lgkmcnt(7)
    v_mfma_f32_32x32x16_bf16 v[80:95], v[20:23], a[136:139], v[80:95]
    ds_read_b64_tr_b16 v[42:43], v157 offset:37888
    ds_read_b64_tr_b16 v[44:45], v158 offset:35840
    ds_read_b64_tr_b16 v[46:47], v158 offset:37888
    v_cvt_pk_bf16_f32 v56, -v56, -v56
    v_cmp_gt_u32 vcc, 32, v0
    s_waitcnt lgkmcnt(8)
    v_mfma_f32_32x32x16_bf16 v[96:111], v[24:27], a[136:139], v[96:111]
    ds_read_b64_tr_b16 v[48:49], v159 offset:35840
    ds_read_b64_tr_b16 v[50:51], v159 offset:37888
    v_cndmask_b32 v172, v56, v172, vcc
    v_mov_b32 v173, 0
    s_waitcnt lgkmcnt(8)
    v_mfma_f32_32x32x16_bf16 v[112:127], v[28:31], a[136:139], v[112:127]
    v_mov_b32 v174, 0
    v_mov_b32 v175, 0
    s_waitcnt lgkmcnt(6)
    v_mfma_f32_32x32x16_bf16 v[64:79], v[36:39], a[140:143], v[64:79]
    s_barrier
    ds_read_b64_tr_b16 v[16:17], v156 offset:0
    ds_read_b64_tr_b16 v[18:19], v156 offset:2048
    s_waitcnt vmcnt(7)
    v_cvt_pk_bf16_f32 v56, v168, v168
    s_waitcnt lgkmcnt(6)
    v_mfma_f32_32x32x16_bf16 v[80:95], v[40:43], a[140:143], v[80:95]
    ds_read_b64_tr_b16 v[20:21], v157 offset:0
    ds_read_b64_tr_b16 v[22:23], v157 offset:2048
    ds_read_b64_tr_b16 v[24:25], v158 offset:0
    ds_read_b64_tr_b16 v[26:27], v158 offset:2048
    v_lshlrev_b32 v56, 16, v56
    v_sub_f32 v56, v168, v56
    s_waitcnt lgkmcnt(8)
    v_mfma_f32_32x32x16_bf16 v[96:111], v[44:47], a[140:143], v[96:111]
    ds_read_b64_tr_b16 v[28:29], v159 offset:0
    ds_read_b64_tr_b16 v[30:31], v159 offset:2048
    v_cvt_pk_bf16_f32 v176, v168, v56
    v_mov_b32 v177, 0
    v_mov_b32 v178, 0
    s_waitcnt lgkmcnt(8)
    v_mfma_f32_32x32x16_bf16 v[112:127], v[48:51], a[140:143], v[112:127]
    v_mov_b32 v179, 0
    s_waitcnt vmcnt(3) lgkmcnt(6)
    v_mfma_f32_32x32x16_bf16 v[64:79], v[16:19], a[144:147], v[64:79]
    ds_read_b64_tr_b16 v[36:37], v156 offset:5120
    ds_read_b64_tr_b16 v[38:39], v156 offset:7168
    ds_read_b64_tr_b16 v[40:41], v157 offset:5120
    v_cvt_pk_bf16_f32 v56, v169, v169
    v_lshlrev_b32 v56, 16, v56
    v_sub_f32 v56, v169, v56
    s_waitcnt lgkmcnt(7)
    v_mfma_f32_32x32x16_bf16 v[80:95], v[20:23], a[144:147], v[80:95]
    ds_read_b64_tr_b16 v[42:43], v157 offset:7168
    ds_read_b64_tr_b16 v[44:45], v158 offset:5120
    ds_read_b64_tr_b16 v[46:47], v158 offset:7168
    v_cvt_pk_bf16_f32 v180, v169, v56
    v_mov_b32 v181, 0
    v_mov_b32 v182, 0
    s_waitcnt lgkmcnt(8)
    v_mfma_f32_32x32x16_bf16 v[96:111], v[24:27], a[144:147], v[96:111]
    ds_read_b64_tr_b16 v[48:49], v159 offset:5120
    ds_read_b64_tr_b16 v[50:51], v159 offset:7168
    v_mov_b32 v183, 0
    v_cvt_pk_bf16_f32 v56, v170, v170
    v_lshlrev_b32 v56, 16, v56
    s_waitcnt lgkmcnt(8)
    v_mfma_f32_32x32x16_bf16 v[112:127], v[28:31], a[144:147], v[112:127]
    v_sub_f32 v56, v170, v56
    v_cvt_pk_bf16_f32 v184, v170, v56
    v_mov_b32 v185, 0
    s_waitcnt vmcnt(2) lgkmcnt(6)
    v_mfma_f32_32x32x16_bf16 v[64:79], v[36:39], a[148:151], v[64:79]
    ds_read_b64_tr_b16 v[16:17], v156 offset:10240
    ds_read_b64_tr_b16 v[18:19], v156 offset:12288
    ds_read_b64_tr_b16 v[20:21], v157 offset:10240
    v_mov_b32 v186, 0
    v_mov_b32 v187, 0
    v_cvt_pk_bf16_f32 v56, v171, v171
    s_waitcnt lgkmcnt(7)
    v_mfma_f32_32x32x16_bf16 v[80:95], v[40:43], a[148:151], v[80:95]
    ds_read_b64_tr_b16 v[22:23], v157 offset:12288
    ds_read_b64_tr_b16 v[24:25], v158 offset:10240
    ds_read_b64_tr_b16 v[26:27], v158 offset:12288
    v_lshlrev_b32 v56, 16, v56
    v_sub_f32 v56, v171, v56
    v_cvt_pk_bf16_f32 v188, v171, v56
    s_waitcnt lgkmcnt(8)
    v_mfma_f32_32x32x16_bf16 v[96:111], v[44:47], a[148:151], v[96:111]
    ds_read_b64_tr_b16 v[28:29], v159 offset:10240
    ds_read_b64_tr_b16 v[30:31], v159 offset:12288
    v_mov_b32 v189, 0
    v_mov_b32 v190, 0
    v_mov_b32 v191, 0
    s_waitcnt lgkmcnt(8)
    v_mfma_f32_32x32x16_bf16 v[112:127], v[48:51], a[148:151], v[112:127]
    v_fma_f32 v161, -v160, v160, v161
    v_max_f32 v161, 0, v161
    s_waitcnt vmcnt(1) lgkmcnt(6)
    v_mfma_f32_32x32x16_bf16 v[64:79], v[16:19], a[152:155], v[64:79]
    ds_read_b64_tr_b16 v[36:37], v156 offset:15360
    ds_read_b64_tr_b16 v[38:39], v156 offset:17408
    ds_read_b64_tr_b16 v[40:41], v157 offset:15360
    v_add_f32 v161, 0x3727c5ac, v161
    v_rsq_f32 v60, v161
    s_nop 0
    v_mul_f32 v58, v60, v60
    s_waitcnt lgkmcnt(7)
    v_mfma_f32_32x32x16_bf16 v[80:95], v[20:23], a[152:155], v[80:95]
    ds_read_b64_tr_b16 v[42:43], v157 offset:17408
    ds_read_b64_tr_b16 v[44:45], v158 offset:15360
    ds_read_b64_tr_b16 v[46:47], v158 offset:17408
    v_mul_f32 v58, v58, v60
    v_mul_f32 v58, 0xbdd2d3e8, v58
    v_rcp_f32 v62, v60
    s_waitcnt lgkmcnt(8)
    v_mfma_f32_32x32x16_bf16 v[96:111], v[24:27], a[152:155], v[96:111]
    ds_read_b64_tr_b16 v[48:49], v159 offset:15360
    ds_read_b64_tr_b16 v[50:51], v159 offset:17408
    v_mul_f32 v56, 0xc0135761, v60
    s_add_u32 m0, s66, 102400
    s_add_u32 s96, s71, 1024
    s_waitcnt lgkmcnt(8)
    v_mfma_f32_32x32x16_bf16 v[112:127], v[28:31], a[152:155], v[112:127]
    buffer_load_dwordx4 v4, s[40:43], s71 offen offset:0 sc1 lds
    buffer_load_dwordx4 v4, s[40:43], s71 offen offset:1024 sc1 lds
    s_waitcnt vmcnt(2) lgkmcnt(6)
    v_mfma_f32_32x32x16_bf16 v[64:79], v[36:39], a[156:159], v[64:79]
    buffer_load_dwordx4 v4, s[40:43], s71 offen offset:2048 sc1 lds
    s_waitcnt lgkmcnt(4)
    v_mfma_f32_32x32x16_bf16 v[80:95], v[40:43], a[156:159], v[80:95]
    buffer_load_dwordx4 v4, s[40:43], s71 offen offset:3072 sc1 lds
    s_add_u32 m0, s66, 103424
    s_waitcnt lgkmcnt(2)
    v_mfma_f32_32x32x16_bf16 v[96:111], v[44:47], a[156:159], v[96:111]
    buffer_load_dwordx4 v4, s[40:43], s96 offen offset:3072 sc1 lds
    s_add_u32 s71, s71, 10240
    s_waitcnt lgkmcnt(0)
    v_mfma_f32_32x32x16_bf16 v[112:127], v[48:51], a[156:159], v[112:127]
    s_cmp_ge_u32 s71, s72
    s_cselect_b32 s71, s73, s71
    v_mfma_f32_32x32x16_bf16 v[64:79], v[176:179], v[172:175], v[64:79]
    v_mfma_f32_32x32x16_bf16 v[80:95], v[180:183], v[172:175], v[80:95]
    v_mfma_f32_32x32x16_bf16 v[96:111], v[184:187], v[172:175], v[96:111]
    v_mfma_f32_32x32x16_bf16 v[112:127], v[188:191], v[172:175], v[112:127]
    s_barrier
    s_mul_i32 s91, s79, 98304
    s_lshl_b32 s83, s62, 13
    s_add_u32 s91, s91, s83
    s_add_u32 s91, s91, 13107200
    s_nop 3
    v_pk_mul_f32 v[40:41], v[64:65], v[64:65]
    v_pk_mul_f32 v[42:43], v[66:67], v[66:67]
    v_pk_mul_f32 v[44:45], v[68:69], v[68:69]
    v_pk_mul_f32 v[46:47], v[70:71], v[70:71]
    v_pk_mul_f32 v[48:49], v[72:73], v[72:73]
    v_pk_mul_f32 v[50:51], v[74:75], v[74:75]
    v_pk_mul_f32 v[52:53], v[76:77], v[76:77]
    v_pk_mul_f32 v[54:55], v[78:79], v[78:79]
    v_pk_fma_f32 v[40:41], v[40:41], v[58:59], v[56:57] op_sel_hi:[1,0,0]
    v_pk_fma_f32 v[42:43], v[42:43], v[58:59], v[56:57] op_sel_hi:[1,0,0]
    v_pk_fma_f32 v[44:45], v[44:45], v[58:59], v[56:57] op_sel_hi:[1,0,0]
    v_pk_fma_f32 v[46:47], v[46:47], v[58:59], v[56:57] op_sel_hi:[1,0,0]
    v_pk_fma_f32 v[48:49], v[48:49], v[58:59], v[56:57] op_sel_hi:[1,0,0]
    v_pk_fma_f32 v[50:51], v[50:51], v[58:59], v[56:57] op_sel_hi:[1,0,0]
    v_pk_fma_f32 v[52:53], v[52:53], v[58:59], v[56:57] op_sel_hi:[1,0,0]
    v_pk_fma_f32 v[54:55], v[54:55], v[58:59], v[56:57] op_sel_hi:[1,0,0]
    s_add_u32 m0, s66, 20480
    s_add_u32 s96, s71, 1024
    buffer_load_dwordx4 v4, s[40:43], s71 offen offset:0 sc1 lds
    v_pk_mul_f32 v[40:41], v[40:41], v[64:65]
    v_pk_mul_f32 v[42:43], v[42:43], v[66:67]
    v_pk_mul_f32 v[44:45], v[44:45], v[68:69]
    v_pk_mul_f32 v[46:47], v[46:47], v[70:71]
    v_pk_mul_f32 v[48:49], v[48:49], v[72:73]
    v_pk_mul_f32 v[50:51], v[50:51], v[74:75]
    v_pk_mul_f32 v[52:53], v[52:53], v[76:77]
    v_pk_mul_f32 v[54:55], v[54:55], v[78:79]
    v_exp_f32 v40, v40
    v_exp_f32 v41, v41
    v_exp_f32 v42, v42
    v_exp_f32 v43, v43
    buffer_load_dwordx4 v4, s[40:43], s71 offen offset:1024 sc1 lds
    v_exp_f32 v44, v44
    v_exp_f32 v45, v45
    v_exp_f32 v46, v46
    v_exp_f32 v47, v47
    v_exp_f32 v48, v48
    v_exp_f32 v49, v49
    v_exp_f32 v50, v50
    v_exp_f32 v51, v51
    buffer_load_dwordx4 v4, s[40:43], s71 offen offset:2048 sc1 lds
    v_exp_f32 v52, v52
    v_exp_f32 v53, v53
    v_exp_f32 v54, v54
    v_exp_f32 v55, v55
    v_pk_fma_f32 v[40:41], v[40:41], v[62:63], v[62:63] op_sel_hi:[1,0,0]
    v_pk_fma_f32 v[42:43], v[42:43], v[62:63], v[62:63] op_sel_hi:[1,0,0]
    v_pk_fma_f32 v[44:45], v[44:45], v[62:63], v[62:63] op_sel_hi:[1,0,0]
    v_pk_fma_f32 v[46:47], v[46:47], v[62:63], v[62:63] op_sel_hi:[1,0,0]
    v_pk_fma_f32 v[48:49], v[48:49], v[62:63], v[62:63] op_sel_hi:[1,0,0]
    v_pk_fma_f32 v[50:51], v[50:51], v[62:63], v[62:63] op_sel_hi:[1,0,0]
    v_pk_fma_f32 v[52:53], v[52:53], v[62:63], v[62:63] op_sel_hi:[1,0,0]
    v_pk_fma_f32 v[54:55], v[54:55], v[62:63], v[62:63] op_sel_hi:[1,0,0]
    buffer_load_dwordx4 v4, s[40:43], s71 offen offset:3072 sc1 lds
    v_rcp_f32 v40, v40
    v_rcp_f32 v41, v41
    v_rcp_f32 v42, v42
    v_rcp_f32 v43, v43
    v_rcp_f32 v44, v44
    v_rcp_f32 v45, v45
    v_rcp_f32 v46, v46
    v_rcp_f32 v47, v47
    s_add_u32 m0, s66, 21504
    s_nop 0
    buffer_load_dwordx4 v4, s[40:43], s96 offen offset:3072 sc1 lds
    v_rcp_f32 v48, v48
    v_rcp_f32 v49, v49
    v_rcp_f32 v50, v50
    v_rcp_f32 v51, v51
    v_rcp_f32 v52, v52
    v_rcp_f32 v53, v53
    v_rcp_f32 v54, v54
    v_rcp_f32 v55, v55
    s_add_u32 s71, s71, 10240
    s_cmp_ge_u32 s71, s72
    s_cselect_b32 s71, s73, s71
    v_pk_mul_f32 v[64:65], v[64:65], v[40:41]
    v_pk_mul_f32 v[66:67], v[66:67], v[42:43]
    v_pk_mul_f32 v[68:69], v[68:69], v[44:45]
    v_pk_mul_f32 v[70:71], v[70:71], v[46:47]
    v_pk_mul_f32 v[72:73], v[72:73], v[48:49]
    v_pk_mul_f32 v[74:75], v[74:75], v[50:51]
    v_pk_mul_f32 v[76:77], v[76:77], v[52:53]
    v_pk_mul_f32 v[78:79], v[78:79], v[54:55]
    v_cvt_pk_bf16_f32 v24, v64, v65
    v_cvt_pk_bf16_f32 v25, v66, v67
    v_cvt_pk_bf16_f32 v26, v68, v69
    v_cvt_pk_bf16_f32 v27, v70, v71
    v_cvt_pk_bf16_f32 v28, v72, v73
    v_cvt_pk_bf16_f32 v29, v74, v75
    v_cvt_pk_bf16_f32 v30, v76, v77
    v_cvt_pk_bf16_f32 v31, v78, v79
    s_add_u32 m0, s66, 40960
    s_add_u32 s96, s71, 1024
    buffer_load_dwordx4 v4, s[40:43], s71 offen offset:0 sc1 lds
    buffer_store_dwordx4 v[24:27], v4, s[40:43], s91 offen offset:0 sc1
    buffer_store_dwordx4 v[28:31], v4, s[40:43], s91 offen offset:1024 sc1
    v_pk_mul_f32 v[40:41], v[80:81], v[80:81]
    v_pk_mul_f32 v[42:43], v[82:83], v[82:83]
    v_pk_mul_f32 v[44:45], v[84:85], v[84:85]
    v_pk_mul_f32 v[46:47], v[86:87], v[86:87]
    v_pk_mul_f32 v[48:49], v[88:89], v[88:89]
    v_pk_mul_f32 v[50:51], v[90:91], v[90:91]
    v_pk_mul_f32 v[52:53], v[92:93], v[92:93]
    v_pk_mul_f32 v[54:55], v[94:95], v[94:95]
    v_pk_fma_f32 v[40:41], v[40:41], v[58:59], v[56:57] op_sel_hi:[1,0,0]
    v_pk_fma_f32 v[42:43], v[42:43], v[58:59], v[56:57] op_sel_hi:[1,0,0]
    v_pk_fma_f32 v[44:45], v[44:45], v[58:59], v[56:57] op_sel_hi:[1,0,0]
    v_pk_fma_f32 v[46:47], v[46:47], v[58:59], v[56:57] op_sel_hi:[1,0,0]
    v_pk_fma_f32 v[48:49], v[48:49], v[58:59], v[56:57] op_sel_hi:[1,0,0]
    v_pk_fma_f32 v[50:51], v[50:51], v[58:59], v[56:57] op_sel_hi:[1,0,0]
    v_pk_fma_f32 v[52:53], v[52:53], v[58:59], v[56:57] op_sel_hi:[1,0,0]
    v_pk_fma_f32 v[54:55], v[54:55], v[58:59], v[56:57] op_sel_hi:[1,0,0]
    buffer_load_dwordx4 v4, s[40:43], s71 offen offset:1024 sc1 lds
    v_pk_mul_f32 v[40:41], v[40:41], v[80:81]
    v_pk_mul_f32 v[42:43], v[42:43], v[82:83]
    v_pk_mul_f32 v[44:45], v[44:45], v[84:85]
    v_pk_mul_f32 v[46:47], v[46:47], v[86:87]
    v_pk_mul_f32 v[48:49], v[48:49], v[88:89]
    v_pk_mul_f32 v[50:51], v[50:51], v[90:91]
    v_pk_mul_f32 v[52:53], v[52:53], v[92:93]
    v_pk_mul_f32 v[54:55], v[54:55], v[94:95]
    v_exp_f32 v40, v40
    v_exp_f32 v41, v41
    v_exp_f32 v42, v42
    v_exp_f32 v43, v43
    buffer_load_dwordx4 v4, s[40:43], s71 offen offset:2048 sc1 lds
    v_exp_f32 v44, v44
    v_exp_f32 v45, v45
    v_exp_f32 v46, v46
    v_exp_f32 v47, v47
    v_exp_f32 v48, v48
    v_exp_f32 v49, v49
    v_exp_f32 v50, v50
    v_exp_f32 v51, v51
    buffer_load_dwordx4 v4, s[40:43], s71 offen offset:3072 sc1 lds
    v_exp_f32 v52, v52
    v_exp_f32 v53, v53
    v_exp_f32 v54, v54
    v_exp_f32 v55, v55
    v_pk_fma_f32 v[40:41], v[40:41], v[62:63], v[62:63] op_sel_hi:[1,0,0]
    v_pk_fma_f32 v[42:43], v[42:43], v[62:63], v[62:63] op_sel_hi:[1,0,0]
    v_pk_fma_f32 v[44:45], v[44:45], v[62:63], v[62:63] op_sel_hi:[1,0,0]
    v_pk_fma_f32 v[46:47], v[46:47], v[62:63], v[62:63] op_sel_hi:[1,0,0]
    v_pk_fma_f32 v[48:49], v[48:49], v[62:63], v[62:63] op_sel_hi:[1,0,0]
    v_pk_fma_f32 v[50:51], v[50:51], v[62:63], v[62:63] op_sel_hi:[1,0,0]
    v_pk_fma_f32 v[52:53], v[52:53], v[62:63], v[62:63] op_sel_hi:[1,0,0]
    v_pk_fma_f32 v[54:55], v[54:55], v[62:63], v[62:63] op_sel_hi:[1,0,0]
    s_add_u32 m0, s66, 41984
    s_nop 0
    buffer_load_dwordx4 v4, s[40:43], s96 offen offset:3072 sc1 lds
    v_rcp_f32 v40, v40
    v_rcp_f32 v41, v41
    v_rcp_f32 v42, v42
    v_rcp_f32 v43, v43
    v_rcp_f32 v44, v44
    v_rcp_f32 v45, v45
    v_rcp_f32 v46, v46
    v_rcp_f32 v47, v47
    s_add_u32 s71, s71, 10240
    s_cmp_ge_u32 s71, s72
    s_cselect_b32 s71, s73, s71
    v_rcp_f32 v48, v48
    v_rcp_f32 v49, v49
    v_rcp_f32 v50, v50
    v_rcp_f32 v51, v51
    v_rcp_f32 v52, v52
    v_rcp_f32 v53, v53
    v_rcp_f32 v54, v54
    v_rcp_f32 v55, v55
    s_add_u32 m0, s66, 61440
    s_add_u32 s96, s71, 1024
    buffer_load_dwordx4 v4, s[40:43], s71 offen offset:0 sc1 lds
    v_pk_mul_f32 v[80:81], v[80:81], v[40:41]
    v_pk_mul_f32 v[82:83], v[82:83], v[42:43]
    v_pk_mul_f32 v[84:85], v[84:85], v[44:45]
    v_pk_mul_f32 v[86:87], v[86:87], v[46:47]
    v_pk_mul_f32 v[88:89], v[88:89], v[48:49]
    v_pk_mul_f32 v[90:91], v[90:91], v[50:51]
    v_pk_mul_f32 v[92:93], v[92:93], v[52:53]
    v_pk_mul_f32 v[94:95], v[94:95], v[54:55]
    v_cvt_pk_bf16_f32 v32, v80, v81
    v_cvt_pk_bf16_f32 v33, v82, v83
    v_cvt_pk_bf16_f32 v34, v84, v85
    v_cvt_pk_bf16_f32 v35, v86, v87
    v_cvt_pk_bf16_f32 v36, v88, v89
    v_cvt_pk_bf16_f32 v37, v90, v91
    v_cvt_pk_bf16_f32 v38, v92, v93
    v_cvt_pk_bf16_f32 v39, v94, v95
    buffer_load_dwordx4 v4, s[40:43], s71 offen offset:1024 sc1 lds
    buffer_store_dwordx4 v[32:35], v4, s[40:43], s91 offen offset:2048 sc1
    buffer_store_dwordx4 v[36:39], v4, s[40:43], s91 offen offset:3072 sc1
    v_pk_mul_f32 v[40:41], v[96:97], v[96:97]
    v_pk_mul_f32 v[42:43], v[98:99], v[98:99]
    v_pk_mul_f32 v[44:45], v[100:101], v[100:101]
    v_pk_mul_f32 v[46:47], v[102:103], v[102:103]
    v_pk_mul_f32 v[48:49], v[104:105], v[104:105]
    v_pk_mul_f32 v[50:51], v[106:107], v[106:107]
    v_pk_mul_f32 v[52:53], v[108:109], v[108:109]
    v_pk_mul_f32 v[54:55], v[110:111], v[110:111]
    v_pk_fma_f32 v[40:41], v[40:41], v[58:59], v[56:57] op_sel_hi:[1,0,0]
    v_pk_fma_f32 v[42:43], v[42:43], v[58:59], v[56:57] op_sel_hi:[1,0,0]
    v_pk_fma_f32 v[44:45], v[44:45], v[58:59], v[56:57] op_sel_hi:[1,0,0]
    v_pk_fma_f32 v[46:47], v[46:47], v[58:59], v[56:57] op_sel_hi:[1,0,0]
    v_pk_fma_f32 v[48:49], v[48:49], v[58:59], v[56:57] op_sel_hi:[1,0,0]
    v_pk_fma_f32 v[50:51], v[50:51], v[58:59], v[56:57] op_sel_hi:[1,0,0]
    v_pk_fma_f32 v[52:53], v[52:53], v[58:59], v[56:57] op_sel_hi:[1,0,0]
    v_pk_fma_f32 v[54:55], v[54:55], v[58:59], v[56:57] op_sel_hi:[1,0,0]
    buffer_load_dwordx4 v4, s[40:43], s71 offen offset:2048 sc1 lds
    v_pk_mul_f32 v[40:41], v[40:41], v[96:97]
    v_pk_mul_f32 v[42:43], v[42:43], v[98:99]
    v_pk_mul_f32 v[44:45], v[44:45], v[100:101]
    v_pk_mul_f32 v[46:47], v[46:47], v[102:103]
    v_pk_mul_f32 v[48:49], v[48:49], v[104:105]
    v_pk_mul_f32 v[50:51], v[50:51], v[106:107]
    v_pk_mul_f32 v[52:53], v[52:53], v[108:109]
    v_pk_mul_f32 v[54:55], v[54:55], v[110:111]
    v_exp_f32 v40, v40
    v_exp_f32 v41, v41
    v_exp_f32 v42, v42
    v_exp_f32 v43, v43
    buffer_load_dwordx4 v4, s[40:43], s71 offen offset:3072 sc1 lds
    v_exp_f32 v44, v44
    v_exp_f32 v45, v45
    v_exp_f32 v46, v46
    v_exp_f32 v47, v47
    v_exp_f32 v48, v48
    v_exp_f32 v49, v49
    v_exp_f32 v50, v50
    v_exp_f32 v51, v51
    s_add_u32 m0, s66, 62464
    s_nop 0
    buffer_load_dwordx4 v4, s[40:43], s96 offen offset:3072 sc1 lds
    v_exp_f32 v52, v52
    v_exp_f32 v53, v53
    v_exp_f32 v54, v54
    v_exp_f32 v55, v55
    v_pk_fma_f32 v[40:41], v[40:41], v[62:63], v[62:63] op_sel_hi:[1,0,0]
    v_pk_fma_f32 v[42:43], v[42:43], v[62:63], v[62:63] op_sel_hi:[1,0,0]
    v_pk_fma_f32 v[44:45], v[44:45], v[62:63], v[62:63] op_sel_hi:[1,0,0]
    v_pk_fma_f32 v[46:47], v[46:47], v[62:63], v[62:63] op_sel_hi:[1,0,0]
    v_pk_fma_f32 v[48:49], v[48:49], v[62:63], v[62:63] op_sel_hi:[1,0,0]
    v_pk_fma_f32 v[50:51], v[50:51], v[62:63], v[62:63] op_sel_hi:[1,0,0]
    v_pk_fma_f32 v[52:53], v[52:53], v[62:63], v[62:63] op_sel_hi:[1,0,0]
    v_pk_fma_f32 v[54:55], v[54:55], v[62:63], v[62:63] op_sel_hi:[1,0,0]
    s_add_u32 s71, s71, 10240
    s_cmp_ge_u32 s71, s72
    s_cselect_b32 s71, s73, s71
    v_rcp_f32 v40, v40
    v_rcp_f32 v41, v41
    v_rcp_f32 v42, v42
    v_rcp_f32 v43, v43
    v_rcp_f32 v44, v44
    v_rcp_f32 v45, v45
    v_rcp_f32 v46, v46
    v_rcp_f32 v47, v47
    s_add_u32 m0, s66, 81920
    s_add_u32 s96, s71, 1024
    buffer_load_dwordx4 v4, s[40:43], s71 offen offset:0 sc1 lds
    v_rcp_f32 v48, v48
    v_rcp_f32 v49, v49
    v_rcp_f32 v50, v50
    v_rcp_f32 v51, v51
    v_rcp_f32 v52, v52
    v_rcp_f32 v53, v53
    v_rcp_f32 v54, v54
    v_rcp_f32 v55, v55
    buffer_load_dwordx4 v4, s[40:43], s71 offen offset:1024 sc1 lds
    v_pk_mul_f32 v[96:97], v[96:97], v[40:41]
    v_pk_mul_f32 v[98:99], v[98:99], v[42:43]
    v_pk_mul_f32 v[100:101], v[100:101], v[44:45]
    v_pk_mul_f32 v[102:103], v[102:103], v[46:47]
    v_pk_mul_f32 v[104:105], v[104:105], v[48:49]
    v_pk_mul_f32 v[106:107], v[106:107], v[50:51]
    v_pk_mul_f32 v[108:109], v[108:109], v[52:53]
    v_pk_mul_f32 v[110:111], v[110:111], v[54:55]
    v_cvt_pk_bf16_f32 v24, v96, v97
    v_cvt_pk_bf16_f32 v25, v98, v99
    v_cvt_pk_bf16_f32 v26, v100, v101
    v_cvt_pk_bf16_f32 v27, v102, v103
    v_cvt_pk_bf16_f32 v28, v104, v105
    v_cvt_pk_bf16_f32 v29, v106, v107
    v_cvt_pk_bf16_f32 v30, v108, v109
    v_cvt_pk_bf16_f32 v31, v110, v111
    buffer_load_dwordx4 v4, s[40:43], s71 offen offset:2048 sc1 lds
    s_add_u32 s91, s91, 4096
    buffer_store_dwordx4 v[24:27], v4, s[40:43], s91 offen offset:0 sc1
    buffer_store_dwordx4 v[28:31], v4, s[40:43], s91 offen offset:1024 sc1
    v_pk_mul_f32 v[40:41], v[112:113], v[112:113]
    v_pk_mul_f32 v[42:43], v[114:115], v[114:115]
    v_pk_mul_f32 v[44:45], v[116:117], v[116:117]
    v_pk_mul_f32 v[46:47], v[118:119], v[118:119]
    v_pk_mul_f32 v[48:49], v[120:121], v[120:121]
    v_pk_mul_f32 v[50:51], v[122:123], v[122:123]
    v_pk_mul_f32 v[52:53], v[124:125], v[124:125]
    v_pk_mul_f32 v[54:55], v[126:127], v[126:127]
    v_pk_fma_f32 v[40:41], v[40:41], v[58:59], v[56:57] op_sel_hi:[1,0,0]
    v_pk_fma_f32 v[42:43], v[42:43], v[58:59], v[56:57] op_sel_hi:[1,0,0]
    v_pk_fma_f32 v[44:45], v[44:45], v[58:59], v[56:57] op_sel_hi:[1,0,0]
    v_pk_fma_f32 v[46:47], v[46:47], v[58:59], v[56:57] op_sel_hi:[1,0,0]
    v_pk_fma_f32 v[48:49], v[48:49], v[58:59], v[56:57] op_sel_hi:[1,0,0]
    v_pk_fma_f32 v[50:51], v[50:51], v[58:59], v[56:57] op_sel_hi:[1,0,0]
    v_pk_fma_f32 v[52:53], v[52:53], v[58:59], v[56:57] op_sel_hi:[1,0,0]
    v_pk_fma_f32 v[54:55], v[54:55], v[58:59], v[56:57] op_sel_hi:[1,0,0]
    buffer_load_dwordx4 v4, s[40:43], s71 offen offset:3072 sc1 lds
    v_pk_mul_f32 v[40:41], v[40:41], v[112:113]
    v_pk_mul_f32 v[42:43], v[42:43], v[114:115]
    v_pk_mul_f32 v[44:45], v[44:45], v[116:117]
    v_pk_mul_f32 v[46:47], v[46:47], v[118:119]
    v_pk_mul_f32 v[48:49], v[48:49], v[120:121]
    v_pk_mul_f32 v[50:51], v[50:51], v[122:123]
    v_pk_mul_f32 v[52:53], v[52:53], v[124:125]
    v_pk_mul_f32 v[54:55], v[54:55], v[126:127]
    v_exp_f32 v40, v40
    v_exp_f32 v41, v41
    v_exp_f32 v42, v42
    v_exp_f32 v43, v43
    s_add_u32 m0, s66, 82944
    s_nop 0
    buffer_load_dwordx4 v4, s[40:43], s96 offen offset:3072 sc1 lds
    v_exp_f32 v44, v44
    v_exp_f32 v45, v45
    v_exp_f32 v46, v46
    v_exp_f32 v47, v47
    v_exp_f32 v48, v48
    v_exp_f32 v49, v49
    v_exp_f32 v50, v50
    v_exp_f32 v51, v51
    s_add_u32 s71, s71, 10240
    s_cmp_ge_u32 s71, s72
    s_cselect_b32 s71, s73, s71
    v_exp_f32 v52, v52
    v_exp_f32 v53, v53
    v_exp_f32 v54, v54
    v_exp_f32 v55, v55
    v_pk_fma_f32 v[40:41], v[40:41], v[62:63], v[62:63] op_sel_hi:[1,0,0]
    v_pk_fma_f32 v[42:43], v[42:43], v[62:63], v[62:63] op_sel_hi:[1,0,0]
    v_pk_fma_f32 v[44:45], v[44:45], v[62:63], v[62:63] op_sel_hi:[1,0,0]
    v_pk_fma_f32 v[46:47], v[46:47], v[62:63], v[62:63] op_sel_hi:[1,0,0]
    v_pk_fma_f32 v[48:49], v[48:49], v[62:63], v[62:63] op_sel_hi:[1,0,0]
    v_pk_fma_f32 v[50:51], v[50:51], v[62:63], v[62:63] op_sel_hi:[1,0,0]
    v_pk_fma_f32 v[52:53], v[52:53], v[62:63], v[62:63] op_sel_hi:[1,0,0]
    v_pk_fma_f32 v[54:55], v[54:55], v[62:63], v[62:63] op_sel_hi:[1,0,0]
    s_add_u32 m0, s66, 0
    s_add_u32 s96, s71, 1024
    buffer_load_dwordx4 v4, s[40:43], s71 offen offset:0 sc1 lds
    v_rcp_f32 v40, v40
    v_rcp_f32 v41, v41
    v_rcp_f32 v42, v42
    v_rcp_f32 v43, v43
    v_rcp_f32 v44, v44
    v_rcp_f32 v45, v45
    v_rcp_f32 v46, v46
    v_rcp_f32 v47, v47
    buffer_load_dwordx4 v4, s[40:43], s71 offen offset:1024 sc1 lds
    v_rcp_f32 v48, v48
    v_rcp_f32 v49, v49
    v_rcp_f32 v50, v50
    v_rcp_f32 v51, v51
    v_rcp_f32 v52, v52
    v_rcp_f32 v53, v53
    v_rcp_f32 v54, v54
    v_rcp_f32 v55, v55
    buffer_load_dwordx4 v4, s[40:43], s71 offen offset:2048 sc1 lds
    v_pk_mul_f32 v[112:113], v[112:113], v[40:41]
    v_pk_mul_f32 v[114:115], v[114:115], v[42:43]
    v_pk_mul_f32 v[116:117], v[116:117], v[44:45]
    v_pk_mul_f32 v[118:119], v[118:119], v[46:47]
    v_pk_mul_f32 v[120:121], v[120:121], v[48:49]
    v_pk_mul_f32 v[122:123], v[122:123], v[50:51]
    v_pk_mul_f32 v[124:125], v[124:125], v[52:53]
    v_pk_mul_f32 v[126:127], v[126:127], v[54:55]
    v_cvt_pk_bf16_f32 v32, v112, v113
    v_cvt_pk_bf16_f32 v33, v114, v115
    v_cvt_pk_bf16_f32 v34, v116, v117
    v_cvt_pk_bf16_f32 v35, v118, v119
    v_cvt_pk_bf16_f32 v36, v120, v121
    v_cvt_pk_bf16_f32 v37, v122, v123
    v_cvt_pk_bf16_f32 v38, v124, v125
    v_cvt_pk_bf16_f32 v39, v126, v127
    buffer_load_dwordx4 v4, s[40:43], s71 offen offset:3072 sc1 lds
    s_add_u32 m0, s66, 1024
    s_nop 0
    buffer_load_dwordx4 v4, s[40:43], s96 offen offset:3072 sc1 lds
    s_add_u32 s71, s71, 10240
    s_cmp_ge_u32 s71, s72
    s_cselect_b32 s71, s73, s71
    buffer_store_dwordx4 v[32:35], v4, s[40:43], s91 offen offset:2048 sc1
    buffer_store_dwordx4 v[36:39], v4, s[40:43], s91 offen offset:3072 sc1
    s_branch L_p3_done
L_p3_s:
    s_waitcnt vmcnt(7)
    v_cvt_pk_bf16_f32 v32, v128, v129
    v_cvt_pk_bf16_f32 v33, v130, v131
    s_waitcnt vmcnt(6)
    v_cvt_pk_bf16_f32 v34, v132, v133
    v_cvt_pk_bf16_f32 v35, v134, v135
    s_waitcnt vmcnt(5)
    v_cvt_pk_bf16_f32 v36, v136, v137
    v_cvt_pk_bf16_f32 v37, v138, v139
    s_waitcnt vmcnt(4)
    v_cvt_pk_bf16_f32 v38, v140, v141
    v_cvt_pk_bf16_f32 v39, v142, v143
    s_waitcnt vmcnt(3)
    v_mfma_f32_32x32x16_bf16 v[64:79], v[32:35], v[160:163], 0
    s_waitcnt vmcnt(2)
    v_mfma_f32_32x32x16_bf16 v[64:79], v[36:39], v[164:167], v[64:79]
    s_waitcnt vmcnt(1)
    v_mfma_f32_32x32x16_bf16 v[80:95], v[32:35], v[168:171], 0
    s_waitcnt vmcnt(0)
    v_mfma_f32_32x32x16_bf16 v[80:95], v[36:39], v[172:175], v[80:95]
    s_nop 7
    v_add_f32 v76, 0x358637bd, v76
    v_rcp_f32 v76, v76
    s_nop 0
    v_pk_mul_f32 v[64:65], v[64:65], v[76:77] op_sel_hi:[1,0]
    v_pk_mul_f32 v[66:67], v[66:67], v[76:77] op_sel_hi:[1,0]
    v_pk_mul_f32 v[68:69], v[68:69], v[76:77] op_sel_hi:[1,0]
    v_pk_mul_f32 v[70:71], v[70:71], v[76:77] op_sel_hi:[1,0]
    v_pk_mul_f32 v[72:73], v[72:73], v[76:77] op_sel_hi:[1,0]
    v_pk_mul_f32 v[74:75], v[74:75], v[76:77] op_sel_hi:[1,0]
    v_cvt_pk_bf16_f32 v16, v64, v65
    v_cvt_pk_bf16_f32 v17, v66, v67
    v_cvt_pk_bf16_f32 v18, v68, v69
    v_cvt_pk_bf16_f32 v19, v70, v71
    v_cvt_pk_bf16_f32 v20, v72, v73
    v_cvt_pk_bf16_f32 v21, v74, v75
    ds_write_b64 v228, v[16:17] offset:0
    ds_write_b64 v229, v[18:19] offset:0
    ds_write_b64 v230, v[20:21] offset:0
    v_add_f32 v92, 0x358637bd, v92
    v_rcp_f32 v92, v92
    s_nop 0
    v_pk_mul_f32 v[80:81], v[80:81], v[92:93] op_sel_hi:[1,0]
    v_pk_mul_f32 v[82:83], v[82:83], v[92:93] op_sel_hi:[1,0]
    v_pk_mul_f32 v[84:85], v[84:85], v[92:93] op_sel_hi:[1,0]
    v_pk_mul_f32 v[86:87], v[86:87], v[92:93] op_sel_hi:[1,0]
    v_pk_mul_f32 v[88:89], v[88:89], v[92:93] op_sel_hi:[1,0]
    v_pk_mul_f32 v[90:91], v[90:91], v[92:93] op_sel_hi:[1,0]
    v_cvt_pk_bf16_f32 v22, v80, v81
    v_cvt_pk_bf16_f32 v23, v82, v83
    v_cvt_pk_bf16_f32 v24, v84, v85
    v_cvt_pk_bf16_f32 v25, v86, v87
    v_cvt_pk_bf16_f32 v26, v88, v89
    v_cvt_pk_bf16_f32 v27, v90, v91
    ds_write_b64 v228, v[22:23] offset:5120
    ds_write_b64 v229, v[24:25] offset:5120
    ds_write_b64 v230, v[26:27] offset:5120
    s_waitcnt lgkmcnt(0)
    s_cmp_lg_u32 s60, 0
    s_cbranch_scc1 L_wd_32
    s_mov_b32 s84, 3
    v_lshlrev_b32 v1, 2, v0
    s_lshl_b32 s82, s61, 9
    s_lshl_b32 s83, s84, 6
    s_add_u32 s82, s82, s83
    s_add_u32 s82, s82, 22020096
    s_mov_b64 exec, 65535
    s_mov_b32 s85, 0
    s_cmp_eq_u32 s64, 0
    s_cbranch_scc1 L_wsl_33
L_wf_34:
    buffer_load_dword v2, v1, s[40:43], s82 offen sc1
    s_add_u32 s85, s85, 1
    s_waitcnt vmcnt(0)
    v_cmp_ne_u32 vcc, v2, v15
    s_cbranch_vccz L_wd_32
    s_cmp_lt_u32 s85, 96
    s_cbranch_scc1 L_wf_34
    s_mov_b32 s64, 0
L_wsl_33:
    s_lshl_b32 s82, s61, 6
    s_lshl_b32 s83, s84, 10
    s_add_u32 s82, s82, s83
    s_add_u32 s82, s82, 22085632
L_ws_35:
    buffer_load_dword v2, v1, s[40:43], s82 offen sc1
    s_add_u32 s85, s85, 1
    s_waitcnt vmcnt(0)
    v_cmp_ne_u32 vcc, v2, v15
    s_cbranch_vccz L_wd_32
    s_cmp_lt_u32 s85, 400000
    s_cbranch_scc1 L_ws_35
L_wd_32:
    s_mov_b64 exec, -1
    s_barrier
    ds_read_b128 v[128:131], v232 offset:0
    ds_read_b128 v[132:135], v232 offset:1024
    ds_read_b128 v[136:139], v232 offset:2048
    s_waitcnt lgkmcnt(2)
    buffer_store_dwordx4 v[128:131], v4, s[40:43], s90 offen offset:0 sc1
    s_waitcnt lgkmcnt(1)
    buffer_store_dwordx4 v[132:135], v4, s[40:43], s90 offen offset:1024 sc1
    s_waitcnt lgkmcnt(0)
    buffer_store_dwordx4 v[136:139], v4, s[40:43], s91 offen offset:2048 sc1
    s_add_u32 m0, s66, 20480
    s_nop 0
    buffer_load_dwordx4 v5, s[44:47], s67 offen offset:0  lds
    buffer_load_dwordx4 v6, s[44:47], s67 offen offset:1024  lds
    buffer_load_dwordx4 v7, s[44:47], s67 offen offset:2048  lds
    buffer_load_dwordx4 v8, s[44:47], s67 offen offset:3072  lds
    s_add_u32 m0, s66, 21504
    s_nop 0
    buffer_load_dwordx4 v9, s[44:47], s67 offen offset:3072  lds
    s_add_u32 s67, s67, s68
    s_cmp_ge_u32 s67, s69
    s_cselect_b32 s67, s70, s67
    s_waitcnt vmcnt(5)
    s_barrier
    s_cmp_gt_u32 s60, 1
    s_cbranch_scc1 L_fs_36
    s_mov_b64 exec, 1
    s_cmp_eq_u32 s60, 0
    s_cbranch_scc1 L_fs_37
    s_lshl_b32 s93, s65, 2
    s_add_u32 s93, s93, 22089728
    buffer_store_dword v15, v4, s[40:43], s93 offen sc1
    s_branch L_fs_36
L_fs_37:
    s_lshl_b32 s92, s61, 9
    s_lshl_b32 s93, s62, 2
    s_add_u32 s92, s92, s93
    s_add_u32 s92, s92, 22020352
    buffer_store_dword v15, v4, s[40:43], s92 offen
L_fs_36:
    s_mov_b64 exec, -1
    s_add_u32 m0, s66, 40960
    s_nop 0
    buffer_load_dwordx4 v5, s[44:47], s67 offen offset:0  lds
    buffer_load_dwordx4 v6, s[44:47], s67 offen offset:1024  lds
    buffer_load_dwordx4 v7, s[44:47], s67 offen offset:2048  lds
    buffer_load_dwordx4 v8, s[44:47], s67 offen offset:3072  lds
    s_add_u32 m0, s66, 41984
    s_nop 0
    buffer_load_dwordx4 v9, s[44:47], s67 offen offset:3072  lds
    s_add_u32 s67, s67, s68
    s_cmp_ge_u32 s67, s69
    s_cselect_b32 s67, s70, s67
    s_cmp_lg_u32 s60, 0
    s_cbranch_scc1 L_wd_38
    s_mov_b32 s84, 4
    v_lshlrev_b32 v1, 2, v0
    s_lshl_b32 s82, s61, 9
    s_lshl_b32 s83, s84, 6
    s_add_u32 s82, s82, s83
    s_add_u32 s82, s82, 22020096
    s_mov_b64 exec, 65535
    s_mov_b32 s85, 0
    s_cmp_eq_u32 s64, 0
    s_cbranch_scc1 L_wsl_39
L_wf_40:
    buffer_load_dword v2, v1, s[40:43], s82 offen sc1
    s_add_u32 s85, s85, 1
    s_waitcnt vmcnt(0)
    v_cmp_ne_u32 vcc, v2, v15
    s_cbranch_vccz L_wd_38
    s_cmp_lt_u32 s85, 96
    s_cbranch_scc1 L_wf_40
    s_mov_b32 s64, 0
L_wsl_39:
    s_lshl_b32 s82, s61, 6
    s_lshl_b32 s83, s84, 10
    s_add_u32 s82, s82, s83
    s_add_u32 s82, s82, 22085632
L_ws_41:
    buffer_load_dword v2, v1, s[40:43], s82 offen sc1
    s_add_u32 s85, s85, 1
    s_waitcnt vmcnt(0)
    v_cmp_ne_u32 vcc, v2, v15
    s_cbranch_vccz L_wd_38
    s_cmp_lt_u32 s85, 400000
    s_cbranch_scc1 L_ws_41
L_wd_38:
    s_mov_b64 exec, -1
    s_barrier
    buffer_load_dwordx4 a[0:3], v4, s[40:43], s74 offen offset:0 sc1
    buffer_load_dwordx4 a[4:7], v4, s[40:43], s74 offen offset:1024 sc1
    buffer_load_dwordx4 a[8:11], v4, s[40:43], s74 offen offset:2048 sc1
    buffer_load_dwordx4 a[12:15], v4, s[40:43], s74 offen offset:3072 sc1
    s_add_u32 s74, s74, 4096
    s_cmp_ge_u32 s74, s75
    s_cselect_b32 s74, s76, s74
    buffer_load_dwordx4 a[16:19], v4, s[40:43], s74 offen offset:0 sc1
    buffer_load_dwordx4 a[20:23], v4, s[40:43], s74 offen offset:1024 sc1
    buffer_load_dwordx4 a[24:27], v4, s[40:43], s74 offen offset:2048 sc1
    buffer_load_dwordx4 a[28:31], v4, s[40:43], s74 offen offset:3072 sc1
    s_add_u32 s74, s74, 4096
    s_cmp_ge_u32 s74, s75
    s_cselect_b32 s74, s76, s74
    s_barrier
    ds_read_b64_tr_b16 v[16:17], v150 offset:20480
    ds_read_b64_tr_b16 v[18:19], v150 offset:23040
    ds_read_b64_tr_b16 v[20:21], v150 offset:20544
    ds_read_b64_tr_b16 v[22:23], v150 offset:23104
    ds_read_b64_tr_b16 v[24:25], v150 offset:20608
    ds_read_b64_tr_b16 v[26:27], v150 offset:23168
    ds_read_b64_tr_b16 v[28:29], v150 offset:20672
    ds_read_b64_tr_b16 v[30:31], v150 offset:23232
    ds_read_b64_tr_b16 v[32:33], v150 offset:20736
    ds_read_b64_tr_b16 v[34:35], v150 offset:23296
    s_waitcnt vmcnt(7) lgkmcnt(8)
    v_mfma_f32_32x32x16_bf16 v[64:79], v[16:19], a[0:3], 0
    ds_read_b64_tr_b16 v[36:37], v150 offset:25600
    ds_read_b64_tr_b16 v[38:39], v150 offset:28160
    ds_read_b64_tr_b16 v[40:41], v150 offset:25664
    buffer_load_dwordx4 a[32:35], v4, s[40:43], s74 offen offset:0 sc1
    s_waitcnt lgkmcnt(9)
    v_mfma_f32_32x32x16_bf16 v[80:95], v[20:23], a[0:3], 0
    ds_read_b64_tr_b16 v[42:43], v150 offset:28224
    ds_read_b64_tr_b16 v[44:45], v150 offset:25728
    buffer_load_dwordx4 a[36:39], v4, s[40:43], s74 offen offset:1024 sc1
    s_waitcnt lgkmcnt(9)
    v_mfma_f32_32x32x16_bf16 v[96:111], v[24:27], a[0:3], 0
    ds_read_b64_tr_b16 v[46:47], v150 offset:28288
    ds_read_b64_tr_b16 v[48:49], v150 offset:25792
    ds_read_b64_tr_b16 v[50:51], v150 offset:28352
    s_waitcnt lgkmcnt(10)
    v_mfma_f32_32x32x16_bf16 v[112:127], v[28:31], a[0:3], 0
    ds_read_b64_tr_b16 v[52:53], v150 offset:25856
    ds_read_b64_tr_b16 v[54:55], v150 offset:28416
    buffer_load_dwordx4 a[40:43], v4, s[40:43], s74 offen offset:2048 sc1
    s_waitcnt lgkmcnt(10)
    v_mfma_f32_32x32x16_bf16 v[128:143], v[32:35], a[0:3], 0
    buffer_load_dwordx4 a[44:47], v4, s[40:43], s74 offen offset:3072 sc1
    s_waitcnt vmcnt(10) lgkmcnt(8)
    v_mfma_f32_32x32x16_bf16 v[64:79], v[36:39], a[4:7], v[64:79]
    ds_read_b64_tr_b16 v[16:17], v150 offset:30720
    ds_read_b64_tr_b16 v[18:19], v150 offset:33280
    ds_read_b64_tr_b16 v[20:21], v150 offset:30784
    s_waitcnt lgkmcnt(9)
    v_mfma_f32_32x32x16_bf16 v[80:95], v[40:43], a[4:7], v[80:95]
    ds_read_b64_tr_b16 v[22:23], v150 offset:33344
    ds_read_b64_tr_b16 v[24:25], v150 offset:30848
    s_add_u32 s74, s74, 4096
    s_cmp_ge_u32 s74, s75
    s_cselect_b32 s74, s76, s74
    s_waitcnt lgkmcnt(9)
    v_mfma_f32_32x32x16_bf16 v[96:111], v[44:47], a[4:7], v[96:111]
    ds_read_b64_tr_b16 v[26:27], v150 offset:33408
    ds_read_b64_tr_b16 v[28:29], v150 offset:30912
    ds_read_b64_tr_b16 v[30:31], v150 offset:33472
    s_waitcnt lgkmcnt(10)
    v_mfma_f32_32x32x16_bf16 v[112:127], v[48:51], a[4:7], v[112:127]
    ds_read_b64_tr_b16 v[32:33], v150 offset:30976
    ds_read_b64_tr_b16 v[34:35], v150 offset:33536
    s_add_u32 m0, s66, 61440
    s_waitcnt lgkmcnt(10)
    v_mfma_f32_32x32x16_bf16 v[128:143], v[52:55], a[4:7], v[128:143]
    buffer_load_dwordx4 v5, s[44:47], s67 offen offset:0  lds
    s_waitcnt vmcnt(10) lgkmcnt(8)
    v_mfma_f32_32x32x16_bf16 v[64:79], v[16:19], a[8:11], v[64:79]
    ds_read_b64_tr_b16 v[36:37], v150 offset:35840
    ds_read_b64_tr_b16 v[38:39], v150 offset:38400
    ds_read_b64_tr_b16 v[40:41], v150 offset:35904
    buffer_load_dwordx4 v6, s[44:47], s67 offen offset:1024  lds
    s_waitcnt lgkmcnt(9)
    v_mfma_f32_32x32x16_bf16 v[80:95], v[20:23], a[8:11], v[80:95]
    ds_read_b64_tr_b16 v[42:43], v150 offset:38464
    ds_read_b64_tr_b16 v[44:45], v150 offset:35968
    s_waitcnt lgkmcnt(9)
    v_mfma_f32_32x32x16_bf16 v[96:111], v[24:27], a[8:11], v[96:111]
    ds_read_b64_tr_b16 v[46:47], v150 offset:38528
    ds_read_b64_tr_b16 v[48:49], v150 offset:36032
    ds_read_b64_tr_b16 v[50:51], v150 offset:38592
    buffer_load_dwordx4 v7, s[44:47], s67 offen offset:2048  lds
    s_waitcnt lgkmcnt(10)
    v_mfma_f32_32x32x16_bf16 v[112:127], v[28:31], a[8:11], v[112:127]
    ds_read_b64_tr_b16 v[52:53], v150 offset:36096
    ds_read_b64_tr_b16 v[54:55], v150 offset:38656
    buffer_load_dwordx4 v8, s[44:47], s67 offen offset:3072  lds
    s_waitcnt lgkmcnt(10)
    v_mfma_f32_32x32x16_bf16 v[128:143], v[32:35], a[8:11], v[128:143]
    s_waitcnt vmcnt(12) lgkmcnt(8)
    v_mfma_f32_32x32x16_bf16 v[64:79], v[36:39], a[12:15], v[64:79]
    s_barrier
    ds_read_b64_tr_b16 v[16:17], v150 offset:0
    ds_read_b64_tr_b16 v[18:19], v150 offset:2560
    s_add_u32 m0, s66, 62464
    s_waitcnt lgkmcnt(8)
    v_mfma_f32_32x32x16_bf16 v[80:95], v[40:43], a[12:15], v[80:95]
    ds_read_b64_tr_b16 v[20:21], v150 offset:64
    ds_read_b64_tr_b16 v[22:23], v150 offset:2624
    ds_read_b64_tr_b16 v[24:25], v150 offset:128
    buffer_load_dwordx4 v9, s[44:47], s67 offen offset:3072  lds
    s_waitcnt lgkmcnt(9)
    v_mfma_f32_32x32x16_bf16 v[96:111], v[44:47], a[12:15], v[96:111]
    ds_read_b64_tr_b16 v[26:27], v150 offset:2688
    ds_read_b64_tr_b16 v[28:29], v150 offset:192
    ds_read_b64_tr_b16 v[30:31], v150 offset:2752
    s_add_u32 s67, s67, s68
    s_waitcnt lgkmcnt(10)
    v_mfma_f32_32x32x16_bf16 v[112:127], v[48:51], a[12:15], v[112:127]
    ds_read_b64_tr_b16 v[32:33], v150 offset:256
    ds_read_b64_tr_b16 v[34:35], v150 offset:2816
    s_cmp_ge_u32 s67, s69
    s_cselect_b32 s67, s70, s67
    s_waitcnt lgkmcnt(10)
    v_mfma_f32_32x32x16_bf16 v[128:143], v[52:55], a[12:15], v[128:143]
    s_waitcnt vmcnt(12) lgkmcnt(8)
    v_mfma_f32_32x32x16_bf16 v[64:79], v[16:19], a[16:19], v[64:79]
    ds_read_b64_tr_b16 v[36:37], v150 offset:5120
    ds_read_b64_tr_b16 v[38:39], v150 offset:7680
    ds_read_b64_tr_b16 v[40:41], v150 offset:5184
    buffer_load_dwordx4 a[48:51], v4, s[40:43], s74 offen offset:0 sc1
    s_waitcnt lgkmcnt(9)
    v_mfma_f32_32x32x16_bf16 v[80:95], v[20:23], a[16:19], v[80:95]
    ds_read_b64_tr_b16 v[42:43], v150 offset:7744
    ds_read_b64_tr_b16 v[44:45], v150 offset:5248
    buffer_load_dwordx4 a[52:55], v4, s[40:43], s74 offen offset:1024 sc1
    s_waitcnt lgkmcnt(9)
    v_mfma_f32_32x32x16_bf16 v[96:111], v[24:27], a[16:19], v[96:111]
    ds_read_b64_tr_b16 v[46:47], v150 offset:7808
    ds_read_b64_tr_b16 v[48:49], v150 offset:5312
    ds_read_b64_tr_b16 v[50:51], v150 offset:7872
    s_waitcnt lgkmcnt(10)
    v_mfma_f32_32x32x16_bf16 v[112:127], v[28:31], a[16:19], v[112:127]
    ds_read_b64_tr_b16 v[52:53], v150 offset:5376
    ds_read_b64_tr_b16 v[54:55], v150 offset:7936
    buffer_load_dwordx4 a[56:59], v4, s[40:43], s74 offen offset:2048 sc1
    s_waitcnt lgkmcnt(10)
    v_mfma_f32_32x32x16_bf16 v[128:143], v[32:35], a[16:19], v[128:143]
    buffer_load_dwordx4 a[60:63], v4, s[40:43], s74 offen offset:3072 sc1
    s_waitcnt vmcnt(15) lgkmcnt(8)
    v_mfma_f32_32x32x16_bf16 v[64:79], v[36:39], a[20:23], v[64:79]
    ds_read_b64_tr_b16 v[16:17], v150 offset:10240
    ds_read_b64_tr_b16 v[18:19], v150 offset:12800
    ds_read_b64_tr_b16 v[20:21], v150 offset:10304
    s_waitcnt lgkmcnt(9)
    v_mfma_f32_32x32x16_bf16 v[80:95], v[40:43], a[20:23], v[80:95]
    ds_read_b64_tr_b16 v[22:23], v150 offset:12864
    ds_read_b64_tr_b16 v[24:25], v150 offset:10368
    s_add_u32 s74, s74, 4096
    s_cmp_ge_u32 s74, s75
    s_cselect_b32 s74, s76, s74
    s_waitcnt lgkmcnt(9)
    v_mfma_f32_32x32x16_bf16 v[96:111], v[44:47], a[20:23], v[96:111]
    ds_read_b64_tr_b16 v[26:27], v150 offset:12928
    ds_read_b64_tr_b16 v[28:29], v150 offset:10432
    ds_read_b64_tr_b16 v[30:31], v150 offset:12992
    s_waitcnt lgkmcnt(10)
    v_mfma_f32_32x32x16_bf16 v[112:127], v[48:51], a[20:23], v[112:127]
    ds_read_b64_tr_b16 v[32:33], v150 offset:10496
    ds_read_b64_tr_b16 v[34:35], v150 offset:13056
    s_add_u32 m0, s66, 81920
    s_waitcnt lgkmcnt(10)
    v_mfma_f32_32x32x16_bf16 v[128:143], v[52:55], a[20:23], v[128:143]
    buffer_load_dwordx4 v5, s[44:47], s67 offen offset:0  lds
    s_waitcnt vmcnt(15) lgkmcnt(8)
    v_mfma_f32_32x32x16_bf16 v[64:79], v[16:19], a[24:27], v[64:79]
    ds_read_b64_tr_b16 v[36:37], v150 offset:15360
    ds_read_b64_tr_b16 v[38:39], v150 offset:17920
    ds_read_b64_tr_b16 v[40:41], v150 offset:15424
    buffer_load_dwordx4 v6, s[44:47], s67 offen offset:1024  lds
    s_waitcnt lgkmcnt(9)
    v_mfma_f32_32x32x16_bf16 v[80:95], v[20:23], a[24:27], v[80:95]
    ds_read_b64_tr_b16 v[42:43], v150 offset:17984
    ds_read_b64_tr_b16 v[44:45], v150 offset:15488
    s_waitcnt lgkmcnt(9)
    v_mfma_f32_32x32x16_bf16 v[96:111], v[24:27], a[24:27], v[96:111]
    ds_read_b64_tr_b16 v[46:47], v150 offset:18048
    ds_read_b64_tr_b16 v[48:49], v150 offset:15552
    ds_read_b64_tr_b16 v[50:51], v150 offset:18112
    buffer_load_dwordx4 v7, s[44:47], s67 offen offset:2048  lds
    s_waitcnt lgkmcnt(10)
    v_mfma_f32_32x32x16_bf16 v[112:127], v[28:31], a[24:27], v[112:127]
    ds_read_b64_tr_b16 v[52:53], v150 offset:15616
    ds_read_b64_tr_b16 v[54:55], v150 offset:18176
    buffer_load_dwordx4 v8, s[44:47], s67 offen offset:3072  lds
    s_waitcnt lgkmcnt(10)
    v_mfma_f32_32x32x16_bf16 v[128:143], v[32:35], a[24:27], v[128:143]
    s_waitcnt vmcnt(17) lgkmcnt(8)
    v_mfma_f32_32x32x16_bf16 v[64:79], v[36:39], a[28:31], v[64:79]
    s_barrier
    ds_read_b64_tr_b16 v[16:17], v149 offset:40960
    ds_read_b64_tr_b16 v[18:19], v149 offset:43520
    s_add_u32 m0, s66, 82944
    s_waitcnt lgkmcnt(8)
    v_mfma_f32_32x32x16_bf16 v[80:95], v[40:43], a[28:31], v[80:95]
    ds_read_b64_tr_b16 v[20:21], v149 offset:41024
    ds_read_b64_tr_b16 v[22:23], v149 offset:43584
    ds_read_b64_tr_b16 v[24:25], v149 offset:41088
    buffer_load_dwordx4 v9, s[44:47], s67 offen offset:3072  lds
    s_waitcnt lgkmcnt(9)
    v_mfma_f32_32x32x16_bf16 v[96:111], v[44:47], a[28:31], v[96:111]
    ds_read_b64_tr_b16 v[26:27], v149 offset:43648
    ds_read_b64_tr_b16 v[28:29], v149 offset:41152
    ds_read_b64_tr_b16 v[30:31], v149 offset:43712
    s_add_u32 s67, s67, s68
    s_waitcnt lgkmcnt(10)
    v_mfma_f32_32x32x16_bf16 v[112:127], v[48:51], a[28:31], v[112:127]
    ds_read_b64_tr_b16 v[32:33], v149 offset:41216
    ds_read_b64_tr_b16 v[34:35], v149 offset:43776
    s_cmp_ge_u32 s67, s69
    s_cselect_b32 s67, s70, s67
    s_waitcnt lgkmcnt(10)
    v_mfma_f32_32x32x16_bf16 v[128:143], v[52:55], a[28:31], v[128:143]
    s_waitcnt vmcnt(17) lgkmcnt(8)
    v_mfma_f32_32x32x16_bf16 v[64:79], v[16:19], a[32:35], v[64:79]
    ds_read_b64_tr_b16 v[36:37], v149 offset:46080
    ds_read_b64_tr_b16 v[38:39], v149 offset:48640
    ds_read_b64_tr_b16 v[40:41], v149 offset:46144
    buffer_load_dwordx4 a[64:67], v4, s[40:43], s74 offen offset:0 sc1
    s_waitcnt lgkmcnt(9)
    v_mfma_f32_32x32x16_bf16 v[80:95], v[20:23], a[32:35], v[80:95]
    ds_read_b64_tr_b16 v[42:43], v149 offset:48704
    ds_read_b64_tr_b16 v[44:45], v149 offset:46208
    buffer_load_dwordx4 a[68:71], v4, s[40:43], s74 offen offset:1024 sc1
    s_waitcnt lgkmcnt(9)
    v_mfma_f32_32x32x16_bf16 v[96:111], v[24:27], a[32:35], v[96:111]
    ds_read_b64_tr_b16 v[46:47], v149 offset:48768
    ds_read_b64_tr_b16 v[48:49], v149 offset:46272
    ds_read_b64_tr_b16 v[50:51], v149 offset:48832
    s_waitcnt lgkmcnt(10)
    v_mfma_f32_32x32x16_bf16 v[112:127], v[28:31], a[32:35], v[112:127]
    ds_read_b64_tr_b16 v[52:53], v149 offset:46336
    ds_read_b64_tr_b16 v[54:55], v149 offset:48896
    buffer_load_dwordx4 a[72:75], v4, s[40:43], s74 offen offset:2048 sc1
    s_waitcnt lgkmcnt(10)
    v_mfma_f32_32x32x16_bf16 v[128:143], v[32:35], a[32:35], v[128:143]
    buffer_load_dwordx4 a[76:79], v4, s[40:43], s74 offen offset:3072 sc1
    s_waitcnt vmcnt(20) lgkmcnt(8)
    v_mfma_f32_32x32x16_bf16 v[64:79], v[36:39], a[36:39], v[64:79]
    ds_read_b64_tr_b16 v[16:17], v149 offset:51200
    ds_read_b64_tr_b16 v[18:19], v149 offset:53760
    ds_read_b64_tr_b16 v[20:21], v149 offset:51264
    s_waitcnt lgkmcnt(9)
    v_mfma_f32_32x32x16_bf16 v[80:95], v[40:43], a[36:39], v[80:95]
    ds_read_b64_tr_b16 v[22:23], v149 offset:53824
    ds_read_b64_tr_b16 v[24:25], v149 offset:51328
    s_add_u32 s74, s74, 4096
    s_cmp_ge_u32 s74, s75
    s_cselect_b32 s74, s76, s74
    s_waitcnt lgkmcnt(9)
    v_mfma_f32_32x32x16_bf16 v[96:111], v[44:47], a[36:39], v[96:111]
    ds_read_b64_tr_b16 v[26:27], v149 offset:53888
    ds_read_b64_tr_b16 v[28:29], v149 offset:51392
    ds_read_b64_tr_b16 v[30:31], v149 offset:53952
    s_waitcnt lgkmcnt(10)
    v_mfma_f32_32x32x16_bf16 v[112:127], v[48:51], a[36:39], v[112:127]
    ds_read_b64_tr_b16 v[32:33], v149 offset:51456
    ds_read_b64_tr_b16 v[34:35], v149 offset:54016
    s_add_u32 m0, s66, 0
    s_waitcnt lgkmcnt(10)
    v_mfma_f32_32x32x16_bf16 v[128:143], v[52:55], a[36:39], v[128:143]
    buffer_load_dwordx4 v5, s[44:47], s67 offen offset:0  lds
    s_waitcnt vmcnt(20) lgkmcnt(8)
    v_mfma_f32_32x32x16_bf16 v[64:79], v[16:19], a[40:43], v[64:79]
    ds_read_b64_tr_b16 v[36:37], v149 offset:56320
    ds_read_b64_tr_b16 v[38:39], v149 offset:58880
    ds_read_b64_tr_b16 v[40:41], v149 offset:56384
    buffer_load_dwordx4 v6, s[44:47], s67 offen offset:1024  lds
    s_waitcnt lgkmcnt(9)
    v_mfma_f32_32x32x16_bf16 v[80:95], v[20:23], a[40:43], v[80:95]
    ds_read_b64_tr_b16 v[42:43], v149 offset:58944
    ds_read_b64_tr_b16 v[44:45], v149 offset:56448
    s_waitcnt lgkmcnt(9)
    v_mfma_f32_32x32x16_bf16 v[96:111], v[24:27], a[40:43], v[96:111]
    ds_read_b64_tr_b16 v[46:47], v149 offset:59008
    ds_read_b64_tr_b16 v[48:49], v149 offset:56512
    ds_read_b64_tr_b16 v[50:51], v149 offset:59072
    buffer_load_dwordx4 v7, s[44:47], s67 offen offset:2048  lds
    s_waitcnt lgkmcnt(10)
    v_mfma_f32_32x32x16_bf16 v[112:127], v[28:31], a[40:43], v[112:127]
    ds_read_b64_tr_b16 v[52:53], v149 offset:56576
    ds_read_b64_tr_b16 v[54:55], v149 offset:59136
    buffer_load_dwordx4 v8, s[44:47], s67 offen offset:3072  lds
    s_waitcnt lgkmcnt(10)
    v_mfma_f32_32x32x16_bf16 v[128:143], v[32:35], a[40:43], v[128:143]
    s_waitcnt vmcnt(22) lgkmcnt(8)
    v_mfma_f32_32x32x16_bf16 v[64:79], v[36:39], a[44:47], v[64:79]
    s_barrier
    ds_read_b64_tr_b16 v[16:17], v148 offset:20480
    ds_read_b64_tr_b16 v[18:19], v148 offset:23040
    s_add_u32 m0, s66, 1024
    s_waitcnt lgkmcnt(8)
    v_mfma_f32_32x32x16_bf16 v[80:95], v[40:43], a[44:47], v[80:95]
    ds_read_b64_tr_b16 v[20:21], v148 offset:20544
    ds_read_b64_tr_b16 v[22:23], v148 offset:23104
    ds_read_b64_tr_b16 v[24:25], v148 offset:20608
    buffer_load_dwordx4 v9, s[44:47], s67 offen offset:3072  lds
    s_waitcnt lgkmcnt(9)
    v_mfma_f32_32x32x16_bf16 v[96:111], v[44:47], a[44:47], v[96:111]
    ds_read_b64_tr_b16 v[26:27], v148 offset:23168
    ds_read_b64_tr_b16 v[28:29], v148 offset:20672
    ds_read_b64_tr_b16 v[30:31], v148 offset:23232
    s_add_u32 s67, s67, s68
    s_waitcnt lgkmcnt(10)
    v_mfma_f32_32x32x16_bf16 v[112:127], v[48:51], a[44:47], v[112:127]
    ds_read_b64_tr_b16 v[32:33], v148 offset:20736
    ds_read_b64_tr_b16 v[34:35], v148 offset:23296
    s_cmp_ge_u32 s67, s69
    s_cselect_b32 s67, s70, s67
    s_waitcnt lgkmcnt(10)
    v_mfma_f32_32x32x16_bf16 v[128:143], v[52:55], a[44:47], v[128:143]
    s_waitcnt vmcnt(17) lgkmcnt(8)
    v_mfma_f32_32x32x16_bf16 v[64:79], v[16:19], a[48:51], v[64:79]
    ds_read_b64_tr_b16 v[36:37], v148 offset:25600
    ds_read_b64_tr_b16 v[38:39], v148 offset:28160
    ds_read_b64_tr_b16 v[40:41], v148 offset:25664
    buffer_load_dwordx4 a[80:83], v4, s[40:43], s74 offen offset:0 sc1
    s_waitcnt lgkmcnt(9)
    v_mfma_f32_32x32x16_bf16 v[80:95], v[20:23], a[48:51], v[80:95]
    ds_read_b64_tr_b16 v[42:43], v148 offset:28224
    ds_read_b64_tr_b16 v[44:45], v148 offset:25728
    buffer_load_dwordx4 a[84:87], v4, s[40:43], s74 offen offset:1024 sc1
    s_waitcnt lgkmcnt(9)
    v_mfma_f32_32x32x16_bf16 v[96:111], v[24:27], a[48:51], v[96:111]
    ds_read_b64_tr_b16 v[46:47], v148 offset:28288
    ds_read_b64_tr_b16 v[48:49], v148 offset:25792
    ds_read_b64_tr_b16 v[50:51], v148 offset:28352
    buffer_load_dwordx4 a[88:91], v4, s[40:43], s74 offen offset:2048 sc1
    s_waitcnt lgkmcnt(10)
    v_mfma_f32_32x32x16_bf16 v[112:127], v[28:31], a[48:51], v[112:127]
    ds_read_b64_tr_b16 v[52:53], v148 offset:25856
    ds_read_b64_tr_b16 v[54:55], v148 offset:28416
    buffer_load_dwordx4 a[92:95], v4, s[40:43], s74 offen offset:3072 sc1
    s_waitcnt lgkmcnt(10)
    v_mfma_f32_32x32x16_bf16 v[128:143], v[32:35], a[48:51], v[128:143]
    s_add_u32 s74, s74, 4096
    s_waitcnt vmcnt(20) lgkmcnt(8)
    v_mfma_f32_32x32x16_bf16 v[64:79], v[36:39], a[52:55], v[64:79]
    ds_read_b64_tr_b16 v[16:17], v148 offset:30720
    ds_read_b64_tr_b16 v[18:19], v148 offset:33280
    ds_read_b64_tr_b16 v[20:21], v148 offset:30784
    s_cmp_ge_u32 s74, s75
    s_cselect_b32 s74, s76, s74
    s_waitcnt lgkmcnt(9)
    v_mfma_f32_32x32x16_bf16 v[80:95], v[40:43], a[52:55], v[80:95]
    ds_read_b64_tr_b16 v[22:23], v148 offset:33344
    ds_read_b64_tr_b16 v[24:25], v148 offset:30848
    s_add_u32 m0, s66, 143360
    s_waitcnt lgkmcnt(9)
    v_mfma_f32_32x32x16_bf16 v[96:111], v[44:47], a[52:55], v[96:111]
    ds_read_b64_tr_b16 v[26:27], v148 offset:33408
    ds_read_b64_tr_b16 v[28:29], v148 offset:30912
    ds_read_b64_tr_b16 v[30:31], v148 offset:33472
    buffer_load_dwordx4 v5, s[44:47], s67 offen offset:0  lds
    s_waitcnt lgkmcnt(10)
    v_mfma_f32_32x32x16_bf16 v[112:127], v[48:51], a[52:55], v[112:127]
    ds_read_b64_tr_b16 v[32:33], v148 offset:30976
    ds_read_b64_tr_b16 v[34:35], v148 offset:33536
    buffer_load_dwordx4 v6, s[44:47], s67 offen offset:1024  lds
    s_waitcnt lgkmcnt(10)
    v_mfma_f32_32x32x16_bf16 v[128:143], v[52:55], a[52:55], v[128:143]
    buffer_load_dwordx4 v7, s[44:47], s67 offen offset:2048  lds
    s_waitcnt vmcnt(22) lgkmcnt(8)
    v_mfma_f32_32x32x16_bf16 v[64:79], v[16:19], a[56:59], v[64:79]
    ds_read_b64_tr_b16 v[36:37], v148 offset:35840
    ds_read_b64_tr_b16 v[38:39], v148 offset:38400
    ds_read_b64_tr_b16 v[40:41], v148 offset:35904
    buffer_load_dwordx4 v8, s[44:47], s67 offen offset:3072  lds
    s_waitcnt lgkmcnt(9)
    v_mfma_f32_32x32x16_bf16 v[80:95], v[20:23], a[56:59], v[80:95]
    ds_read_b64_tr_b16 v[42:43], v148 offset:38464
    ds_read_b64_tr_b16 v[44:45], v148 offset:35968
    s_waitcnt lgkmcnt(9)
    v_mfma_f32_32x32x16_bf16 v[96:111], v[24:27], a[56:59], v[96:111]
    ds_read_b64_tr_b16 v[46:47], v148 offset:38528
    ds_read_b64_tr_b16 v[48:49], v148 offset:36032
    ds_read_b64_tr_b16 v[50:51], v148 offset:38592
    s_add_u32 m0, s66, 144384
    s_nop 0
    buffer_load_dwordx4 v9, s[44:47], s67 offen offset:3072  lds
    s_waitcnt lgkmcnt(10)
    v_mfma_f32_32x32x16_bf16 v[112:127], v[28:31], a[56:59], v[112:127]
    ds_read_b64_tr_b16 v[52:53], v148 offset:36096
    ds_read_b64_tr_b16 v[54:55], v148 offset:38656
    s_add_u32 s67, s67, s68
    s_waitcnt lgkmcnt(10)
    v_mfma_f32_32x32x16_bf16 v[128:143], v[32:35], a[56:59], v[128:143]
    s_cmp_ge_u32 s67, s69
    s_cselect_b32 s67, s70, s67
    s_waitcnt vmcnt(23) lgkmcnt(8)
    v_mfma_f32_32x32x16_bf16 v[64:79], v[36:39], a[60:63], v[64:79]
    s_barrier
    ds_read_b64_tr_b16 v[16:17], v148 offset:40960
    ds_read_b64_tr_b16 v[18:19], v148 offset:43520
    v_lshrrev_b32 v1, 2, v0
    s_waitcnt lgkmcnt(8)
    v_mfma_f32_32x32x16_bf16 v[80:95], v[40:43], a[60:63], v[80:95]
    ds_read_b64_tr_b16 v[20:21], v148 offset:41024
    ds_read_b64_tr_b16 v[22:23], v148 offset:43584
    ds_read_b64_tr_b16 v[24:25], v148 offset:41088
    v_lshlrev_b32 v1, 7, v1
    v_and_b32 v2, 3, v0
    s_waitcnt lgkmcnt(9)
    v_mfma_f32_32x32x16_bf16 v[96:111], v[44:47], a[60:63], v[96:111]
    ds_read_b64_tr_b16 v[26:27], v148 offset:43648
    ds_read_b64_tr_b16 v[28:29], v148 offset:41152
    ds_read_b64_tr_b16 v[30:31], v148 offset:43712
    v_lshl_add_u32 v1, v2, 4, v1
    s_waitcnt lgkmcnt(10)
    v_mfma_f32_32x32x16_bf16 v[112:127], v[48:51], a[60:63], v[112:127]
    ds_read_b64_tr_b16 v[32:33], v148 offset:41216
    ds_read_b64_tr_b16 v[34:35], v148 offset:43776
    v_min_u32 v1, 1456, v1
    s_mov_b32 s95, 22093824
    s_waitcnt lgkmcnt(10)
    v_mfma_f32_32x32x16_bf16 v[128:143], v[52:55], a[60:63], v[128:143]
    buffer_load_dwordx4 v[144:147], v1, s[40:43], s95 offen sc1
    s_waitcnt vmcnt(18) lgkmcnt(8)
    v_mfma_f32_32x32x16_bf16 v[64:79], v[16:19], a[64:67], v[64:79]
    ds_read_b64_tr_b16 v[36:37], v148 offset:46080
    ds_read_b64_tr_b16 v[38:39], v148 offset:48640
    ds_read_b64_tr_b16 v[40:41], v148 offset:46144
    buffer_load_dwordx4 a[96:99], v4, s[40:43], s74 offen offset:0 sc1
    s_waitcnt lgkmcnt(9)
    v_mfma_f32_32x32x16_bf16 v[80:95], v[20:23], a[64:67], v[80:95]
    ds_read_b64_tr_b16 v[42:43], v148 offset:48704
    ds_read_b64_tr_b16 v[44:45], v148 offset:46208
    buffer_load_dwordx4 a[100:103], v4, s[40:43], s74 offen offset:1024 sc1
    s_waitcnt lgkmcnt(9)
    v_mfma_f32_32x32x16_bf16 v[96:111], v[24:27], a[64:67], v[96:111]
    ds_read_b64_tr_b16 v[46:47], v148 offset:48768
    ds_read_b64_tr_b16 v[48:49], v148 offset:46272
    ds_read_b64_tr_b16 v[50:51], v148 offset:48832
    s_waitcnt lgkmcnt(10)
    v_mfma_f32_32x32x16_bf16 v[112:127], v[28:31], a[64:67], v[112:127]
    ds_read_b64_tr_b16 v[52:53], v148 offset:46336
    ds_read_b64_tr_b16 v[54:55], v148 offset:48896
    buffer_load_dwordx4 a[104:107], v4, s[40:43], s74 offen offset:2048 sc1
    s_waitcnt lgkmcnt(10)
    v_mfma_f32_32x32x16_bf16 v[128:143], v[32:35], a[64:67], v[128:143]
    buffer_load_dwordx4 a[108:111], v4, s[40:43], s74 offen offset:3072 sc1
    s_waitcnt vmcnt(21) lgkmcnt(8)
    v_mfma_f32_32x32x16_bf16 v[64:79], v[36:39], a[68:71], v[64:79]
    ds_read_b64_tr_b16 v[16:17], v148 offset:51200
    ds_read_b64_tr_b16 v[18:19], v148 offset:53760
    ds_read_b64_tr_b16 v[20:21], v148 offset:51264
    s_waitcnt lgkmcnt(9)
    v_mfma_f32_32x32x16_bf16 v[80:95], v[40:43], a[68:71], v[80:95]
    ds_read_b64_tr_b16 v[22:23], v148 offset:53824
    ds_read_b64_tr_b16 v[24:25], v148 offset:51328
    s_add_u32 s74, s74, 4096
    s_cmp_ge_u32 s74, s75
    s_cselect_b32 s74, s76, s74
    s_waitcnt lgkmcnt(9)
    v_mfma_f32_32x32x16_bf16 v[96:111], v[44:47], a[68:71], v[96:111]
    ds_read_b64_tr_b16 v[26:27], v148 offset:53888
    ds_read_b64_tr_b16 v[28:29], v148 offset:51392
    ds_read_b64_tr_b16 v[30:31], v148 offset:53952
    s_waitcnt lgkmcnt(10)
    v_mfma_f32_32x32x16_bf16 v[112:127], v[48:51], a[68:71], v[112:127]
    ds_read_b64_tr_b16 v[32:33], v148 offset:51456
    ds_read_b64_tr_b16 v[34:35], v148 offset:54016
    s_add_u32 m0, s66, 122880
    s_waitcnt lgkmcnt(10)
    v_mfma_f32_32x32x16_bf16 v[128:143], v[52:55], a[68:71], v[128:143]
    buffer_load_dwordx4 v5, s[44:47], s67 offen offset:0  lds
    s_waitcnt vmcnt(21) lgkmcnt(8)
    v_mfma_f32_32x32x16_bf16 v[64:79], v[16:19], a[72:75], v[64:79]
    ds_read_b64_tr_b16 v[36:37], v148 offset:56320
    ds_read_b64_tr_b16 v[38:39], v148 offset:58880
    ds_read_b64_tr_b16 v[40:41], v148 offset:56384
    buffer_load_dwordx4 v6, s[44:47], s67 offen offset:1024  lds
    s_waitcnt lgkmcnt(9)
    v_mfma_f32_32x32x16_bf16 v[80:95], v[20:23], a[72:75], v[80:95]
    ds_read_b64_tr_b16 v[42:43], v148 offset:58944
    ds_read_b64_tr_b16 v[44:45], v148 offset:56448
    s_waitcnt lgkmcnt(9)
    v_mfma_f32_32x32x16_bf16 v[96:111], v[24:27], a[72:75], v[96:111]
    ds_read_b64_tr_b16 v[46:47], v148 offset:59008
    ds_read_b64_tr_b16 v[48:49], v148 offset:56512
    ds_read_b64_tr_b16 v[50:51], v148 offset:59072
    buffer_load_dwordx4 v7, s[44:47], s67 offen offset:2048  lds
    s_waitcnt lgkmcnt(10)
    v_mfma_f32_32x32x16_bf16 v[112:127], v[28:31], a[72:75], v[112:127]
    ds_read_b64_tr_b16 v[52:53], v148 offset:56576
    ds_read_b64_tr_b16 v[54:55], v148 offset:59136
    buffer_load_dwordx4 v8, s[44:47], s67 offen offset:3072  lds
    s_waitcnt lgkmcnt(10)
    v_mfma_f32_32x32x16_bf16 v[128:143], v[32:35], a[72:75], v[128:143]
    s_waitcnt vmcnt(23) lgkmcnt(8)
    v_mfma_f32_32x32x16_bf16 v[64:79], v[36:39], a[76:79], v[64:79]
    s_barrier
    ds_read_b64_tr_b16 v[16:17], v149 offset:0
    ds_read_b64_tr_b16 v[18:19], v149 offset:2560
    s_add_u32 m0, s66, 123904
    s_waitcnt lgkmcnt(8)
    v_mfma_f32_32x32x16_bf16 v[80:95], v[40:43], a[76:79], v[80:95]
    ds_read_b64_tr_b16 v[20:21], v149 offset:64
    ds_read_b64_tr_b16 v[22:23], v149 offset:2624
    ds_read_b64_tr_b16 v[24:25], v149 offset:128
    buffer_load_dwordx4 v9, s[44:47], s67 offen offset:3072  lds
    s_waitcnt lgkmcnt(9)
    v_mfma_f32_32x32x16_bf16 v[96:111], v[44:47], a[76:79], v[96:111]
    ds_read_b64_tr_b16 v[26:27], v149 offset:2688
    ds_read_b64_tr_b16 v[28:29], v149 offset:192
    ds_read_b64_tr_b16 v[30:31], v149 offset:2752
    s_add_u32 s67, s67, s68
    s_waitcnt lgkmcnt(10)
    v_mfma_f32_32x32x16_bf16 v[112:127], v[48:51], a[76:79], v[112:127]
    ds_read_b64_tr_b16 v[32:33], v149 offset:256
    ds_read_b64_tr_b16 v[34:35], v149 offset:2816
    s_cmp_ge_u32 s67, s69
    s_cselect_b32 s67, s70, s67
    s_waitcnt lgkmcnt(10)
    v_mfma_f32_32x32x16_bf16 v[128:143], v[52:55], a[76:79], v[128:143]
    s_waitcnt vmcnt(18) lgkmcnt(8)
    v_mfma_f32_32x32x16_bf16 v[64:79], v[16:19], a[80:83], v[64:79]
    ds_read_b64_tr_b16 v[36:37], v149 offset:5120
    ds_read_b64_tr_b16 v[38:39], v149 offset:7680
    ds_read_b64_tr_b16 v[40:41], v149 offset:5184
    buffer_load_dwordx4 a[112:115], v4, s[40:43], s74 offen offset:0 sc1
    s_waitcnt lgkmcnt(9)
    v_mfma_f32_32x32x16_bf16 v[80:95], v[20:23], a[80:83], v[80:95]
    ds_read_b64_tr_b16 v[42:43], v149 offset:7744
    ds_read_b64_tr_b16 v[44:45], v149 offset:5248
    s_waitcnt lgkmcnt(9)
    v_mfma_f32_32x32x16_bf16 v[96:111], v[24:27], a[80:83], v[96:111]
    ds_read_b64_tr_b16 v[46:47], v149 offset:7808
    ds_read_b64_tr_b16 v[48:49], v149 offset:5312
    ds_read_b64_tr_b16 v[50:51], v149 offset:7872
    buffer_load_dwordx4 a[116:119], v4, s[40:43], s74 offen offset:1024 sc1
    s_waitcnt lgkmcnt(10)
    v_mfma_f32_32x32x16_bf16 v[112:127], v[28:31], a[80:83], v[112:127]
    ds_read_b64_tr_b16 v[52:53], v149 offset:5376
    ds_read_b64_tr_b16 v[54:55], v149 offset:7936
    s_waitcnt lgkmcnt(10)
    v_mfma_f32_32x32x16_bf16 v[128:143], v[32:35], a[80:83], v[128:143]
    buffer_load_dwordx4 a[120:123], v4, s[40:43], s74 offen offset:2048 sc1
    s_waitcnt vmcnt(20) lgkmcnt(8)
    v_mfma_f32_32x32x16_bf16 v[64:79], v[36:39], a[84:87], v[64:79]
    ds_read_b64_tr_b16 v[16:17], v149 offset:10240
    ds_read_b64_tr_b16 v[18:19], v149 offset:12800
    ds_read_b64_tr_b16 v[20:21], v149 offset:10304
    s_waitcnt lgkmcnt(9)
    v_mfma_f32_32x32x16_bf16 v[80:95], v[40:43], a[84:87], v[80:95]
    ds_read_b64_tr_b16 v[22:23], v149 offset:12864
    ds_read_b64_tr_b16 v[24:25], v149 offset:10368
    buffer_load_dwordx4 a[124:127], v4, s[40:43], s74 offen offset:3072 sc1
    s_waitcnt lgkmcnt(9)
    v_mfma_f32_32x32x16_bf16 v[96:111], v[44:47], a[84:87], v[96:111]
    ds_read_b64_tr_b16 v[26:27], v149 offset:12928
    ds_read_b64_tr_b16 v[28:29], v149 offset:10432
    ds_read_b64_tr_b16 v[30:31], v149 offset:12992
    s_waitcnt lgkmcnt(10)
    v_mfma_f32_32x32x16_bf16 v[112:127], v[48:51], a[84:87], v[112:127]
    ds_read_b64_tr_b16 v[32:33], v149 offset:10496
    ds_read_b64_tr_b16 v[34:35], v149 offset:13056
    s_add_u32 s74, s74, 4096
    s_waitcnt lgkmcnt(10)
    v_mfma_f32_32x32x16_bf16 v[128:143], v[52:55], a[84:87], v[128:143]
    s_cmp_ge_u32 s74, s75
    s_cselect_b32 s74, s76, s74
    s_waitcnt vmcnt(20) lgkmcnt(8)
    v_mfma_f32_32x32x16_bf16 v[64:79], v[16:19], a[88:91], v[64:79]
    ds_read_b64_tr_b16 v[36:37], v149 offset:15360
    ds_read_b64_tr_b16 v[38:39], v149 offset:17920
    ds_read_b64_tr_b16 v[40:41], v149 offset:15424
    s_waitcnt lgkmcnt(9)
    v_mfma_f32_32x32x16_bf16 v[80:95], v[20:23], a[88:91], v[80:95]
    ds_read_b64_tr_b16 v[42:43], v149 offset:17984
    ds_read_b64_tr_b16 v[44:45], v149 offset:15488
    s_waitcnt lgkmcnt(9)
    v_mfma_f32_32x32x16_bf16 v[96:111], v[24:27], a[88:91], v[96:111]
    ds_read_b64_tr_b16 v[46:47], v149 offset:18048
    ds_read_b64_tr_b16 v[48:49], v149 offset:15552
    ds_read_b64_tr_b16 v[50:51], v149 offset:18112
    s_waitcnt lgkmcnt(10)
    v_mfma_f32_32x32x16_bf16 v[112:127], v[28:31], a[88:91], v[112:127]
    ds_read_b64_tr_b16 v[52:53], v149 offset:15616
    ds_read_b64_tr_b16 v[54:55], v149 offset:18176
    s_waitcnt lgkmcnt(10)
    v_mfma_f32_32x32x16_bf16 v[128:143], v[32:35], a[88:91], v[128:143]
    s_waitcnt vmcnt(19) lgkmcnt(8)
    v_mfma_f32_32x32x16_bf16 v[64:79], v[36:39], a[92:95], v[64:79]
    s_barrier
    ds_read_b64_tr_b16 v[16:17], v149 offset:20480
    ds_read_b64_tr_b16 v[18:19], v149 offset:23040
    s_waitcnt lgkmcnt(8)
    v_mfma_f32_32x32x16_bf16 v[80:95], v[40:43], a[92:95], v[80:95]
    ds_read_b64_tr_b16 v[20:21], v149 offset:20544
    ds_read_b64_tr_b16 v[22:23], v149 offset:23104
    ds_read_b64_tr_b16 v[24:25], v149 offset:20608
    s_waitcnt lgkmcnt(9)
    v_mfma_f32_32x32x16_bf16 v[96:111], v[44:47], a[92:95], v[96:111]
    ds_read_b64_tr_b16 v[26:27], v149 offset:23168
    ds_read_b64_tr_b16 v[28:29], v149 offset:20672
    ds_read_b64_tr_b16 v[30:31], v149 offset:23232
    s_waitcnt lgkmcnt(10)
    v_mfma_f32_32x32x16_bf16 v[112:127], v[48:51], a[92:95], v[112:127]
    ds_read_b64_tr_b16 v[32:33], v149 offset:20736
    ds_read_b64_tr_b16 v[34:35], v149 offset:23296
    s_waitcnt lgkmcnt(10)
    v_mfma_f32_32x32x16_bf16 v[128:143], v[52:55], a[92:95], v[128:143]
    s_waitcnt vmcnt(13)
    v_xor_b32 v144, v144, v15
    v_xor_b32 v145, v145, v15
    v_xor_b32 v146, v146, v15
    v_xor_b32 v147, v147, v15
    v_or3_b32 v144, v144, v145, v146
    v_or_b32 v144, v144, v147
    v_cmp_ne_u32 vcc, 0, v144
    s_cbranch_vccz L_fd_42
    s_mov_b32 s94, 0
    s_mov_b32 s95, 22093824
L_fl_43:
    s_sleep 3
    buffer_load_dwordx4 v[144:147], v1, s[40:43], s95 offen sc1
    s_add_u32 s94, s94, 1
    s_waitcnt vmcnt(0)
    v_xor_b32 v144, v144, v15
    v_xor_b32 v145, v145, v15
    v_xor_b32 v146, v146, v15
    v_xor_b32 v147, v147, v15
    v_or3_b32 v144, v144, v145, v146
    v_or_b32 v144, v144, v147
    v_cmp_ne_u32 vcc, 0, v144
    s_cbranch_vccz L_fd_42
    s_cmp_lt_u32 s94, 400000
    s_cbranch_scc1 L_fl_43
L_fd_42:
    s_waitcnt vmcnt(12) lgkmcnt(8)
    v_mfma_f32_32x32x16_bf16 v[64:79], v[16:19], a[96:99], v[64:79]
    ds_read_b64_tr_b16 v[36:37], v149 offset:25600
    ds_read_b64_tr_b16 v[38:39], v149 offset:28160
    ds_read_b64_tr_b16 v[40:41], v149 offset:25664
    buffer_load_dwordx4 a[128:131], v4, s[40:43], s74 offen offset:0 sc1
    s_waitcnt lgkmcnt(9)
    v_mfma_f32_32x32x16_bf16 v[80:95], v[20:23], a[96:99], v[80:95]
    ds_read_b64_tr_b16 v[42:43], v149 offset:28224
    ds_read_b64_tr_b16 v[44:45], v149 offset:25728
    buffer_load_dwordx4 a[132:135], v4, s[40:43], s74 offen offset:1024 sc1
    s_waitcnt lgkmcnt(9)
    v_mfma_f32_32x32x16_bf16 v[96:111], v[24:27], a[96:99], v[96:111]
    ds_read_b64_tr_b16 v[46:47], v149 offset:28288
    ds_read_b64_tr_b16 v[48:49], v149 offset:25792
    ds_read_b64_tr_b16 v[50:51], v149 offset:28352
    buffer_load_dwordx4 a[136:139], v4, s[40:43], s74 offen offset:2048 sc1
    s_waitcnt lgkmcnt(10)
    v_mfma_f32_32x32x16_bf16 v[112:127], v[28:31], a[96:99], v[112:127]
    ds_read_b64_tr_b16 v[52:53], v149 offset:25856
    ds_read_b64_tr_b16 v[54:55], v149 offset:28416
    s_waitcnt lgkmcnt(10)
    v_mfma_f32_32x32x16_bf16 v[128:143], v[32:35], a[96:99], v[128:143]
    buffer_load_dwordx4 a[140:143], v4, s[40:43], s74 offen offset:3072 sc1
    s_waitcnt vmcnt(15) lgkmcnt(8)
    v_mfma_f32_32x32x16_bf16 v[64:79], v[36:39], a[100:103], v[64:79]
    ds_read_b64_tr_b16 v[16:17], v149 offset:30720
    ds_read_b64_tr_b16 v[18:19], v149 offset:33280
    ds_read_b64_tr_b16 v[20:21], v149 offset:30784
    s_add_u32 s74, s74, 4096
    s_waitcnt lgkmcnt(9)
    v_mfma_f32_32x32x16_bf16 v[80:95], v[40:43], a[100:103], v[80:95]
    ds_read_b64_tr_b16 v[22:23], v149 offset:33344
    ds_read_b64_tr_b16 v[24:25], v149 offset:30848
    s_cmp_ge_u32 s74, s75
    s_cselect_b32 s74, s76, s74
    s_waitcnt lgkmcnt(9)
    v_mfma_f32_32x32x16_bf16 v[96:111], v[44:47], a[100:103], v[96:111]
    ds_read_b64_tr_b16 v[26:27], v149 offset:33408
    ds_read_b64_tr_b16 v[28:29], v149 offset:30912
    ds_read_b64_tr_b16 v[30:31], v149 offset:33472
    s_waitcnt lgkmcnt(10)
    v_mfma_f32_32x32x16_bf16 v[112:127], v[48:51], a[100:103], v[112:127]
    ds_read_b64_tr_b16 v[32:33], v149 offset:30976
    ds_read_b64_tr_b16 v[34:35], v149 offset:33536
    s_add_u32 m0, s66, 102400
    s_add_u32 s96, s71, 1024
    s_waitcnt lgkmcnt(10)
    v_mfma_f32_32x32x16_bf16 v[128:143], v[52:55], a[100:103], v[128:143]
    buffer_load_dwordx4 v4, s[40:43], s71 offen offset:0 sc1 lds
    s_waitcnt vmcnt(15) lgkmcnt(8)
    v_mfma_f32_32x32x16_bf16 v[64:79], v[16:19], a[104:107], v[64:79]
    ds_read_b64_tr_b16 v[36:37], v149 offset:35840
    ds_read_b64_tr_b16 v[38:39], v149 offset:38400
    ds_read_b64_tr_b16 v[40:41], v149 offset:35904
    s_waitcnt lgkmcnt(9)
    v_mfma_f32_32x32x16_bf16 v[80:95], v[20:23], a[104:107], v[80:95]
    ds_read_b64_tr_b16 v[42:43], v149 offset:38464
    ds_read_b64_tr_b16 v[44:45], v149 offset:35968
    buffer_load_dwordx4 v4, s[40:43], s71 offen offset:1024 sc1 lds
    s_waitcnt lgkmcnt(9)
    v_mfma_f32_32x32x16_bf16 v[96:111], v[24:27], a[104:107], v[96:111]
    ds_read_b64_tr_b16 v[46:47], v149 offset:38528
    ds_read_b64_tr_b16 v[48:49], v149 offset:36032
    ds_read_b64_tr_b16 v[50:51], v149 offset:38592
    buffer_load_dwordx4 v4, s[40:43], s71 offen offset:2048 sc1 lds
    s_waitcnt lgkmcnt(10)
    v_mfma_f32_32x32x16_bf16 v[112:127], v[28:31], a[104:107], v[112:127]
    ds_read_b64_tr_b16 v[52:53], v149 offset:36096
    ds_read_b64_tr_b16 v[54:55], v149 offset:38656
    s_waitcnt lgkmcnt(10)
    v_mfma_f32_32x32x16_bf16 v[128:143], v[32:35], a[104:107], v[128:143]
    buffer_load_dwordx4 v4, s[40:43], s71 offen offset:3072 sc1 lds
    s_waitcnt vmcnt(17) lgkmcnt(8)
    v_mfma_f32_32x32x16_bf16 v[64:79], v[36:39], a[108:111], v[64:79]
    s_barrier
    ds_read_b64_tr_b16 v[16:17], v148 offset:0
    ds_read_b64_tr_b16 v[18:19], v148 offset:2560
    s_add_u32 m0, s66, 103424
    s_waitcnt lgkmcnt(8)
    v_mfma_f32_32x32x16_bf16 v[80:95], v[40:43], a[108:111], v[80:95]
    ds_read_b64_tr_b16 v[20:21], v148 offset:64
    ds_read_b64_tr_b16 v[22:23], v148 offset:2624
    ds_read_b64_tr_b16 v[24:25], v148 offset:128
    buffer_load_dwordx4 v4, s[40:43], s96 offen offset:3072 sc1 lds
    s_waitcnt lgkmcnt(9)
    v_mfma_f32_32x32x16_bf16 v[96:111], v[44:47], a[108:111], v[96:111]
    ds_read_b64_tr_b16 v[26:27], v148 offset:2688
    ds_read_b64_tr_b16 v[28:29], v148 offset:192
    ds_read_b64_tr_b16 v[30:31], v148 offset:2752
    s_add_u32 s71, s71, 10240
    s_waitcnt lgkmcnt(10)
    v_mfma_f32_32x32x16_bf16 v[112:127], v[48:51], a[108:111], v[112:127]
    ds_read_b64_tr_b16 v[32:33], v148 offset:256
    ds_read_b64_tr_b16 v[34:35], v148 offset:2816
    s_cmp_ge_u32 s71, s72
    s_cselect_b32 s71, s73, s71
    s_waitcnt lgkmcnt(10)
    v_mfma_f32_32x32x16_bf16 v[128:143], v[52:55], a[108:111], v[128:143]
    s_waitcnt vmcnt(12) lgkmcnt(8)
    v_mfma_f32_32x32x16_bf16 v[64:79], v[16:19], a[112:115], v[64:79]
    ds_read_b64_tr_b16 v[36:37], v148 offset:5120
    ds_read_b64_tr_b16 v[38:39], v148 offset:7680
    ds_read_b64_tr_b16 v[40:41], v148 offset:5184
    buffer_load_dwordx4 a[144:147], v4, s[40:43], s74 offen offset:0 sc1
    s_waitcnt lgkmcnt(9)
    v_mfma_f32_32x32x16_bf16 v[80:95], v[20:23], a[112:115], v[80:95]
    ds_read_b64_tr_b16 v[42:43], v148 offset:7744
    ds_read_b64_tr_b16 v[44:45], v148 offset:5248
    buffer_load_dwordx4 a[148:151], v4, s[40:43], s74 offen offset:1024 sc1
    s_waitcnt lgkmcnt(9)
    v_mfma_f32_32x32x16_bf16 v[96:111], v[24:27], a[112:115], v[96:111]
    ds_read_b64_tr_b16 v[46:47], v148 offset:7808
    ds_read_b64_tr_b16 v[48:49], v148 offset:5312
    ds_read_b64_tr_b16 v[50:51], v148 offset:7872
    buffer_load_dwordx4 a[152:155], v4, s[40:43], s74 offen offset:2048 sc1
    s_waitcnt lgkmcnt(10)
    v_mfma_f32_32x32x16_bf16 v[112:127], v[28:31], a[112:115], v[112:127]
    ds_read_b64_tr_b16 v[52:53], v148 offset:5376
    ds_read_b64_tr_b16 v[54:55], v148 offset:7936
    s_waitcnt lgkmcnt(10)
    v_mfma_f32_32x32x16_bf16 v[128:143], v[32:35], a[112:115], v[128:143]
    buffer_load_dwordx4 a[156:159], v4, s[40:43], s74 offen offset:3072 sc1
    s_waitcnt vmcnt(15) lgkmcnt(8)
    v_mfma_f32_32x32x16_bf16 v[64:79], v[36:39], a[116:119], v[64:79]
    ds_read_b64_tr_b16 v[16:17], v148 offset:10240
    ds_read_b64_tr_b16 v[18:19], v148 offset:12800
    ds_read_b64_tr_b16 v[20:21], v148 offset:10304
    s_add_u32 s74, s74, 4096
    s_waitcnt lgkmcnt(9)
    v_mfma_f32_32x32x16_bf16 v[80:95], v[40:43], a[116:119], v[80:95]
    ds_read_b64_tr_b16 v[22:23], v148 offset:12864
    ds_read_b64_tr_b16 v[24:25], v148 offset:10368
    s_cmp_ge_u32 s74, s75
    s_cselect_b32 s74, s76, s74
    s_waitcnt lgkmcnt(9)
    v_mfma_f32_32x32x16_bf16 v[96:111], v[44:47], a[116:119], v[96:111]
    ds_read_b64_tr_b16 v[26:27], v148 offset:12928
    ds_read_b64_tr_b16 v[28:29], v148 offset:10432
    ds_read_b64_tr_b16 v[30:31], v148 offset:12992
    s_waitcnt lgkmcnt(10)
    v_mfma_f32_32x32x16_bf16 v[112:127], v[48:51], a[116:119], v[112:127]
    ds_read_b64_tr_b16 v[32:33], v148 offset:10496
    ds_read_b64_tr_b16 v[34:35], v148 offset:13056
    s_add_u32 m0, s66, 20480
    s_add_u32 s96, s71, 1024
    s_waitcnt lgkmcnt(10)
    v_mfma_f32_32x32x16_bf16 v[128:143], v[52:55], a[116:119], v[128:143]
    buffer_load_dwordx4 v4, s[40:43], s71 offen offset:0 sc1 lds
    s_waitcnt vmcnt(15) lgkmcnt(8)
    v_mfma_f32_32x32x16_bf16 v[64:79], v[16:19], a[120:123], v[64:79]
    ds_read_b64_tr_b16 v[36:37], v148 offset:15360
    ds_read_b64_tr_b16 v[38:39], v148 offset:17920
    ds_read_b64_tr_b16 v[40:41], v148 offset:15424
    s_waitcnt lgkmcnt(9)
    v_mfma_f32_32x32x16_bf16 v[80:95], v[20:23], a[120:123], v[80:95]
    ds_read_b64_tr_b16 v[42:43], v148 offset:17984
    ds_read_b64_tr_b16 v[44:45], v148 offset:15488
    buffer_load_dwordx4 v4, s[40:43], s71 offen offset:1024 sc1 lds
    s_waitcnt lgkmcnt(9)
    v_mfma_f32_32x32x16_bf16 v[96:111], v[24:27], a[120:123], v[96:111]
    ds_read_b64_tr_b16 v[46:47], v148 offset:18048
    ds_read_b64_tr_b16 v[48:49], v148 offset:15552
    ds_read_b64_tr_b16 v[50:51], v148 offset:18112
    buffer_load_dwordx4 v4, s[40:43], s71 offen offset:2048 sc1 lds
    s_waitcnt lgkmcnt(10)
    v_mfma_f32_32x32x16_bf16 v[112:127], v[28:31], a[120:123], v[112:127]
    ds_read_b64_tr_b16 v[52:53], v148 offset:15616
    ds_read_b64_tr_b16 v[54:55], v148 offset:18176
    s_waitcnt lgkmcnt(10)
    v_mfma_f32_32x32x16_bf16 v[128:143], v[32:35], a[120:123], v[128:143]
    buffer_load_dwordx4 v4, s[40:43], s71 offen offset:3072 sc1 lds
    s_waitcnt vmcnt(17) lgkmcnt(8)
    v_mfma_f32_32x32x16_bf16 v[64:79], v[36:39], a[124:127], v[64:79]
    s_barrier
    ds_read_b64_tr_b16 v[16:17], v150 offset:20480
    ds_read_b64_tr_b16 v[18:19], v150 offset:23040
    s_add_u32 m0, s66, 21504
    s_waitcnt lgkmcnt(8)
    v_mfma_f32_32x32x16_bf16 v[80:95], v[40:43], a[124:127], v[80:95]
    ds_read_b64_tr_b16 v[20:21], v150 offset:20544
    ds_read_b64_tr_b16 v[22:23], v150 offset:23104
    ds_read_b64_tr_b16 v[24:25], v150 offset:20608
    buffer_load_dwordx4 v4, s[40:43], s96 offen offset:3072 sc1 lds
    s_waitcnt lgkmcnt(9)
    v_mfma_f32_32x32x16_bf16 v[96:111], v[44:47], a[124:127], v[96:111]
    ds_read_b64_tr_b16 v[26:27], v150 offset:23168
    ds_read_b64_tr_b16 v[28:29], v150 offset:20672
    ds_read_b64_tr_b16 v[30:31], v150 offset:23232
    s_add_u32 s71, s71, 10240
    s_waitcnt lgkmcnt(10)
    v_mfma_f32_32x32x16_bf16 v[112:127], v[48:51], a[124:127], v[112:127]
    ds_read_b64_tr_b16 v[32:33], v150 offset:20736
    ds_read_b64_tr_b16 v[34:35], v150 offset:23296
    s_cmp_ge_u32 s71, s72
    s_cselect_b32 s71, s73, s71
    s_waitcnt lgkmcnt(10)
    v_mfma_f32_32x32x16_bf16 v[128:143], v[52:55], a[124:127], v[128:143]
    s_waitcnt vmcnt(17) lgkmcnt(8)
    v_mfma_f32_32x32x16_bf16 v[64:79], v[16:19], a[128:131], v[64:79]
    ds_read_b64_tr_b16 v[36:37], v150 offset:25600
    ds_read_b64_tr_b16 v[38:39], v150 offset:28160
    ds_read_b64_tr_b16 v[40:41], v150 offset:25664
    s_add_u32 m0, s66, 40960
    s_waitcnt lgkmcnt(9)
    v_mfma_f32_32x32x16_bf16 v[80:95], v[20:23], a[128:131], v[80:95]
    ds_read_b64_tr_b16 v[42:43], v150 offset:28224
    ds_read_b64_tr_b16 v[44:45], v150 offset:25728
    s_add_u32 s96, s71, 1024
    s_waitcnt lgkmcnt(9)
    v_mfma_f32_32x32x16_bf16 v[96:111], v[24:27], a[128:131], v[96:111]
    ds_read_b64_tr_b16 v[46:47], v150 offset:28288
    ds_read_b64_tr_b16 v[48:49], v150 offset:25792
    ds_read_b64_tr_b16 v[50:51], v150 offset:28352
    buffer_load_dwordx4 v4, s[40:43], s71 offen offset:0 sc1 lds
    s_waitcnt lgkmcnt(10)
    v_mfma_f32_32x32x16_bf16 v[112:127], v[28:31], a[128:131], v[112:127]
    ds_read_b64_tr_b16 v[52:53], v150 offset:25856
    ds_read_b64_tr_b16 v[54:55], v150 offset:28416
    s_waitcnt lgkmcnt(10)
    v_mfma_f32_32x32x16_bf16 v[128:143], v[32:35], a[128:131], v[128:143]
    s_waitcnt vmcnt(17) lgkmcnt(8)
    v_mfma_f32_32x32x16_bf16 v[64:79], v[36:39], a[132:135], v[64:79]
    ds_read_b64_tr_b16 v[16:17], v150 offset:30720
    ds_read_b64_tr_b16 v[18:19], v150 offset:33280
    ds_read_b64_tr_b16 v[20:21], v150 offset:30784
    buffer_load_dwordx4 v4, s[40:43], s71 offen offset:1024 sc1 lds
    s_waitcnt lgkmcnt(9)
    v_mfma_f32_32x32x16_bf16 v[80:95], v[40:43], a[132:135], v[80:95]
    ds_read_b64_tr_b16 v[22:23], v150 offset:33344
    ds_read_b64_tr_b16 v[24:25], v150 offset:30848
    s_waitcnt lgkmcnt(9)
    v_mfma_f32_32x32x16_bf16 v[96:111], v[44:47], a[132:135], v[96:111]
    ds_read_b64_tr_b16 v[26:27], v150 offset:33408
    ds_read_b64_tr_b16 v[28:29], v150 offset:30912
    ds_read_b64_tr_b16 v[30:31], v150 offset:33472
    buffer_load_dwordx4 v4, s[40:43], s71 offen offset:2048 sc1 lds
    s_waitcnt lgkmcnt(10)
    v_mfma_f32_32x32x16_bf16 v[112:127], v[48:51], a[132:135], v[112:127]
    ds_read_b64_tr_b16 v[32:33], v150 offset:30976
    ds_read_b64_tr_b16 v[34:35], v150 offset:33536
    s_waitcnt lgkmcnt(10)
    v_mfma_f32_32x32x16_bf16 v[128:143], v[52:55], a[132:135], v[128:143]
    s_waitcnt vmcnt(18) lgkmcnt(8)
    v_mfma_f32_32x32x16_bf16 v[64:79], v[16:19], a[136:139], v[64:79]
    ds_read_b64_tr_b16 v[36:37], v150 offset:35840
    ds_read_b64_tr_b16 v[38:39], v150 offset:38400
    ds_read_b64_tr_b16 v[40:41], v150 offset:35904
    buffer_load_dwordx4 v4, s[40:43], s71 offen offset:3072 sc1 lds
    s_waitcnt lgkmcnt(9)
    v_mfma_f32_32x32x16_bf16 v[80:95], v[20:23], a[136:139], v[80:95]
    ds_read_b64_tr_b16 v[42:43], v150 offset:38464
    ds_read_b64_tr_b16 v[44:45], v150 offset:35968
    s_waitcnt lgkmcnt(9)
    v_mfma_f32_32x32x16_bf16 v[96:111], v[24:27], a[136:139], v[96:111]
    ds_read_b64_tr_b16 v[46:47], v150 offset:38528
    ds_read_b64_tr_b16 v[48:49], v150 offset:36032
    ds_read_b64_tr_b16 v[50:51], v150 offset:38592
    s_add_u32 m0, s66, 41984
    s_waitcnt lgkmcnt(10)
    v_mfma_f32_32x32x16_bf16 v[112:127], v[28:31], a[136:139], v[112:127]
    ds_read_b64_tr_b16 v[52:53], v150 offset:36096
    ds_read_b64_tr_b16 v[54:55], v150 offset:38656
    buffer_load_dwordx4 v4, s[40:43], s96 offen offset:3072 sc1 lds
    s_waitcnt lgkmcnt(10)
    v_mfma_f32_32x32x16_bf16 v[128:143], v[32:35], a[136:139], v[128:143]
    s_waitcnt vmcnt(19) lgkmcnt(8)
    v_mfma_f32_32x32x16_bf16 v[64:79], v[36:39], a[140:143], v[64:79]
    s_barrier
    ds_read_b64_tr_b16 v[16:17], v150 offset:0
    ds_read_b64_tr_b16 v[18:19], v150 offset:2560
    s_waitcnt lgkmcnt(8)
    v_mfma_f32_32x32x16_bf16 v[80:95], v[40:43], a[140:143], v[80:95]
    ds_read_b64_tr_b16 v[20:21], v150 offset:64
    ds_read_b64_tr_b16 v[22:23], v150 offset:2624
    ds_read_b64_tr_b16 v[24:25], v150 offset:128
    s_add_u32 s71, s71, 10240
    s_waitcnt lgkmcnt(9)
    v_mfma_f32_32x32x16_bf16 v[96:111], v[44:47], a[140:143], v[96:111]
    ds_read_b64_tr_b16 v[26:27], v150 offset:2688
    ds_read_b64_tr_b16 v[28:29], v150 offset:192
    ds_read_b64_tr_b16 v[30:31], v150 offset:2752
    s_cmp_ge_u32 s71, s72
    s_cselect_b32 s71, s73, s71
    s_waitcnt lgkmcnt(10)
    v_mfma_f32_32x32x16_bf16 v[112:127], v[48:51], a[140:143], v[112:127]
    ds_read_b64_tr_b16 v[32:33], v150 offset:256
    ds_read_b64_tr_b16 v[34:35], v150 offset:2816
    s_waitcnt lgkmcnt(10)
    v_mfma_f32_32x32x16_bf16 v[128:143], v[52:55], a[140:143], v[128:143]
    s_waitcnt vmcnt(13) lgkmcnt(8)
    v_mfma_f32_32x32x16_bf16 v[64:79], v[16:19], a[144:147], v[64:79]
    ds_read_b64_tr_b16 v[36:37], v150 offset:5120
    ds_read_b64_tr_b16 v[38:39], v150 offset:7680
    ds_read_b64_tr_b16 v[40:41], v150 offset:5184
    s_add_u32 m0, s66, 61440
    s_waitcnt lgkmcnt(9)
    v_mfma_f32_32x32x16_bf16 v[80:95], v[20:23], a[144:147], v[80:95]
    ds_read_b64_tr_b16 v[42:43], v150 offset:7744
    ds_read_b64_tr_b16 v[44:45], v150 offset:5248
    s_add_u32 s96, s71, 1024
    s_waitcnt lgkmcnt(9)
    v_mfma_f32_32x32x16_bf16 v[96:111], v[24:27], a[144:147], v[96:111]
    ds_read_b64_tr_b16 v[46:47], v150 offset:7808
    ds_read_b64_tr_b16 v[48:49], v150 offset:5312
    ds_read_b64_tr_b16 v[50:51], v150 offset:7872
    buffer_load_dwordx4 v4, s[40:43], s71 offen offset:0 sc1 lds
    s_waitcnt lgkmcnt(10)
    v_mfma_f32_32x32x16_bf16 v[112:127], v[28:31], a[144:147], v[112:127]
    ds_read_b64_tr_b16 v[52:53], v150 offset:5376
    ds_read_b64_tr_b16 v[54:55], v150 offset:7936
    s_waitcnt lgkmcnt(10)
    v_mfma_f32_32x32x16_bf16 v[128:143], v[32:35], a[144:147], v[128:143]
    s_waitcnt vmcnt(13) lgkmcnt(8)
    v_mfma_f32_32x32x16_bf16 v[64:79], v[36:39], a[148:151], v[64:79]
    ds_read_b64_tr_b16 v[16:17], v150 offset:10240
    ds_read_b64_tr_b16 v[18:19], v150 offset:12800
    ds_read_b64_tr_b16 v[20:21], v150 offset:10304
    buffer_load_dwordx4 v4, s[40:43], s71 offen offset:1024 sc1 lds
    s_waitcnt lgkmcnt(9)
    v_mfma_f32_32x32x16_bf16 v[80:95], v[40:43], a[148:151], v[80:95]
    ds_read_b64_tr_b16 v[22:23], v150 offset:12864
    ds_read_b64_tr_b16 v[24:25], v150 offset:10368
    s_waitcnt lgkmcnt(9)
    v_mfma_f32_32x32x16_bf16 v[96:111], v[44:47], a[148:151], v[96:111]
    ds_read_b64_tr_b16 v[26:27], v150 offset:12928
    ds_read_b64_tr_b16 v[28:29], v150 offset:10432
    ds_read_b64_tr_b16 v[30:31], v150 offset:12992
    buffer_load_dwordx4 v4, s[40:43], s71 offen offset:2048 sc1 lds
    s_waitcnt lgkmcnt(10)
    v_mfma_f32_32x32x16_bf16 v[112:127], v[48:51], a[148:151], v[112:127]
    ds_read_b64_tr_b16 v[32:33], v150 offset:10496
    ds_read_b64_tr_b16 v[34:35], v150 offset:13056
    s_waitcnt lgkmcnt(10)
    v_mfma_f32_32x32x16_bf16 v[128:143], v[52:55], a[148:151], v[128:143]
    s_waitcnt vmcnt(14) lgkmcnt(8)
    v_mfma_f32_32x32x16_bf16 v[64:79], v[16:19], a[152:155], v[64:79]
    ds_read_b64_tr_b16 v[36:37], v150 offset:15360
    ds_read_b64_tr_b16 v[38:39], v150 offset:17920
    ds_read_b64_tr_b16 v[40:41], v150 offset:15424
    buffer_load_dwordx4 v4, s[40:43], s71 offen offset:3072 sc1 lds
    s_waitcnt lgkmcnt(9)
    v_mfma_f32_32x32x16_bf16 v[80:95], v[20:23], a[152:155], v[80:95]
    ds_read_b64_tr_b16 v[42:43], v150 offset:17984
    ds_read_b64_tr_b16 v[44:45], v150 offset:15488
    s_waitcnt lgkmcnt(9)
    v_mfma_f32_32x32x16_bf16 v[96:111], v[24:27], a[152:155], v[96:111]
    ds_read_b64_tr_b16 v[46:47], v150 offset:18048
    ds_read_b64_tr_b16 v[48:49], v150 offset:15552
    ds_read_b64_tr_b16 v[50:51], v150 offset:18112
    s_add_u32 m0, s66, 62464
    s_waitcnt lgkmcnt(10)
    v_mfma_f32_32x32x16_bf16 v[112:127], v[28:31], a[152:155], v[112:127]
    ds_read_b64_tr_b16 v[52:53], v150 offset:15616
    ds_read_b64_tr_b16 v[54:55], v150 offset:18176
    buffer_load_dwordx4 v4, s[40:43], s96 offen offset:3072 sc1 lds
    s_waitcnt lgkmcnt(10)
    v_mfma_f32_32x32x16_bf16 v[128:143], v[32:35], a[152:155], v[128:143]
    s_waitcnt vmcnt(15) lgkmcnt(8)
    v_mfma_f32_32x32x16_bf16 v[64:79], v[36:39], a[156:159], v[64:79]
    s_waitcnt lgkmcnt(6)
    v_mfma_f32_32x32x16_bf16 v[80:95], v[40:43], a[156:159], v[80:95]
    s_add_u32 s71, s71, 10240
    s_waitcnt lgkmcnt(4)
    v_mfma_f32_32x32x16_bf16 v[96:111], v[44:47], a[156:159], v[96:111]
    s_cmp_ge_u32 s71, s72
    s_cselect_b32 s71, s73, s71
    s_waitcnt lgkmcnt(2)
    v_mfma_f32_32x32x16_bf16 v[112:127], v[48:51], a[156:159], v[112:127]
    s_waitcnt lgkmcnt(0)
    v_mfma_f32_32x32x16_bf16 v[128:143], v[52:55], a[156:159], v[128:143]
    s_barrier
    s_sub_u32 s91, s62, 12
    s_mul_i32 s91, s91, 10240
    s_add_u32 s91, s91, s39
    s_add_u32 s91, s91, 10485760
    v_cvt_pk_bf16_f32 v24, v64, v65
    v_cvt_pk_bf16_f32 v25, v66, v67
    s_add_u32 m0, s66, 81920
    s_add_u32 s96, s71, 1024
    buffer_load_dwordx4 v4, s[40:43], s71 offen offset:0 sc1 lds
    v_cvt_pk_bf16_f32 v26, v68, v69
    v_cvt_pk_bf16_f32 v27, v70, v71
    buffer_load_dwordx4 v4, s[40:43], s71 offen offset:1024 sc1 lds
    v_cvt_pk_bf16_f32 v28, v72, v73
    v_cvt_pk_bf16_f32 v29, v74, v75
    buffer_load_dwordx4 v4, s[40:43], s71 offen offset:2048 sc1 lds
    v_cvt_pk_bf16_f32 v30, v76, v77
    v_cvt_pk_bf16_f32 v31, v78, v79
    buffer_load_dwordx4 v4, s[40:43], s71 offen offset:3072 sc1 lds
    buffer_store_dwordx4 v[24:27], v4, s[40:43], s91 offen offset:0 sc1
    buffer_store_dwordx4 v[28:31], v4, s[40:43], s91 offen offset:1024 sc1
    v_cvt_pk_bf16_f32 v32, v80, v81
    v_cvt_pk_bf16_f32 v33, v82, v83
    s_add_u32 m0, s66, 82944
    s_nop 0
    buffer_load_dwordx4 v4, s[40:43], s96 offen offset:3072 sc1 lds
    v_cvt_pk_bf16_f32 v34, v84, v85
    v_cvt_pk_bf16_f32 v35, v86, v87
    s_add_u32 s71, s71, 10240
    s_cmp_ge_u32 s71, s72
    s_cselect_b32 s71, s73, s71
    v_cvt_pk_bf16_f32 v36, v88, v89
    v_cvt_pk_bf16_f32 v37, v90, v91
    s_add_u32 m0, s66, 0
    s_add_u32 s96, s71, 1024
    buffer_load_dwordx4 v4, s[40:43], s71 offen offset:0 sc1 lds
    v_cvt_pk_bf16_f32 v38, v92, v93
    v_cvt_pk_bf16_f32 v39, v94, v95
    buffer_load_dwordx4 v4, s[40:43], s71 offen offset:1024 sc1 lds
    buffer_store_dwordx4 v[32:35], v4, s[40:43], s91 offen offset:2048 sc1
    buffer_store_dwordx4 v[36:39], v4, s[40:43], s91 offen offset:3072 sc1
    v_cvt_pk_bf16_f32 v24, v96, v97
    v_cvt_pk_bf16_f32 v25, v98, v99
    buffer_load_dwordx4 v4, s[40:43], s71 offen offset:2048 sc1 lds
    v_cvt_pk_bf16_f32 v26, v100, v101
    v_cvt_pk_bf16_f32 v27, v102, v103
    buffer_load_dwordx4 v4, s[40:43], s71 offen offset:3072 sc1 lds
    v_cvt_pk_bf16_f32 v28, v104, v105
    v_cvt_pk_bf16_f32 v29, v106, v107
    s_add_u32 m0, s66, 1024
    s_nop 0
    buffer_load_dwordx4 v4, s[40:43], s96 offen offset:3072 sc1 lds
    v_cvt_pk_bf16_f32 v30, v108, v109
    v_cvt_pk_bf16_f32 v31, v110, v111
    s_add_u32 s71, s71, 10240
    s_cmp_ge_u32 s71, s72
    s_cselect_b32 s71, s73, s71
    s_add_u32 s91, s91, 4096
    buffer_store_dwordx4 v[24:27], v4, s[40:43], s91 offen offset:0 sc1
    buffer_store_dwordx4 v[28:31], v4, s[40:43], s91 offen offset:1024 sc1
    v_cvt_pk_bf16_f32 v32, v112, v113
    v_cvt_pk_bf16_f32 v33, v114, v115
    v_cvt_pk_bf16_f32 v34, v116, v117
    v_cvt_pk_bf16_f32 v35, v118, v119
    v_cvt_pk_bf16_f32 v36, v120, v121
    v_cvt_pk_bf16_f32 v37, v122, v123
    v_cvt_pk_bf16_f32 v38, v124, v125
    v_cvt_pk_bf16_f32 v39, v126, v127
    buffer_store_dwordx4 v[32:35], v4, s[40:43], s91 offen offset:2048 sc1
    buffer_store_dwordx4 v[36:39], v4, s[40:43], s91 offen offset:3072 sc1
    v_cvt_pk_bf16_f32 v24, v128, v129
    v_cvt_pk_bf16_f32 v25, v130, v131
    v_cvt_pk_bf16_f32 v26, v132, v133
    v_cvt_pk_bf16_f32 v27, v134, v135
    v_cvt_pk_bf16_f32 v28, v136, v137
    v_cvt_pk_bf16_f32 v29, v138, v139
    v_cvt_pk_bf16_f32 v30, v140, v141
    v_cvt_pk_bf16_f32 v31, v142, v143
    s_add_u32 s91, s91, 4096
    buffer_store_dwordx4 v[24:27], v4, s[40:43], s91 offen offset:0 sc1
    buffer_store_dwordx4 v[28:31], v4, s[40:43], s91 offen offset:1024 sc1
L_p3_done:
    s_nop 1
    s_mul_i32 s82, s77, 10240
    v_add_u32 v148, s82, v4
    v_add_u32 v149, 61440, v148
    v_add_u32 v150, 122880, v148
    v_add_u32 v234, 81920, v234
    v_add_u32 v235, 81920, v235
    s_mov_b32 s82, 0xffff0000
    v_lshlrev_b32 v64, 16, v212
    v_and_b32 v65, s82, v212
    v_lshlrev_b32 v66, 16, v213
    v_and_b32 v67, s82, v213
    v_lshlrev_b32 v68, 16, v214
    v_and_b32 v69, s82, v214
    v_lshlrev_b32 v70, 16, v215
    v_and_b32 v71, s82, v215
    v_lshlrev_b32 v72, 16, v216
    v_and_b32 v73, s82, v216
    v_lshlrev_b32 v74, 16, v217
    v_and_b32 v75, s82, v217
    v_lshlrev_b32 v76, 16, v218
    v_and_b32 v77, s82, v218
    v_lshlrev_b32 v78, 16, v219
    v_and_b32 v79, s82, v219
    v_lshlrev_b32 v80, 16, v220
    v_and_b32 v81, s82, v220
    v_lshlrev_b32 v82, 16, v221
    v_and_b32 v83, s82, v221
    s_mov_b32 s52, s32
    s_mov_b32 s53, s33
    s_mov_b32 s54, 2621440
    s_mov_b32 s55, 0x20000
    s_mul_i32 s82, s80, 98304
    s_mul_i32 s83, s77, 49152
    s_add_u32 s82, s82, s83
    s_add_u32 s82, s82, 13107200
    s_mov_b32 s76, s82
    s_add_u32 s75, s82, 49152
    s_mul_i32 s74, s14, 4096
    s_add_u32 s74, s74, s82
    s_add_u32 m0, s66, 143360
    s_add_u32 s96, s71, 1024
    buffer_load_dwordx4 v4, s[40:43], s71 offen offset:0 sc1 lds
    buffer_load_dwordx4 v4, s[40:43], s71 offen offset:1024 sc1 lds
    buffer_load_dwordx4 v4, s[40:43], s71 offen offset:2048 sc1 lds
    buffer_load_dwordx4 v4, s[40:43], s71 offen offset:3072 sc1 lds
    s_add_u32 m0, s66, 144384
    s_nop 0
    buffer_load_dwordx4 v4, s[40:43], s96 offen offset:3072 sc1 lds
    s_add_u32 s71, s71, 10240
    s_cmp_ge_u32 s71, s72
    s_cselect_b32 s71, s73, s71
    s_waitcnt vmcnt(5)
    s_barrier
    s_cmp_gt_u32 s60, 1
    s_cbranch_scc1 L_fs_44
    s_mov_b64 exec, 1
    s_cmp_eq_u32 s60, 0
    s_cbranch_scc1 L_fs_45
    s_lshl_b32 s93, s65, 2
    s_add_u32 s93, s93, 22090752
    buffer_store_dword v15, v4, s[40:43], s93 offen sc1
    s_branch L_fs_44
L_fs_45:
    s_lshl_b32 s92, s61, 9
    s_lshl_b32 s93, s62, 2
    s_add_u32 s92, s92, s93
    s_add_u32 s92, s92, 22020416
    buffer_store_dword v15, v4, s[40:43], s92 offen
L_fs_44:
    s_mov_b64 exec, -1
    s_lshl_b32 s83, s60, 13
    s_add_u32 s83, s83, 122880
    v_add_u32 v60, 0, v0
    v_mul_u32_u24 v61, 6554, v60
    v_lshrrev_b32 v61, 16, v61
    v_mul_u32_u24 v63, 10, v61
    v_sub_u32 v62, v60, v63
    v_mul_u32_u24 v61, 336, v61
    v_lshl_add_u32 v61, v62, 5, v61
    v_add_u32 v176, s83, v61
    v_add_u32 v60, 64, v0
    v_mul_u32_u24 v61, 6554, v60
    v_lshrrev_b32 v61, 16, v61
    v_mul_u32_u24 v63, 10, v61
    v_sub_u32 v62, v60, v63
    v_mul_u32_u24 v61, 336, v61
    v_lshl_add_u32 v61, v62, 5, v61
    v_add_u32 v177, s83, v61
    v_add_u32 v60, 128, v0
    v_mul_u32_u24 v61, 6554, v60
    v_lshrrev_b32 v61, 16, v61
    v_mul_u32_u24 v63, 10, v61
    v_sub_u32 v62, v60, v63
    v_mul_u32_u24 v61, 336, v61
    v_lshl_add_u32 v61, v62, 5, v61
    v_add_u32 v178, s83, v61
    v_and_b32 v58, 15, v0
    v_mul_u32_u24 v58, 336, v58
    v_lshrrev_b32 v59, 4, v0
    v_lshl_add_u32 v58, v59, 4, v58
    v_add_u32 v179, s83, v58
    v_lshrrev_b32 v59, 5, v0
    v_lshl_add_u32 v180, v59, 5, v179
    s_mov_b32 s82, 0xffff0000
    v_lshlrev_b32 v152, 16, v200
    v_and_b32 v153, s82, v200
    v_lshlrev_b32 v154, 16, v201
    v_and_b32 v155, s82, v201
    v_lshlrev_b32 v156, 16, v202
    v_and_b32 v157, s82, v202
    v_lshlrev_b32 v158, 16, v203
    v_and_b32 v159, s82, v203
    v_lshlrev_b32 v160, 16, v204
    v_and_b32 v161, s82, v204
    v_lshlrev_b32 v162, 16, v205
    v_and_b32 v163, s82, v205
    v_lshlrev_b32 v164, 16, v206
    v_and_b32 v165, s82, v206
    v_lshlrev_b32 v166, 16, v207
    v_and_b32 v167, s82, v207
    v_lshlrev_b32 v168, 16, v208
    v_and_b32 v169, s82, v208
    v_lshlrev_b32 v170, 16, v209
    v_and_b32 v171, s82, v209
    v_lshlrev_b32 v172, 16, v210
    v_and_b32 v173, s82, v210
    v_lshlrev_b32 v174, 16, v211
    v_and_b32 v175, s82, v211
    s_cmp_lg_u32 s60, 0
    s_cbranch_scc1 L_wd_46
    s_mov_b32 s84, 5
    v_lshlrev_b32 v1, 2, v0
    s_lshl_b32 s82, s61, 9
    s_lshl_b32 s83, s84, 6
    s_add_u32 s82, s82, s83
    s_add_u32 s82, s82, 22020096
    s_mov_b64 exec, 4095
    s_mov_b32 s85, 0
    s_cmp_eq_u32 s64, 0
    s_cbranch_scc1 L_wsl_47
L_wf_48:
    buffer_load_dword v2, v1, s[40:43], s82 offen sc1
    s_add_u32 s85, s85, 1
    s_waitcnt vmcnt(0)
    v_cmp_ne_u32 vcc, v2, v15
    s_cbranch_vccz L_wd_46
    s_cmp_lt_u32 s85, 96
    s_cbranch_scc1 L_wf_48
    s_mov_b32 s64, 0
L_wsl_47:
    s_lshl_b32 s82, s61, 6
    s_lshl_b32 s83, s84, 10
    s_add_u32 s82, s82, s83
    s_add_u32 s82, s82, 22085632
L_ws_49:
    buffer_load_dword v2, v1, s[40:43], s82 offen sc1
    s_add_u32 s85, s85, 1
    s_waitcnt vmcnt(0)
    v_cmp_ne_u32 vcc, v2, v15
    s_cbranch_vccz L_wd_46
    s_cmp_lt_u32 s85, 400000
    s_cbranch_scc1 L_ws_49
L_wd_46:
    s_mov_b64 exec, -1
    s_barrier
    buffer_load_dwordx4 a[0:3], v10, s[40:43], s74 offen offset:0 sc1
    buffer_load_dwordx4 a[4:7], v11, s[40:43], s74 offen offset:0 sc1
    buffer_load_dwordx4 a[8:11], v10, s[40:43], s74 offen offset:2048 sc1
    buffer_load_dwordx4 a[12:15], v11, s[40:43], s74 offen offset:2048 sc1
    s_add_u32 s74, s74, 4096
    s_cmp_ge_u32 s74, s75
    s_cselect_b32 s74, s76, s74
    buffer_load_dwordx4 a[16:19], v10, s[40:43], s74 offen offset:0 sc1
    buffer_load_dwordx4 a[20:23], v11, s[40:43], s74 offen offset:0 sc1
    buffer_load_dwordx4 a[24:27], v10, s[40:43], s74 offen offset:2048 sc1
    buffer_load_dwordx4 a[28:31], v11, s[40:43], s74 offen offset:2048 sc1
    s_add_u32 s74, s74, 4096
    s_cmp_ge_u32 s74, s75
    s_cselect_b32 s74, s76, s74
    buffer_load_dwordx4 a[32:35], v10, s[40:43], s74 offen offset:0 sc1
    buffer_load_dwordx4 a[36:39], v11, s[40:43], s74 offen offset:0 sc1
    buffer_load_dwordx4 a[40:43], v10, s[40:43], s74 offen offset:2048 sc1
    buffer_load_dwordx4 a[44:47], v11, s[40:43], s74 offen offset:2048 sc1
    s_add_u32 s74, s74, 4096
    s_cmp_ge_u32 s74, s75
    s_cselect_b32 s74, s76, s74
    s_barrier
    ds_read_b128 v[16:19], v149 offset:40960
    ds_read_b128 v[20:23], v149 offset:41984
    ds_read_b128 v[24:27], v149 offset:43008
    ds_read_b128 v[28:31], v149 offset:44032
    ds_read_b128 v[32:35], v149 offset:45056
    s_waitcnt vmcnt(11) lgkmcnt(4)
    v_mfma_f32_16x16x32_bf16 v[64:67], v[16:19], a[0:3], v[64:67]
    ds_read_b128 v[36:39], v149 offset:46080
    buffer_load_dwordx4 a[48:51], v10, s[40:43], s74 offen offset:0 sc1
    s_waitcnt vmcnt(11)
    v_mfma_f32_16x16x32_bf16 v[84:87], v[16:19], a[4:7], 0
    ds_read_b128 v[40:43], v149 offset:47104
    s_waitcnt lgkmcnt(5)
    v_mfma_f32_16x16x32_bf16 v[68:71], v[20:23], a[0:3], v[68:71]
    v_mfma_f32_16x16x32_bf16 v[88:91], v[20:23], a[4:7], 0
    ds_read_b128 v[44:47], v149 offset:48128
    s_waitcnt lgkmcnt(5)
    v_mfma_f32_16x16x32_bf16 v[72:75], v[24:27], a[0:3], v[72:75]
    buffer_load_dwordx4 a[52:55], v11, s[40:43], s74 offen offset:0 sc1
    v_mfma_f32_16x16x32_bf16 v[92:95], v[24:27], a[4:7], 0
    ds_read_b128 v[48:51], v149 offset:49152
    s_waitcnt lgkmcnt(5)
    v_mfma_f32_16x16x32_bf16 v[76:79], v[28:31], a[0:3], v[76:79]
    v_mfma_f32_16x16x32_bf16 v[96:99], v[28:31], a[4:7], 0
    ds_read_b128 v[52:55], v149 offset:50176
    s_waitcnt lgkmcnt(5)
    v_mfma_f32_16x16x32_bf16 v[80:83], v[32:35], a[0:3], v[80:83]
    buffer_load_dwordx4 a[56:59], v10, s[40:43], s74 offen offset:2048 sc1
    v_mfma_f32_16x16x32_bf16 v[100:103], v[32:35], a[4:7], 0
    s_waitcnt vmcnt(12) lgkmcnt(4)
    v_mfma_f32_16x16x32_bf16 v[64:67], v[36:39], a[8:11], v[64:67]
    s_barrier
    s_waitcnt vmcnt(11)
    v_mfma_f32_16x16x32_bf16 v[84:87], v[36:39], a[12:15], v[84:87]
    ds_read_b128 v[16:19], v148 offset:20480
    s_waitcnt lgkmcnt(4)
    v_mfma_f32_16x16x32_bf16 v[68:71], v[40:43], a[8:11], v[68:71]
    ds_read_b128 v[20:23], v148 offset:21504
    buffer_load_dwordx4 a[60:63], v11, s[40:43], s74 offen offset:2048 sc1
    v_mfma_f32_16x16x32_bf16 v[88:91], v[40:43], a[12:15], v[88:91]
    ds_read_b128 v[24:27], v148 offset:22528
    s_waitcnt lgkmcnt(5)
    v_mfma_f32_16x16x32_bf16 v[72:75], v[44:47], a[8:11], v[72:75]
    s_add_u32 s74, s74, 4096
    v_mfma_f32_16x16x32_bf16 v[92:95], v[44:47], a[12:15], v[92:95]
    ds_read_b128 v[28:31], v148 offset:23552
    s_waitcnt lgkmcnt(5)
    v_mfma_f32_16x16x32_bf16 v[76:79], v[48:51], a[8:11], v[76:79]
    s_cmp_ge_u32 s74, s75
    s_cselect_b32 s74, s76, s74
    v_mfma_f32_16x16x32_bf16 v[96:99], v[48:51], a[12:15], v[96:99]
    ds_read_b128 v[32:35], v148 offset:24576
    s_waitcnt lgkmcnt(5)
    v_mfma_f32_16x16x32_bf16 v[80:83], v[52:55], a[8:11], v[80:83]
    v_mfma_f32_16x16x32_bf16 v[100:103], v[52:55], a[12:15], v[100:103]
    s_waitcnt vmcnt(11) lgkmcnt(4)
    v_mfma_f32_16x16x32_bf16 v[64:67], v[16:19], a[16:19], v[64:67]
    ds_read_b128 v[36:39], v148 offset:25600
    buffer_load_dwordx4 a[64:67], v10, s[40:43], s74 offen offset:0 sc1
    s_waitcnt vmcnt(11)
    v_mfma_f32_16x16x32_bf16 v[84:87], v[16:19], a[20:23], v[84:87]
    ds_read_b128 v[40:43], v148 offset:26624
    s_waitcnt lgkmcnt(5)
    v_mfma_f32_16x16x32_bf16 v[68:71], v[20:23], a[16:19], v[68:71]
    buffer_load_dwordx4 a[68:71], v11, s[40:43], s74 offen offset:0 sc1
    v_mfma_f32_16x16x32_bf16 v[88:91], v[20:23], a[20:23], v[88:91]
    ds_read_b128 v[44:47], v148 offset:27648
    s_waitcnt lgkmcnt(5)
    v_mfma_f32_16x16x32_bf16 v[72:75], v[24:27], a[16:19], v[72:75]
    buffer_load_dwordx4 a[72:75], v10, s[40:43], s74 offen offset:2048 sc1
    v_mfma_f32_16x16x32_bf16 v[92:95], v[24:27], a[20:23], v[92:95]
    ds_read_b128 v[48:51], v148 offset:28672
    s_waitcnt lgkmcnt(5)
    v_mfma_f32_16x16x32_bf16 v[76:79], v[28:31], a[16:19], v[76:79]
    buffer_load_dwordx4 a[76:79], v11, s[40:43], s74 offen offset:2048 sc1
    s_add_u32 s74, s74, 4096
    v_mfma_f32_16x16x32_bf16 v[96:99], v[28:31], a[20:23], v[96:99]
    ds_read_b128 v[52:55], v148 offset:29696
    s_waitcnt lgkmcnt(5)
    v_mfma_f32_16x16x32_bf16 v[80:83], v[32:35], a[16:19], v[80:83]
    s_cmp_ge_u32 s74, s75
    s_cselect_b32 s74, s76, s74
    s_add_u32 m0, s66, 122880
    v_mfma_f32_16x16x32_bf16 v[100:103], v[32:35], a[20:23], v[100:103]
    s_add_u32 s96, s71, 1024
    s_waitcnt vmcnt(13) lgkmcnt(4)
    v_mfma_f32_16x16x32_bf16 v[64:67], v[36:39], a[24:27], v[64:67]
    s_barrier
    s_waitcnt vmcnt(12)
    v_mfma_f32_16x16x32_bf16 v[84:87], v[36:39], a[28:31], v[84:87]
    ds_read_b128 v[16:19], v148 offset:40960
    s_waitcnt lgkmcnt(4)
    v_mfma_f32_16x16x32_bf16 v[68:71], v[40:43], a[24:27], v[68:71]
    ds_read_b128 v[20:23], v148 offset:41984
    buffer_load_dwordx4 v4, s[40:43], s71 offen offset:0 sc1 lds
    v_mfma_f32_16x16x32_bf16 v[88:91], v[40:43], a[28:31], v[88:91]
    ds_read_b128 v[24:27], v148 offset:43008
    s_waitcnt lgkmcnt(5)
    v_mfma_f32_16x16x32_bf16 v[72:75], v[44:47], a[24:27], v[72:75]
    buffer_load_dwordx4 v4, s[40:43], s71 offen offset:1024 sc1 lds
    v_mfma_f32_16x16x32_bf16 v[92:95], v[44:47], a[28:31], v[92:95]
    ds_read_b128 v[28:31], v148 offset:44032
    s_waitcnt lgkmcnt(5)
    v_mfma_f32_16x16x32_bf16 v[76:79], v[48:51], a[24:27], v[76:79]
    buffer_load_dwordx4 v4, s[40:43], s71 offen offset:2048 sc1 lds
    v_mfma_f32_16x16x32_bf16 v[96:99], v[48:51], a[28:31], v[96:99]
    ds_read_b128 v[32:35], v148 offset:45056
    s_waitcnt lgkmcnt(5)
    v_mfma_f32_16x16x32_bf16 v[80:83], v[52:55], a[24:27], v[80:83]
    buffer_load_dwordx4 v4, s[40:43], s71 offen offset:3072 sc1 lds
    s_add_u32 m0, s66, 123904
    v_mfma_f32_16x16x32_bf16 v[100:103], v[52:55], a[28:31], v[100:103]
    buffer_load_dwordx4 v4, s[40:43], s96 offen offset:3072 sc1 lds
    s_add_u32 s71, s71, 10240
    s_cmp_ge_u32 s71, s72
    s_cselect_b32 s71, s73, s71
    s_waitcnt vmcnt(16) lgkmcnt(4)
    v_mfma_f32_16x16x32_bf16 v[64:67], v[16:19], a[32:35], v[64:67]
    ds_read_b128 v[36:39], v148 offset:46080
    buffer_load_dwordx4 a[80:83], v10, s[40:43], s74 offen offset:0 sc1
    s_waitcnt vmcnt(16)
    v_mfma_f32_16x16x32_bf16 v[84:87], v[16:19], a[36:39], v[84:87]
    ds_read_b128 v[40:43], v148 offset:47104
    s_waitcnt lgkmcnt(5)
    v_mfma_f32_16x16x32_bf16 v[68:71], v[20:23], a[32:35], v[68:71]
    buffer_load_dwordx4 a[84:87], v11, s[40:43], s74 offen offset:0 sc1
    v_mfma_f32_16x16x32_bf16 v[88:91], v[20:23], a[36:39], v[88:91]
    ds_read_b128 v[44:47], v148 offset:48128
    s_waitcnt lgkmcnt(5)
    v_mfma_f32_16x16x32_bf16 v[72:75], v[24:27], a[32:35], v[72:75]
    buffer_load_dwordx4 a[88:91], v10, s[40:43], s74 offen offset:2048 sc1
    v_mfma_f32_16x16x32_bf16 v[92:95], v[24:27], a[36:39], v[92:95]
    ds_read_b128 v[48:51], v148 offset:49152
    s_waitcnt lgkmcnt(5)
    v_mfma_f32_16x16x32_bf16 v[76:79], v[28:31], a[32:35], v[76:79]
    buffer_load_dwordx4 a[92:95], v11, s[40:43], s74 offen offset:2048 sc1
    s_add_u32 s74, s74, 4096
    v_mfma_f32_16x16x32_bf16 v[96:99], v[28:31], a[36:39], v[96:99]
    ds_read_b128 v[52:55], v148 offset:50176
    s_waitcnt lgkmcnt(5)
    v_mfma_f32_16x16x32_bf16 v[80:83], v[32:35], a[32:35], v[80:83]
    s_cmp_ge_u32 s74, s75
    s_cselect_b32 s74, s76, s74
    s_add_u32 m0, s66, 102400
    v_mfma_f32_16x16x32_bf16 v[100:103], v[32:35], a[36:39], v[100:103]
    s_add_u32 s96, s71, 1024
    s_waitcnt vmcnt(18) lgkmcnt(4)
    v_mfma_f32_16x16x32_bf16 v[64:67], v[36:39], a[40:43], v[64:67]
    s_barrier
    s_waitcnt vmcnt(17)
    v_mfma_f32_16x16x32_bf16 v[84:87], v[36:39], a[44:47], v[84:87]
    ds_read_b128 v[16:19], v149 offset:0
    s_waitcnt lgkmcnt(4)
    v_mfma_f32_16x16x32_bf16 v[68:71], v[40:43], a[40:43], v[68:71]
    ds_read_b128 v[20:23], v149 offset:1024
    buffer_load_dwordx4 v4, s[40:43], s71 offen offset:0 sc1 lds
    v_mfma_f32_16x16x32_bf16 v[88:91], v[40:43], a[44:47], v[88:91]
    ds_read_b128 v[24:27], v149 offset:2048
    s_waitcnt lgkmcnt(5)
    v_mfma_f32_16x16x32_bf16 v[72:75], v[44:47], a[40:43], v[72:75]
    buffer_load_dwordx4 v4, s[40:43], s71 offen offset:1024 sc1 lds
    v_mfma_f32_16x16x32_bf16 v[92:95], v[44:47], a[44:47], v[92:95]
    ds_read_b128 v[28:31], v149 offset:3072
    s_waitcnt lgkmcnt(5)
    v_mfma_f32_16x16x32_bf16 v[76:79], v[48:51], a[40:43], v[76:79]
    buffer_load_dwordx4 v4, s[40:43], s71 offen offset:2048 sc1 lds
    v_mfma_f32_16x16x32_bf16 v[96:99], v[48:51], a[44:47], v[96:99]
    ds_read_b128 v[32:35], v149 offset:4096
    s_waitcnt lgkmcnt(5)
    v_mfma_f32_16x16x32_bf16 v[80:83], v[52:55], a[40:43], v[80:83]
    buffer_load_dwordx4 v4, s[40:43], s71 offen offset:3072 sc1 lds
    s_add_u32 m0, s66, 103424
    v_mfma_f32_16x16x32_bf16 v[100:103], v[52:55], a[44:47], v[100:103]
    buffer_load_dwordx4 v4, s[40:43], s96 offen offset:3072 sc1 lds
    s_add_u32 s71, s71, 10240
    s_cmp_ge_u32 s71, s72
    s_cselect_b32 s71, s73, s71
    s_waitcnt vmcnt(21) lgkmcnt(4)
    v_mfma_f32_16x16x32_bf16 v[64:67], v[16:19], a[48:51], v[64:67]
    ds_read_b128 v[36:39], v149 offset:5120
    buffer_load_dwordx4 a[96:99], v10, s[40:43], s74 offen offset:0 sc1
    s_waitcnt vmcnt(21)
    v_mfma_f32_16x16x32_bf16 v[84:87], v[16:19], a[52:55], v[84:87]
    ds_read_b128 v[40:43], v149 offset:6144
    s_waitcnt lgkmcnt(5)
    v_mfma_f32_16x16x32_bf16 v[68:71], v[20:23], a[48:51], v[68:71]
    buffer_load_dwordx4 a[100:103], v11, s[40:43], s74 offen offset:0 sc1
    v_mfma_f32_16x16x32_bf16 v[88:91], v[20:23], a[52:55], v[88:91]
    ds_read_b128 v[44:47], v149 offset:7168
    s_waitcnt lgkmcnt(5)
    v_mfma_f32_16x16x32_bf16 v[72:75], v[24:27], a[48:51], v[72:75]
    buffer_load_dwordx4 a[104:107], v10, s[40:43], s74 offen offset:2048 sc1
    v_mfma_f32_16x16x32_bf16 v[92:95], v[24:27], a[52:55], v[92:95]
    ds_read_b128 v[48:51], v149 offset:8192
    s_waitcnt lgkmcnt(5)
    v_mfma_f32_16x16x32_bf16 v[76:79], v[28:31], a[48:51], v[76:79]
    buffer_load_dwordx4 a[108:111], v11, s[40:43], s74 offen offset:2048 sc1
    s_add_u32 s74, s74, 4096
    v_mfma_f32_16x16x32_bf16 v[96:99], v[28:31], a[52:55], v[96:99]
    ds_read_b128 v[52:55], v149 offset:9216
    s_waitcnt lgkmcnt(5)
    v_mfma_f32_16x16x32_bf16 v[80:83], v[32:35], a[48:51], v[80:83]
    s_cmp_ge_u32 s74, s75
    s_cselect_b32 s74, s76, s74
    s_add_u32 m0, s66, 20480
    v_mfma_f32_16x16x32_bf16 v[100:103], v[32:35], a[52:55], v[100:103]
    s_add_u32 s96, s71, 1024
    s_waitcnt vmcnt(23) lgkmcnt(4)
    v_mfma_f32_16x16x32_bf16 v[64:67], v[36:39], a[56:59], v[64:67]
    s_barrier
    s_waitcnt vmcnt(22)
    v_mfma_f32_16x16x32_bf16 v[84:87], v[36:39], a[60:63], v[84:87]
    ds_read_b128 v[16:19], v149 offset:20480
    s_waitcnt lgkmcnt(4)
    v_mfma_f32_16x16x32_bf16 v[68:71], v[40:43], a[56:59], v[68:71]
    ds_read_b128 v[20:23], v149 offset:21504
    buffer_load_dwordx4 v4, s[40:43], s71 offen offset:0 sc1 lds
    v_mfma_f32_16x16x32_bf16 v[88:91], v[40:43], a[60:63], v[88:91]
    ds_read_b128 v[24:27], v149 offset:22528
    s_waitcnt lgkmcnt(5)
    v_mfma_f32_16x16x32_bf16 v[72:75], v[44:47], a[56:59], v[72:75]
    buffer_load_dwordx4 v4, s[40:43], s71 offen offset:1024 sc1 lds
    v_mfma_f32_16x16x32_bf16 v[92:95], v[44:47], a[60:63], v[92:95]
    ds_read_b128 v[28:31], v149 offset:23552
    s_waitcnt lgkmcnt(5)
    v_mfma_f32_16x16x32_bf16 v[76:79], v[48:51], a[56:59], v[76:79]
    buffer_load_dwordx4 v4, s[40:43], s71 offen offset:2048 sc1 lds
    v_mfma_f32_16x16x32_bf16 v[96:99], v[48:51], a[60:63], v[96:99]
    ds_read_b128 v[32:35], v149 offset:24576
    s_waitcnt lgkmcnt(5)
    v_mfma_f32_16x16x32_bf16 v[80:83], v[52:55], a[56:59], v[80:83]
    buffer_load_dwordx4 v4, s[40:43], s71 offen offset:3072 sc1 lds
    s_add_u32 m0, s66, 21504
    v_mfma_f32_16x16x32_bf16 v[100:103], v[52:55], a[60:63], v[100:103]
    buffer_load_dwordx4 v4, s[40:43], s96 offen offset:3072 sc1 lds
    s_add_u32 s71, s71, 10240
    s_cmp_ge_u32 s71, s72
    s_cselect_b32 s71, s73, s71
    s_waitcnt vmcnt(26) lgkmcnt(4)
    v_mfma_f32_16x16x32_bf16 v[64:67], v[16:19], a[64:67], v[64:67]
    ds_read_b128 v[36:39], v149 offset:25600
    buffer_load_dwordx4 a[112:115], v10, s[40:43], s74 offen offset:0 sc1
    s_waitcnt vmcnt(26)
    v_mfma_f32_16x16x32_bf16 v[84:87], v[16:19], a[68:71], v[84:87]
    ds_read_b128 v[40:43], v149 offset:26624
    s_waitcnt lgkmcnt(5)
    v_mfma_f32_16x16x32_bf16 v[68:71], v[20:23], a[64:67], v[68:71]
    buffer_load_dwordx4 a[116:119], v11, s[40:43], s74 offen offset:0 sc1
    v_mfma_f32_16x16x32_bf16 v[88:91], v[20:23], a[68:71], v[88:91]
    ds_read_b128 v[44:47], v149 offset:27648
    s_waitcnt lgkmcnt(5)
    v_mfma_f32_16x16x32_bf16 v[72:75], v[24:27], a[64:67], v[72:75]
    buffer_load_dwordx4 a[120:123], v10, s[40:43], s74 offen offset:2048 sc1
    v_mfma_f32_16x16x32_bf16 v[92:95], v[24:27], a[68:71], v[92:95]
    ds_read_b128 v[48:51], v149 offset:28672
    s_waitcnt lgkmcnt(5)
    v_mfma_f32_16x16x32_bf16 v[76:79], v[28:31], a[64:67], v[76:79]
    buffer_load_dwordx4 a[124:127], v11, s[40:43], s74 offen offset:2048 sc1
    s_add_u32 s74, s74, 4096
    v_mfma_f32_16x16x32_bf16 v[96:99], v[28:31], a[68:71], v[96:99]
    ds_read_b128 v[52:55], v149 offset:29696
    s_waitcnt lgkmcnt(5)
    v_mfma_f32_16x16x32_bf16 v[80:83], v[32:35], a[64:67], v[80:83]
    s_cmp_ge_u32 s74, s75
    s_cselect_b32 s74, s76, s74
    s_add_u32 m0, s66, 40960
    v_mfma_f32_16x16x32_bf16 v[100:103], v[32:35], a[68:71], v[100:103]
    s_add_u32 s96, s71, 1024
    s_waitcnt vmcnt(28) lgkmcnt(4)
    v_mfma_f32_16x16x32_bf16 v[64:67], v[36:39], a[72:75], v[64:67]
    s_barrier
    s_waitcnt vmcnt(27)
    v_mfma_f32_16x16x32_bf16 v[84:87], v[36:39], a[76:79], v[84:87]
    ds_read_b128 v[16:19], v148 offset:0
    s_waitcnt lgkmcnt(4)
    v_mfma_f32_16x16x32_bf16 v[68:71], v[40:43], a[72:75], v[68:71]
    ds_read_b128 v[20:23], v148 offset:1024
    buffer_load_dwordx4 v4, s[40:43], s71 offen offset:0 sc1 lds
    v_mfma_f32_16x16x32_bf16 v[88:91], v[40:43], a[76:79], v[88:91]
    ds_read_b128 v[24:27], v148 offset:2048
    s_waitcnt lgkmcnt(5)
    v_mfma_f32_16x16x32_bf16 v[72:75], v[44:47], a[72:75], v[72:75]
    buffer_load_dwordx4 v4, s[40:43], s71 offen offset:1024 sc1 lds
    v_mfma_f32_16x16x32_bf16 v[92:95], v[44:47], a[76:79], v[92:95]
    ds_read_b128 v[28:31], v148 offset:3072
    s_waitcnt lgkmcnt(5)
    v_mfma_f32_16x16x32_bf16 v[76:79], v[48:51], a[72:75], v[76:79]
    buffer_load_dwordx4 v4, s[40:43], s71 offen offset:2048 sc1 lds
    v_mfma_f32_16x16x32_bf16 v[96:99], v[48:51], a[76:79], v[96:99]
    ds_read_b128 v[32:35], v148 offset:4096
    s_waitcnt lgkmcnt(5)
    v_mfma_f32_16x16x32_bf16 v[80:83], v[52:55], a[72:75], v[80:83]
    buffer_load_dwordx4 v4, s[40:43], s71 offen offset:3072 sc1 lds
    s_add_u32 m0, s66, 41984
    v_mfma_f32_16x16x32_bf16 v[100:103], v[52:55], a[76:79], v[100:103]
    buffer_load_dwordx4 v4, s[40:43], s96 offen offset:3072 sc1 lds
    s_add_u32 s71, s71, 10240
    s_cmp_ge_u32 s71, s72
    s_cselect_b32 s71, s73, s71
    s_waitcnt vmcnt(26) lgkmcnt(4)
    v_mfma_f32_16x16x32_bf16 v[64:67], v[16:19], a[80:83], v[64:67]
    ds_read_b128 v[36:39], v148 offset:5120
    buffer_load_dwordx4 a[128:131], v10, s[40:43], s74 offen offset:0 sc1
    s_waitcnt vmcnt(26)
    v_mfma_f32_16x16x32_bf16 v[84:87], v[16:19], a[84:87], v[84:87]
    ds_read_b128 v[40:43], v148 offset:6144
    s_waitcnt lgkmcnt(5)
    v_mfma_f32_16x16x32_bf16 v[68:71], v[20:23], a[80:83], v[68:71]
    buffer_load_dwordx4 a[132:135], v11, s[40:43], s74 offen offset:0 sc1
    v_mfma_f32_16x16x32_bf16 v[88:91], v[20:23], a[84:87], v[88:91]
    ds_read_b128 v[44:47], v148 offset:7168
    s_waitcnt lgkmcnt(5)
    v_mfma_f32_16x16x32_bf16 v[72:75], v[24:27], a[80:83], v[72:75]
    buffer_load_dwordx4 a[136:139], v10, s[40:43], s74 offen offset:2048 sc1
    v_mfma_f32_16x16x32_bf16 v[92:95], v[24:27], a[84:87], v[92:95]
    ds_read_b128 v[48:51], v148 offset:8192
    s_waitcnt lgkmcnt(5)
    v_mfma_f32_16x16x32_bf16 v[76:79], v[28:31], a[80:83], v[76:79]
    buffer_load_dwordx4 a[140:143], v11, s[40:43], s74 offen offset:2048 sc1
    s_add_u32 s74, s74, 4096
    v_mfma_f32_16x16x32_bf16 v[96:99], v[28:31], a[84:87], v[96:99]
    ds_read_b128 v[52:55], v148 offset:9216
    s_waitcnt lgkmcnt(5)
    v_mfma_f32_16x16x32_bf16 v[80:83], v[32:35], a[80:83], v[80:83]
    s_cmp_ge_u32 s74, s75
    s_cselect_b32 s74, s76, s74
    s_add_u32 m0, s66, 61440
    v_mfma_f32_16x16x32_bf16 v[100:103], v[32:35], a[84:87], v[100:103]
    s_add_u32 s96, s71, 1024
    s_waitcnt vmcnt(28) lgkmcnt(4)
    v_mfma_f32_16x16x32_bf16 v[64:67], v[36:39], a[88:91], v[64:67]
    s_barrier
    s_waitcnt vmcnt(27)
    v_mfma_f32_16x16x32_bf16 v[84:87], v[36:39], a[92:95], v[84:87]
    ds_read_b128 v[16:19], v150 offset:20480
    s_waitcnt lgkmcnt(4)
    v_mfma_f32_16x16x32_bf16 v[68:71], v[40:43], a[88:91], v[68:71]
    ds_read_b128 v[20:23], v150 offset:21504
    buffer_load_dwordx4 v4, s[40:43], s71 offen offset:0 sc1 lds
    v_mfma_f32_16x16x32_bf16 v[88:91], v[40:43], a[92:95], v[88:91]
    ds_read_b128 v[24:27], v150 offset:22528
    s_waitcnt lgkmcnt(5)
    v_mfma_f32_16x16x32_bf16 v[72:75], v[44:47], a[88:91], v[72:75]
    buffer_load_dwordx4 v4, s[40:43], s71 offen offset:1024 sc1 lds
    v_mfma_f32_16x16x32_bf16 v[92:95], v[44:47], a[92:95], v[92:95]
    ds_read_b128 v[28:31], v150 offset:23552
    s_waitcnt lgkmcnt(5)
    v_mfma_f32_16x16x32_bf16 v[76:79], v[48:51], a[88:91], v[76:79]
    buffer_load_dwordx4 v4, s[40:43], s71 offen offset:2048 sc1 lds
    v_mfma_f32_16x16x32_bf16 v[96:99], v[48:51], a[92:95], v[96:99]
    ds_read_b128 v[32:35], v150 offset:24576
    s_waitcnt lgkmcnt(5)
    v_mfma_f32_16x16x32_bf16 v[80:83], v[52:55], a[88:91], v[80:83]
    buffer_load_dwordx4 v4, s[40:43], s71 offen offset:3072 sc1 lds
    s_add_u32 m0, s66, 62464
    v_mfma_f32_16x16x32_bf16 v[100:103], v[52:55], a[92:95], v[100:103]
    buffer_load_dwordx4 v4, s[40:43], s96 offen offset:3072 sc1 lds
    s_add_u32 s71, s71, 10240
    s_cmp_ge_u32 s71, s72
    s_cselect_b32 s71, s73, s71
    s_waitcnt vmcnt(26) lgkmcnt(4)
    v_mfma_f32_16x16x32_bf16 v[64:67], v[16:19], a[96:99], v[64:67]
    ds_read_b128 v[36:39], v150 offset:25600
    buffer_load_dwordx4 a[144:147], v10, s[40:43], s74 offen offset:0 sc1
    s_waitcnt vmcnt(26)
    v_mfma_f32_16x16x32_bf16 v[84:87], v[16:19], a[100:103], v[84:87]
    ds_read_b128 v[40:43], v150 offset:26624
    s_waitcnt lgkmcnt(5)
    v_mfma_f32_16x16x32_bf16 v[68:71], v[20:23], a[96:99], v[68:71]
    v_mfma_f32_16x16x32_bf16 v[88:91], v[20:23], a[100:103], v[88:91]
    ds_read_b128 v[44:47], v150 offset:27648
    s_waitcnt lgkmcnt(5)
    v_mfma_f32_16x16x32_bf16 v[72:75], v[24:27], a[96:99], v[72:75]
    buffer_load_dwordx4 a[148:151], v11, s[40:43], s74 offen offset:0 sc1
    v_mfma_f32_16x16x32_bf16 v[92:95], v[24:27], a[100:103], v[92:95]
    ds_read_b128 v[48:51], v150 offset:28672
    s_waitcnt lgkmcnt(5)
    v_mfma_f32_16x16x32_bf16 v[76:79], v[28:31], a[96:99], v[76:79]
    v_mfma_f32_16x16x32_bf16 v[96:99], v[28:31], a[100:103], v[96:99]
    ds_read_b128 v[52:55], v150 offset:29696
    s_waitcnt lgkmcnt(5)
    v_mfma_f32_16x16x32_bf16 v[80:83], v[32:35], a[96:99], v[80:83]
    buffer_load_dwordx4 a[152:155], v10, s[40:43], s74 offen offset:2048 sc1
    v_mfma_f32_16x16x32_bf16 v[100:103], v[32:35], a[100:103], v[100:103]
    s_waitcnt vmcnt(27) lgkmcnt(4)
    v_mfma_f32_16x16x32_bf16 v[64:67], v[36:39], a[104:107], v[64:67]
    s_barrier
    s_waitcnt vmcnt(26)
    v_mfma_f32_16x16x32_bf16 v[84:87], v[36:39], a[108:111], v[84:87]
    ds_read_b128 v[16:19], v150 offset:0
    s_waitcnt lgkmcnt(4)
    v_mfma_f32_16x16x32_bf16 v[68:71], v[40:43], a[104:107], v[68:71]
    ds_read_b128 v[20:23], v150 offset:1024
    buffer_load_dwordx4 a[156:159], v11, s[40:43], s74 offen offset:2048 sc1
    v_mfma_f32_16x16x32_bf16 v[88:91], v[40:43], a[108:111], v[88:91]
    ds_read_b128 v[24:27], v150 offset:2048
    s_waitcnt lgkmcnt(5)
    v_mfma_f32_16x16x32_bf16 v[72:75], v[44:47], a[104:107], v[72:75]
    s_add_u32 s74, s74, 4096
    v_mfma_f32_16x16x32_bf16 v[92:95], v[44:47], a[108:111], v[92:95]
    ds_read_b128 v[28:31], v150 offset:3072
    s_waitcnt lgkmcnt(5)
    v_mfma_f32_16x16x32_bf16 v[76:79], v[48:51], a[104:107], v[76:79]
    s_cmp_ge_u32 s74, s75
    s_cselect_b32 s74, s76, s74
    v_mfma_f32_16x16x32_bf16 v[96:99], v[48:51], a[108:111], v[96:99]
    ds_read_b128 v[32:35], v150 offset:4096
    s_waitcnt lgkmcnt(5)
    v_mfma_f32_16x16x32_bf16 v[80:83], v[52:55], a[104:107], v[80:83]
    v_mfma_f32_16x16x32_bf16 v[100:103], v[52:55], a[108:111], v[100:103]
    s_waitcnt vmcnt(21) lgkmcnt(4)
    v_mfma_f32_16x16x32_bf16 v[64:67], v[16:19], a[112:115], v[64:67]
    ds_read_b128 v[36:39], v150 offset:5120
    buffer_load_dwordx4 a[0:3], v10, s[40:43], s74 offen offset:0 sc1
    s_waitcnt vmcnt(21)
    v_mfma_f32_16x16x32_bf16 v[84:87], v[16:19], a[116:119], v[84:87]
    ds_read_b128 v[40:43], v150 offset:6144
    s_waitcnt lgkmcnt(5)
    v_mfma_f32_16x16x32_bf16 v[68:71], v[20:23], a[112:115], v[68:71]
    v_mfma_f32_16x16x32_bf16 v[88:91], v[20:23], a[116:119], v[88:91]
    ds_read_b128 v[44:47], v150 offset:7168
    s_waitcnt lgkmcnt(5)
    v_mfma_f32_16x16x32_bf16 v[72:75], v[24:27], a[112:115], v[72:75]
    buffer_load_dwordx4 a[4:7], v11, s[40:43], s74 offen offset:0 sc1
    v_mfma_f32_16x16x32_bf16 v[92:95], v[24:27], a[116:119], v[92:95]
    ds_read_b128 v[48:51], v150 offset:8192
    s_waitcnt lgkmcnt(5)
    v_mfma_f32_16x16x32_bf16 v[76:79], v[28:31], a[112:115], v[76:79]
    v_mfma_f32_16x16x32_bf16 v[96:99], v[28:31], a[116:119], v[96:99]
    ds_read_b128 v[52:55], v150 offset:9216
    s_waitcnt lgkmcnt(5)
    v_mfma_f32_16x16x32_bf16 v[80:83], v[32:35], a[112:115], v[80:83]
    buffer_load_dwordx4 a[8:11], v10, s[40:43], s74 offen offset:2048 sc1
    v_mfma_f32_16x16x32_bf16 v[100:103], v[32:35], a[116:119], v[100:103]
    s_waitcnt vmcnt(22) lgkmcnt(4)
    v_mfma_f32_16x16x32_bf16 v[64:67], v[36:39], a[120:123], v[64:67]
    s_barrier
    s_waitcnt vmcnt(21)
    v_mfma_f32_16x16x32_bf16 v[84:87], v[36:39], a[124:127], v[84:87]
    ds_read_b128 v[16:19], v149 offset:40960
    s_waitcnt lgkmcnt(4)
    v_mfma_f32_16x16x32_bf16 v[68:71], v[40:43], a[120:123], v[68:71]
    ds_read_b128 v[20:23], v149 offset:41984
    buffer_load_dwordx4 a[12:15], v11, s[40:43], s74 offen offset:2048 sc1
    v_mfma_f32_16x16x32_bf16 v[88:91], v[40:43], a[124:127], v[88:91]
    ds_read_b128 v[24:27], v149 offset:43008
    s_waitcnt lgkmcnt(5)
    v_mfma_f32_16x16x32_bf16 v[72:75], v[44:47], a[120:123], v[72:75]
    s_add_u32 s74, s74, 4096
    v_mfma_f32_16x16x32_bf16 v[92:95], v[44:47], a[124:127], v[92:95]
    ds_read_b128 v[28:31], v149 offset:44032
    s_waitcnt lgkmcnt(5)
    v_mfma_f32_16x16x32_bf16 v[76:79], v[48:51], a[120:123], v[76:79]
    s_cmp_ge_u32 s74, s75
    s_cselect_b32 s74, s76, s74
    v_mfma_f32_16x16x32_bf16 v[96:99], v[48:51], a[124:127], v[96:99]
    ds_read_b128 v[32:35], v149 offset:45056
    s_waitcnt lgkmcnt(5)
    v_mfma_f32_16x16x32_bf16 v[80:83], v[52:55], a[120:123], v[80:83]
    v_mfma_f32_16x16x32_bf16 v[100:103], v[52:55], a[124:127], v[100:103]
    s_waitcnt vmcnt(16) lgkmcnt(4)
    v_mfma_f32_16x16x32_bf16 v[64:67], v[16:19], a[128:131], v[64:67]
    ds_read_b128 v[36:39], v149 offset:46080
    buffer_load_dwordx4 a[16:19], v10, s[40:43], s74 offen offset:0 sc1
    s_waitcnt vmcnt(16)
    v_mfma_f32_16x16x32_bf16 v[84:87], v[16:19], a[132:135], v[84:87]
    ds_read_b128 v[40:43], v149 offset:47104
    s_waitcnt lgkmcnt(5)
    v_mfma_f32_16x16x32_bf16 v[68:71], v[20:23], a[128:131], v[68:71]
    v_mfma_f32_16x16x32_bf16 v[88:91], v[20:23], a[132:135], v[88:91]
    ds_read_b128 v[44:47], v149 offset:48128
    s_waitcnt lgkmcnt(5)
    v_mfma_f32_16x16x32_bf16 v[72:75], v[24:27], a[128:131], v[72:75]
    buffer_load_dwordx4 a[20:23], v11, s[40:43], s74 offen offset:0 sc1
    v_mfma_f32_16x16x32_bf16 v[92:95], v[24:27], a[132:135], v[92:95]
    ds_read_b128 v[48:51], v149 offset:49152
    s_waitcnt lgkmcnt(5)
    v_mfma_f32_16x16x32_bf16 v[76:79], v[28:31], a[128:131], v[76:79]
    v_mfma_f32_16x16x32_bf16 v[96:99], v[28:31], a[132:135], v[96:99]
    ds_read_b128 v[52:55], v149 offset:50176
    s_waitcnt lgkmcnt(5)
    v_mfma_f32_16x16x32_bf16 v[80:83], v[32:35], a[128:131], v[80:83]
    buffer_load_dwordx4 a[24:27], v10, s[40:43], s74 offen offset:2048 sc1
    v_mfma_f32_16x16x32_bf16 v[100:103], v[32:35], a[132:135], v[100:103]
    s_waitcnt vmcnt(17) lgkmcnt(4)
    v_mfma_f32_16x16x32_bf16 v[64:67], v[36:39], a[136:139], v[64:67]
    s_barrier
    s_waitcnt vmcnt(16)
    v_mfma_f32_16x16x32_bf16 v[84:87], v[36:39], a[140:143], v[84:87]
    ds_read_b128 v[16:19], v148 offset:20480
    s_waitcnt lgkmcnt(4)
    v_mfma_f32_16x16x32_bf16 v[68:71], v[40:43], a[136:139], v[68:71]
    ds_read_b128 v[20:23], v148 offset:21504
    buffer_load_dwordx4 a[28:31], v11, s[40:43], s74 offen offset:2048 sc1
    v_mfma_f32_16x16x32_bf16 v[88:91], v[40:43], a[140:143], v[88:91]
    ds_read_b128 v[24:27], v148 offset:22528
    s_waitcnt lgkmcnt(5)
    v_mfma_f32_16x16x32_bf16 v[72:75], v[44:47], a[136:139], v[72:75]
    s_add_u32 s74, s74, 4096
    v_mfma_f32_16x16x32_bf16 v[92:95], v[44:47], a[140:143], v[92:95]
    ds_read_b128 v[28:31], v148 offset:23552
    s_waitcnt lgkmcnt(5)
    v_mfma_f32_16x16x32_bf16 v[76:79], v[48:51], a[136:139], v[76:79]
    s_cmp_ge_u32 s74, s75
    s_cselect_b32 s74, s76, s74
    v_mfma_f32_16x16x32_bf16 v[96:99], v[48:51], a[140:143], v[96:99]
    ds_read_b128 v[32:35], v148 offset:24576
    s_waitcnt lgkmcnt(5)
    v_mfma_f32_16x16x32_bf16 v[80:83], v[52:55], a[136:139], v[80:83]
    v_mfma_f32_16x16x32_bf16 v[100:103], v[52:55], a[140:143], v[100:103]
    s_waitcnt vmcnt(11) lgkmcnt(4)
    v_mfma_f32_16x16x32_bf16 v[64:67], v[16:19], a[144:147], v[64:67]
    ds_read_b128 v[36:39], v148 offset:25600
    s_waitcnt vmcnt(10)
    v_mfma_f32_16x16x32_bf16 v[84:87], v[16:19], a[148:151], v[84:87]
    ds_read_b128 v[40:43], v148 offset:26624
    s_waitcnt lgkmcnt(5)
    v_mfma_f32_16x16x32_bf16 v[68:71], v[20:23], a[144:147], v[68:71]
    v_mfma_f32_16x16x32_bf16 v[88:91], v[20:23], a[148:151], v[88:91]
    ds_read_b128 v[44:47], v148 offset:27648
    s_waitcnt lgkmcnt(5)
    v_mfma_f32_16x16x32_bf16 v[72:75], v[24:27], a[144:147], v[72:75]
    v_mfma_f32_16x16x32_bf16 v[92:95], v[24:27], a[148:151], v[92:95]
    ds_read_b128 v[48:51], v148 offset:28672
    s_waitcnt lgkmcnt(5)
    v_mfma_f32_16x16x32_bf16 v[76:79], v[28:31], a[144:147], v[76:79]
    v_mfma_f32_16x16x32_bf16 v[96:99], v[28:31], a[148:151], v[96:99]
    ds_read_b128 v[52:55], v148 offset:29696
    s_waitcnt lgkmcnt(5)
    v_mfma_f32_16x16x32_bf16 v[80:83], v[32:35], a[144:147], v[80:83]
    v_mfma_f32_16x16x32_bf16 v[100:103], v[32:35], a[148:151], v[100:103]
    s_waitcnt vmcnt(9) lgkmcnt(4)
    v_mfma_f32_16x16x32_bf16 v[64:67], v[36:39], a[152:155], v[64:67]
    s_barrier
    s_waitcnt vmcnt(8)
    v_mfma_f32_16x16x32_bf16 v[84:87], v[36:39], a[156:159], v[84:87]
    ds_read_b128 v[16:19], v148 offset:40960
    s_waitcnt lgkmcnt(4)
    v_mfma_f32_16x16x32_bf16 v[68:71], v[40:43], a[152:155], v[68:71]
    ds_read_b128 v[20:23], v148 offset:41984
    v_mfma_f32_16x16x32_bf16 v[88:91], v[40:43], a[156:159], v[88:91]
    ds_read_b128 v[24:27], v148 offset:43008
    s_waitcnt lgkmcnt(5)
    v_mfma_f32_16x16x32_bf16 v[72:75], v[44:47], a[152:155], v[72:75]
    v_mfma_f32_16x16x32_bf16 v[92:95], v[44:47], a[156:159], v[92:95]
    ds_read_b128 v[28:31], v148 offset:44032
    s_waitcnt lgkmcnt(5)
    v_mfma_f32_16x16x32_bf16 v[76:79], v[48:51], a[152:155], v[76:79]
    v_mfma_f32_16x16x32_bf16 v[96:99], v[48:51], a[156:159], v[96:99]
    ds_read_b128 v[32:35], v148 offset:45056
    s_waitcnt lgkmcnt(5)
    v_mfma_f32_16x16x32_bf16 v[80:83], v[52:55], a[152:155], v[80:83]
    v_mfma_f32_16x16x32_bf16 v[100:103], v[52:55], a[156:159], v[100:103]
    s_waitcnt vmcnt(7) lgkmcnt(4)
    v_mfma_f32_16x16x32_bf16 v[64:67], v[16:19], a[0:3], v[64:67]
    ds_read_b128 v[36:39], v148 offset:46080
    s_waitcnt vmcnt(6)
    v_mfma_f32_16x16x32_bf16 v[84:87], v[16:19], a[4:7], v[84:87]
    ds_read_b128 v[40:43], v148 offset:47104
    s_waitcnt lgkmcnt(5)
    v_mfma_f32_16x16x32_bf16 v[68:71], v[20:23], a[0:3], v[68:71]
    v_mfma_f32_16x16x32_bf16 v[88:91], v[20:23], a[4:7], v[88:91]
    ds_read_b128 v[44:47], v148 offset:48128
    s_waitcnt lgkmcnt(5)
    v_mfma_f32_16x16x32_bf16 v[72:75], v[24:27], a[0:3], v[72:75]
    v_mfma_f32_16x16x32_bf16 v[92:95], v[24:27], a[4:7], v[92:95]
    ds_read_b128 v[48:51], v148 offset:49152
    s_waitcnt lgkmcnt(5)
    v_mfma_f32_16x16x32_bf16 v[76:79], v[28:31], a[0:3], v[76:79]
    v_mfma_f32_16x16x32_bf16 v[96:99], v[28:31], a[4:7], v[96:99]
    ds_read_b128 v[52:55], v148 offset:50176
    s_waitcnt lgkmcnt(5)
    v_mfma_f32_16x16x32_bf16 v[80:83], v[32:35], a[0:3], v[80:83]
    v_mfma_f32_16x16x32_bf16 v[100:103], v[32:35], a[4:7], v[100:103]
    s_waitcnt vmcnt(5) lgkmcnt(4)
    v_mfma_f32_16x16x32_bf16 v[64:67], v[36:39], a[8:11], v[64:67]
    s_barrier
    s_cmp_lg_u32 s60, 0
    s_cbranch_scc1 L_wd_50
    s_mov_b32 s84, 5
    v_lshlrev_b32 v1, 2, v0
    s_lshl_b32 s82, s61, 9
    s_lshl_b32 s83, s84, 6
    s_add_u32 s82, s82, s83
    s_add_u32 s82, s82, 22020096
    s_mov_b64 exec, 61440
    s_mov_b32 s85, 0
    s_cmp_eq_u32 s64, 0
    s_cbranch_scc1 L_wsl_51
L_wf_52:
    buffer_load_dword v2, v1, s[40:43], s82 offen sc1
    s_add_u32 s85, s85, 1
    s_waitcnt vmcnt(0)
    v_cmp_ne_u32 vcc, v2, v15
    s_cbranch_vccz L_wd_50
    s_cmp_lt_u32 s85, 96
    s_cbranch_scc1 L_wf_52
    s_mov_b32 s64, 0
L_wsl_51:
    s_lshl_b32 s82, s61, 6
    s_lshl_b32 s83, s84, 10
    s_add_u32 s82, s82, s83
    s_add_u32 s82, s82, 22085632
L_ws_53:
    buffer_load_dword v2, v1, s[40:43], s82 offen sc1
    s_add_u32 s85, s85, 1
    s_waitcnt vmcnt(0)
    v_cmp_ne_u32 vcc, v2, v15
    s_cbranch_vccz L_wd_50
    s_cmp_lt_u32 s85, 400000
    s_cbranch_scc1 L_ws_53
L_wd_50:
    s_mov_b64 exec, -1
    s_waitcnt lgkmcnt(0)
    s_barrier
    s_add_u32 s82, s38, 10485760
    s_add_u32 s83, s82, 4096
    buffer_load_dwordx4 v[128:131], v10, s[40:43], s82 offen sc1
    buffer_load_dwordx4 v[132:135], v10, s[40:43], s82 offen offset:2048 sc1
    buffer_load_dwordx2 v[136:137], v12, s[40:43], s83 offen sc1
    s_waitcnt vmcnt(7)
    v_mfma_f32_16x16x32_bf16 v[84:87], v[36:39], a[12:15], v[84:87]
    ds_read_b128 v[16:19], v149 offset:0
    v_mfma_f32_16x16x32_bf16 v[68:71], v[40:43], a[8:11], v[68:71]
    ds_read_b128 v[20:23], v149 offset:1024
    v_mfma_f32_16x16x32_bf16 v[88:91], v[40:43], a[12:15], v[88:91]
    ds_read_b128 v[24:27], v149 offset:2048
    v_mfma_f32_16x16x32_bf16 v[72:75], v[44:47], a[8:11], v[72:75]
    v_mfma_f32_16x16x32_bf16 v[92:95], v[44:47], a[12:15], v[92:95]
    ds_read_b128 v[28:31], v149 offset:3072
    v_mfma_f32_16x16x32_bf16 v[76:79], v[48:51], a[8:11], v[76:79]
    v_mfma_f32_16x16x32_bf16 v[96:99], v[48:51], a[12:15], v[96:99]
    ds_read_b128 v[32:35], v149 offset:4096
    v_mfma_f32_16x16x32_bf16 v[80:83], v[52:55], a[8:11], v[80:83]
    v_mfma_f32_16x16x32_bf16 v[100:103], v[52:55], a[12:15], v[100:103]
    s_waitcnt vmcnt(6) lgkmcnt(4)
    v_mfma_f32_16x16x32_bf16 v[64:67], v[16:19], a[16:19], v[64:67]
    ds_read_b128 v[36:39], v149 offset:5120
    s_waitcnt vmcnt(5)
    v_mfma_f32_16x16x32_bf16 v[84:87], v[16:19], a[20:23], v[84:87]
    ds_read_b128 v[40:43], v149 offset:6144
    s_waitcnt lgkmcnt(5)
    v_mfma_f32_16x16x32_bf16 v[68:71], v[20:23], a[16:19], v[68:71]
    v_mfma_f32_16x16x32_bf16 v[88:91], v[20:23], a[20:23], v[88:91]
    ds_read_b128 v[44:47], v149 offset:7168
    s_waitcnt lgkmcnt(5)
    v_mfma_f32_16x16x32_bf16 v[72:75], v[24:27], a[16:19], v[72:75]
    v_mfma_f32_16x16x32_bf16 v[92:95], v[24:27], a[20:23], v[92:95]
    ds_read_b128 v[48:51], v149 offset:8192
    s_waitcnt lgkmcnt(5)
    v_mfma_f32_16x16x32_bf16 v[76:79], v[28:31], a[16:19], v[76:79]
    v_mfma_f32_16x16x32_bf16 v[96:99], v[28:31], a[20:23], v[96:99]
    ds_read_b128 v[52:55], v149 offset:9216
    s_waitcnt lgkmcnt(5)
    v_mfma_f32_16x16x32_bf16 v[80:83], v[32:35], a[16:19], v[80:83]
    v_mfma_f32_16x16x32_bf16 v[100:103], v[32:35], a[20:23], v[100:103]
    s_waitcnt vmcnt(4) lgkmcnt(4)
    v_mfma_f32_16x16x32_bf16 v[64:67], v[36:39], a[24:27], v[64:67]
    s_waitcnt vmcnt(3)
    v_mfma_f32_16x16x32_bf16 v[84:87], v[36:39], a[28:31], v[84:87]
    s_waitcnt lgkmcnt(3)
    v_mfma_f32_16x16x32_bf16 v[68:71], v[40:43], a[24:27], v[68:71]
    v_mfma_f32_16x16x32_bf16 v[88:91], v[40:43], a[28:31], v[88:91]
    s_waitcnt lgkmcnt(2)
    v_mfma_f32_16x16x32_bf16 v[72:75], v[44:47], a[24:27], v[72:75]
    v_mfma_f32_16x16x32_bf16 v[92:95], v[44:47], a[28:31], v[92:95]
    s_waitcnt lgkmcnt(1)
    v_mfma_f32_16x16x32_bf16 v[76:79], v[48:51], a[24:27], v[76:79]
    v_mfma_f32_16x16x32_bf16 v[96:99], v[48:51], a[28:31], v[96:99]
    s_waitcnt lgkmcnt(0)
    v_mfma_f32_16x16x32_bf16 v[80:83], v[52:55], a[24:27], v[80:83]
    v_mfma_f32_16x16x32_bf16 v[100:103], v[52:55], a[28:31], v[100:103]
    ds_write_b128 v234, v[84:87] offset:0
    ds_write_b128 v234, v[88:91] offset:1024
    ds_write_b128 v234, v[92:95] offset:2048
    s_nop 1
    ds_write_b128 v234, v[96:99] offset:3072
    s_nop 1
    ds_write_b128 v234, v[100:103] offset:4096
    s_waitcnt lgkmcnt(0)
    s_barrier
    ds_read_b128 v[16:19], v235 offset:0
    ds_read_b128 v[20:23], v235 offset:1024
    ds_read_b128 v[24:27], v235 offset:2048
    ds_read_b128 v[28:31], v235 offset:3072
    ds_read_b128 v[32:35], v235 offset:4096
    s_waitcnt lgkmcnt(4)
    v_pk_add_f32 v[64:65], v[64:65], v[16:17]
    v_pk_add_f32 v[66:67], v[66:67], v[18:19]
    s_waitcnt lgkmcnt(3)
    v_pk_add_f32 v[68:69], v[68:69], v[20:21]
    v_pk_add_f32 v[70:71], v[70:71], v[22:23]
    s_waitcnt lgkmcnt(2)
    v_pk_add_f32 v[72:73], v[72:73], v[24:25]
    v_pk_add_f32 v[74:75], v[74:75], v[26:27]
    s_waitcnt lgkmcnt(1)
    v_pk_add_f32 v[76:77], v[76:77], v[28:29]
    v_pk_add_f32 v[78:79], v[78:79], v[30:31]
    s_waitcnt lgkmcnt(0)
    v_pk_add_f32 v[80:81], v[80:81], v[32:33]
    v_pk_add_f32 v[82:83], v[82:83], v[34:35]
    v_mov_b32 v56, 0xbfb8aa3b
    v_pk_mul_f32 v[16:17], v[64:65], v[56:57] op_sel_hi:[1,0]
    v_pk_mul_f32 v[18:19], v[66:67], v[56:57] op_sel_hi:[1,0]
    v_pk_mul_f32 v[20:21], v[68:69], v[56:57] op_sel_hi:[1,0]
    v_pk_mul_f32 v[22:23], v[70:71], v[56:57] op_sel_hi:[1,0]
    v_pk_mul_f32 v[24:25], v[72:73], v[56:57] op_sel_hi:[1,0]
    v_pk_mul_f32 v[26:27], v[74:75], v[56:57] op_sel_hi:[1,0]
    v_pk_mul_f32 v[28:29], v[76:77], v[56:57] op_sel_hi:[1,0]
    v_pk_mul_f32 v[30:31], v[78:79], v[56:57] op_sel_hi:[1,0]
    v_pk_mul_f32 v[32:33], v[80:81], v[56:57] op_sel_hi:[1,0]
    v_pk_mul_f32 v[34:35], v[82:83], v[56:57] op_sel_hi:[1,0]
    v_exp_f32 v16, v16
    v_exp_f32 v17, v17
    v_exp_f32 v18, v18
    v_exp_f32 v19, v19
    v_exp_f32 v20, v20
    v_exp_f32 v21, v21
    v_exp_f32 v22, v22
    v_exp_f32 v23, v23
    v_exp_f32 v24, v24
    v_exp_f32 v25, v25
    v_exp_f32 v26, v26
    v_exp_f32 v27, v27
    v_exp_f32 v28, v28
    v_exp_f32 v29, v29
    v_exp_f32 v30, v30
    v_exp_f32 v31, v31
    v_exp_f32 v32, v32
    v_exp_f32 v33, v33
    v_exp_f32 v34, v34
    v_exp_f32 v35, v35
    v_pk_add_f32 v[16:17], v[16:17], 1.0 op_sel_hi:[1,0]
    v_pk_add_f32 v[18:19], v[18:19], 1.0 op_sel_hi:[1,0]
    v_pk_add_f32 v[20:21], v[20:21], 1.0 op_sel_hi:[1,0]
    v_pk_add_f32 v[22:23], v[22:23], 1.0 op_sel_hi:[1,0]
    v_pk_add_f32 v[24:25], v[24:25], 1.0 op_sel_hi:[1,0]
    v_pk_add_f32 v[26:27], v[26:27], 1.0 op_sel_hi:[1,0]
    v_pk_add_f32 v[28:29], v[28:29], 1.0 op_sel_hi:[1,0]
    v_pk_add_f32 v[30:31], v[30:31], 1.0 op_sel_hi:[1,0]
    v_pk_add_f32 v[32:33], v[32:33], 1.0 op_sel_hi:[1,0]
    v_pk_add_f32 v[34:35], v[34:35], 1.0 op_sel_hi:[1,0]
    v_rcp_f32 v16, v16
    v_rcp_f32 v17, v17
    v_rcp_f32 v18, v18
    v_rcp_f32 v19, v19
    v_rcp_f32 v20, v20
    v_rcp_f32 v21, v21
    v_rcp_f32 v22, v22
    v_rcp_f32 v23, v23
    v_rcp_f32 v24, v24
    v_rcp_f32 v25, v25
    v_rcp_f32 v26, v26
    v_rcp_f32 v27, v27
    v_rcp_f32 v28, v28
    v_rcp_f32 v29, v29
    v_rcp_f32 v30, v30
    v_rcp_f32 v31, v31
    v_rcp_f32 v32, v32
    v_rcp_f32 v33, v33
    v_rcp_f32 v34, v34
    v_rcp_f32 v35, v35
    s_mov_b32 s82, 0xffff0000
    s_waitcnt vmcnt(2)
    v_lshlrev_b32 v84, 16, v128
    v_and_b32 v85, s82, v128
    v_lshlrev_b32 v86, 16, v129
    v_and_b32 v87, s82, v129
    v_lshlrev_b32 v88, 16, v130
    v_and_b32 v89, s82, v130
    v_lshlrev_b32 v90, 16, v131
    v_and_b32 v91, s82, v131
    s_waitcnt vmcnt(1)
    v_lshlrev_b32 v92, 16, v132
    v_and_b32 v93, s82, v132
    v_lshlrev_b32 v94, 16, v133
    v_and_b32 v95, s82, v133
    v_lshlrev_b32 v96, 16, v134
    v_and_b32 v97, s82, v134
    v_lshlrev_b32 v98, 16, v135
    v_and_b32 v99, s82, v135
    s_waitcnt vmcnt(0)
    v_lshlrev_b32 v100, 16, v136
    v_and_b32 v101, s82, v136
    v_lshlrev_b32 v102, 16, v137
    v_and_b32 v103, s82, v137
    v_pk_mul_f32 v[64:65], v[64:65], v[16:17]
    v_pk_mul_f32 v[66:67], v[66:67], v[18:19]
    v_pk_mul_f32 v[68:69], v[68:69], v[20:21]
    v_pk_mul_f32 v[70:71], v[70:71], v[22:23]
    v_pk_mul_f32 v[72:73], v[72:73], v[24:25]
    v_pk_mul_f32 v[74:75], v[74:75], v[26:27]
    v_pk_mul_f32 v[76:77], v[76:77], v[28:29]
    v_pk_mul_f32 v[78:79], v[78:79], v[30:31]
    v_pk_mul_f32 v[80:81], v[80:81], v[32:33]
    v_pk_mul_f32 v[82:83], v[82:83], v[34:35]
    v_pk_mul_f32 v[64:65], v[64:65], v[84:85]
    v_pk_mul_f32 v[66:67], v[66:67], v[86:87]
    v_pk_mul_f32 v[68:69], v[68:69], v[88:89]
    v_pk_mul_f32 v[70:71], v[70:71], v[90:91]
    v_pk_mul_f32 v[72:73], v[72:73], v[92:93]
    v_pk_mul_f32 v[74:75], v[74:75], v[94:95]
    v_pk_mul_f32 v[76:77], v[76:77], v[96:97]
    v_pk_mul_f32 v[78:79], v[78:79], v[98:99]
    v_pk_mul_f32 v[80:81], v[80:81], v[100:101]
    v_pk_mul_f32 v[82:83], v[82:83], v[102:103]
    ds_write_b128 v180, v[64:67] offset:0
    ds_write_b128 v180, v[68:71] offset:32
    ds_write_b128 v180, v[72:75] offset:128
    ds_write_b128 v180, v[76:79] offset:160
    ds_write_b128 v179, v[80:83] offset:256
    s_waitcnt lgkmcnt(0)
    ds_read_b128 v[64:67], v176
    ds_read_b128 v[68:71], v176 offset:16
    ds_read_b128 v[72:75], v177
    ds_read_b128 v[76:79], v177 offset:16
    ds_read_b128 v[80:83], v178
    ds_read_b128 v[84:87], v178 offset:16
    s_waitcnt lgkmcnt(5)
    v_pk_add_f32 v[64:65], v[64:65], v[152:153]
    v_pk_add_f32 v[66:67], v[66:67], v[154:155]
    s_waitcnt lgkmcnt(4)
    v_pk_add_f32 v[68:69], v[68:69], v[156:157]
    v_pk_add_f32 v[70:71], v[70:71], v[158:159]
    v_cvt_pk_bf16_f32 v40, v64, v65
    v_cvt_pk_bf16_f32 v41, v66, v67
    v_cvt_pk_bf16_f32 v42, v68, v69
    v_cvt_pk_bf16_f32 v43, v70, v71
    buffer_store_dwordx4 v[40:43], v192, s[52:55], s15 offen
    s_waitcnt lgkmcnt(3)
    v_pk_add_f32 v[72:73], v[72:73], v[160:161]
    v_pk_add_f32 v[74:75], v[74:75], v[162:163]
    s_waitcnt lgkmcnt(2)
    v_pk_add_f32 v[76:77], v[76:77], v[164:165]
    v_pk_add_f32 v[78:79], v[78:79], v[166:167]
    v_cvt_pk_bf16_f32 v44, v72, v73
    v_cvt_pk_bf16_f32 v45, v74, v75
    v_cvt_pk_bf16_f32 v46, v76, v77
    v_cvt_pk_bf16_f32 v47, v78, v79
    buffer_store_dwordx4 v[44:47], v193, s[52:55], s15 offen
    s_waitcnt lgkmcnt(1)
    v_pk_add_f32 v[80:81], v[80:81], v[168:169]
    v_pk_add_f32 v[82:83], v[82:83], v[170:171]
    s_waitcnt lgkmcnt(0)
    v_pk_add_f32 v[84:85], v[84:85], v[172:173]
    v_pk_add_f32 v[86:87], v[86:87], v[174:175]
    v_cvt_pk_bf16_f32 v48, v80, v81
    v_cvt_pk_bf16_f32 v49, v82, v83
    v_cvt_pk_bf16_f32 v50, v84, v85
    v_cvt_pk_bf16_f32 v51, v86, v87
    buffer_store_dwordx4 v[48:51], v198, s[52:55], s15 offen
L_end:
    s_endpgm
.section .rodata,"a"
.p2align 6
.amdhsa_kernel recurrent_scan__linear_attn_block__mixer_s_mlp__prompt_kernel
  .amdhsa_next_free_vgpr 416
  .amdhsa_next_free_sgpr 102
  .amdhsa_accum_offset 256
  .amdhsa_group_segment_fixed_size 0
  .amdhsa_kernarg_size 88
  .amdhsa_user_sgpr_count 2
  .amdhsa_user_sgpr_kernarg_segment_ptr 1
  .amdhsa_system_sgpr_workgroup_id_x 1
.end_amdhsa_kernel
```
